```python
import torch

def _softmax(x, axis=-1):
    return torch.softmax(x, dim=axis)
def _gelu(x):
    return torch.nn.functional.gelu(x, approximate="tanh")
def _silu(x):
    return torch.nn.functional.silu(x)
def _sigmoid(x):
    return torch.sigmoid(x)
def _layernorm(x, axis=-1, eps=1e-5):
    m = x.mean(dim=axis, keepdim=True)
    v = x.var(dim=axis, keepdim=True, unbiased=False)
    return (x - m) / torch.sqrt(v + eps)
def _scatter_add(tgt, idx, src, axis=0):
    return tgt.clone().index_add_(axis, idx, src)
def _segment_sum(src, seg, n):
    out = torch.zeros((n,) + src.shape[1:], dtype=src.dtype)
    return out.index_add_(0, seg, src)
def _pad(x, pw):
    flat = tuple(v for pair in reversed(pw) for v in pair)
    return torch.nn.functional.pad(x, flat)

kernel_name = 'parallel_sum__ssm_conv_s5__glu_gated_geglu__prompt'

def setup_inputs():

    _w = (lambda a: (lambda t: t.to(torch.bfloat16) if t.is_floating_point() else t)(torch.as_tensor(a)))
    def _A_setup():
        B, S, D = 1, 2048, 640
        P = D
        Lambda_re = -0.5 * (lambda _x: torch.exp(torch.as_tensor(_x)))((lambda *s: torch.randn(*s, dtype=torch.bfloat16) * 0.2)(P))
        Lambda_im = (lambda *s: torch.randn(*s, dtype=torch.bfloat16) * 0.4)(P) * 1.0
        B_re = (lambda *s: torch.randn(*s, dtype=torch.bfloat16) * 0.2)(P, D) * (D ** -0.5)
        B_im = (lambda *s: torch.randn(*s, dtype=torch.bfloat16) * 0.2)(P, D) * (D ** -0.5)
        C_re = (lambda *s: torch.randn(*s, dtype=torch.bfloat16) * 0.2)(D, P) * (P ** -0.5)
        C_im = (lambda *s: torch.randn(*s, dtype=torch.bfloat16) * 0.2)(D, P) * (P ** -0.5)
        log_dt = (lambda *s: torch.randn(*s, dtype=torch.bfloat16) * 0.2)(P) * 0.3 - 2.0
        Dskip = (lambda *s: torch.randn(*s, dtype=torch.bfloat16) * 0.05)(D)
        return {
            "x": _w((lambda *s: torch.randn(*s, dtype=torch.bfloat16) * 0.05)(B, S, D)),
            "Lambda_re": _w(Lambda_re),
            "Lambda_im": _w(Lambda_im),
            "B_re": _w(B_re),
            "B_im": _w(B_im),
            "C_re": _w(C_re),
            "C_im": _w(C_im),
            "log_dt": _w(log_dt),
            "Dskip": _w(Dskip),
        }
    _A_in = _A_setup()

    def _B_setup():
        B, S, Dm, Df = 1, 2048, 640, 1728
        return {
            "x": _w((lambda *s: torch.randn(*s, dtype=torch.bfloat16) * 0.05)(B, S, Dm)),
            "w_gate": _w((lambda *s: torch.randn(*s, dtype=torch.bfloat16) * 0.4)(Dm, Df) * (Dm ** -0.5)),
            "w_up": _w((lambda *s: torch.randn(*s, dtype=torch.bfloat16) * 0.4)(Dm, Df) * (Dm ** -0.5)),
            "w_down": _w((lambda *s: torch.randn(*s, dtype=torch.bfloat16) * 0.4)(Df, Dm) * (Df ** -0.5)),
        }
    _B_in = _B_setup()

    return {
        "A_x": _A_in["x"],
        "A_Lambda_re": _A_in["Lambda_re"],
        "A_Lambda_im": _A_in["Lambda_im"],
        "A_B_re": _A_in["B_re"],
        "A_B_im": _A_in["B_im"],
        "A_C_re": _A_in["C_re"],
        "A_C_im": _A_in["C_im"],
        "A_log_dt": _A_in["log_dt"],
        "A_Dskip": _A_in["Dskip"],
        "B_x": _B_in["x"],
        "B_w_gate": _B_in["w_gate"],
        "B_w_up": _B_in["w_up"],
        "B_w_down": _B_in["w_down"],
    }

def reference(A_x, A_Lambda_re, A_Lambda_im, A_B_re, A_B_im, A_C_re, A_C_im, A_log_dt, A_Dskip, B_x, B_w_gate, B_w_up, B_w_down):
    def _A_ref(x, Lambda_re, Lambda_im, B_re, B_im, C_re, C_im, log_dt, Dskip):
        Bsz, L, H = x.shape
        Lam = Lambda_re + 1j * Lambda_im
        Bmat = B_re + 1j * B_im
        Cmat = C_re + 1j * C_im
        dt = torch.exp(log_dt)
        Lam_bar = torch.exp(dt * Lam)
        B_bar = ((Lam_bar - 1.0) / Lam)[:, None] * Bmat
        Bu = torch.einsum("bld,pd->blp", x + 0j, B_bar)
        h = torch.zeros_like(Bu[:, 0, :])
        hs = []
        for t in range(L):
            h = Lam_bar[None, :] * h + Bu[:, t, :]
            hs.append(h)
        hseq = torch.stack(hs, 1)
        y = 2.0 * torch.einsum("blp,dp->bld", hseq, Cmat).real + x * Dskip[None, None, :]
        return y

    def _B_ref(x, w_gate, w_up, w_down):
        g = torch.einsum("bsd,df->bsf", x, w_gate)
        u = torch.einsum("bsd,df->bsf", x, w_up)
        h = _gelu(g) * u
        return torch.einsum("bsf,fd->bsd", h, w_down)

    x = A_x
    xn = _layernorm(x, axis=-1)
    return x + _A_ref(xn, A_Lambda_re, A_Lambda_im, A_B_re, A_B_im, A_C_re, A_C_im, A_log_dt, A_Dskip) + _B_ref(xn, B_w_gate, B_w_up, B_w_down)
```

```asm
; @launch grid=(256,1,1) block=(256,1,1) lds=163840
.amdgcn_target "amdgcn-amd-amdhsa--gfx950"
.text
.globl parallel_sum__ssm_conv_s5__glu_gated_geglu__prompt_kernel
.p2align 8
.type parallel_sum__ssm_conv_s5__glu_gated_geglu__prompt_kernel,@function
parallel_sum__ssm_conv_s5__glu_gated_geglu__prompt_kernel:
  s_cmp_ge_u32 s2, 256
  s_cbranch_scc1 L_END
  s_load_dwordx2 s[54:55], s[0:1], 0
  s_load_dwordx4 s[40:43], s[0:1], 80
  s_load_dwordx4 s[44:47], s[0:1], 24
  s_load_dwordx4 s[36:39], s[0:1], 112
  s_memrealtime s[60:61]
  v_lshrrev_b32 v24, 6, v0
  v_and_b32 v1, 63, v0
  s_and_b32 s25, s2, 1
  s_lshl_b32 s25, s25, 3
  v_readfirstlane_b32 s24, v24
  s_bfe_u32 s3, s2, 0x30003
  s_add_u32 s25, s25, s3
  s_bfe_u32 s3, s2, 0x10001
  s_lshl_b32 s3, s3, 2
  s_lshr_b32 s56, s2, 6
  s_add_u32 s3, s3, s56
  s_lshl_b32 s3, s3, 2
  s_mov_b32 s26, 0xa54f9876
  s_bitcmp0_b32 s2, 2
  s_cselect_b32 s26, 0x32ed10cb, s26
  s_lshr_b32 s26, s26, s3
  s_and_b32 s26, s26, 15
  s_lshl_b32 s27, s24, 12
  s_and_b32 s34, s24, 1
  s_lshr_b32 s35, s24, 1
  s_mul_i32 s56, s56, 5
  s_add_u32 s56, s56, 1
  s_lshr_b32 s56, s56, 1
  s_add_u32 s68, s56, s25
  s_mul_hi_u32 s3, s68, 429496730
  s_mul_i32 s3, s3, 10
  s_sub_u32 s68, s68, s3
  s_mov_b32 s69, s68
  s_mov_b32 s48, s68
  v_lshrrev_b32 v24, 3, v1
  v_lshrrev_b32 v25, 4, v1
  v_and_b32 v26, 7, v1
  v_xor_b32 v27, v26, v25
  v_lshlrev_b32 v27, 4, v27
  v_mul_u32_u24 v28, 1280, v24
  v_add_u32 v29, v28, v27
  s_mul_i32 s57, s24, 40960
  v_add_u32 v2, s57, v29
  s_cmp_ge_u32 s26, 11
  s_cselect_b32 s49, 0, 64
  s_cselect_b32 s50, 64, 0
  s_cselect_b32 s51, 64, 0
  s_cselect_b32 s52, 1280, 0
  s_cselect_b32 s53, 3, 1
  s_cselect_b32 s58, 0, s35
  s_cselect_b32 s59, 0, 1
  v_xor_b32 v3, s49, v2
  v_xor_b32 v4, s50, v2
  v_xor_b32 v5, 64, v2
  v_add_u32 v3, 9216, v3
  v_add_u32 v4, 18432, v4
  v_add_u32 v5, 27648, v5
  s_cselect_b32 s52, s52, 3456
  s_lshl_b32 s58, s58, 2
  v_and_b32 v27, s53, v25
  v_lshlrev_b32 v27, s59, v27
  v_or_b32 v27, s58, v27
  v_xor_b32 v27, v27, v26
  v_mul_u32_u24 v28, s52, v24
  v_lshl_add_u32 v28, v27, 4, v28
  s_mul_i32 s57, s34, s52
  s_lshl_b32 s57, s57, 5
  v_add_u32 v6, s57, v28
  s_lshl_b32 s57, s52, 3
  s_sub_u32 s57, s57, 1024
  v_xor_b32 v7, s51, v6
  v_add_u32 v7, s57, v7
  s_lshl_b32 s57, s57, 1
  v_add_u32 v8, s57, v6
  v_add_u32 v9, s57, v7
  s_mul_i32 s3, s26, 320
  s_and_b32 s57, s26, 1
  s_lshl_b32 s30, s57, 6
  s_add_u32 s30, s30, s3
  s_mul_i32 s101, s68, 221184
  s_add_u32 s101, s101, s30
  s_lshl_b32 s3, s68, 7
  s_sub_u32 s33, s26, 11
  s_mul_i32 s57, s33, 163840
  s_cmp_ge_u32 s26, 11
  s_cselect_b32 s101, s3, s101
  s_cselect_b32 s57, s57, 0
  s_cselect_b32 s10, 163840, 0
  s_cselect_b32 s3, 0, 2211840
  s_or_b32 s10, s10, s3
  s_lshl_b32 s58, s25, 4
  s_add_u32 s58, s58, s26
  s_lshl_b32 s58, s58, 3
  s_lshl_b32 s3, s24, 1
  s_add_u32 s58, s58, s3
  v_lshrrev_b32 v128, 5, v1
  v_add_u32 v128, s58, v128
  v_mul_u32_u24 v129, 1280, v128
  v_and_b32 v190, 31, v1
  v_lshl_add_u32 v129, v190, 3, v129
  v_mov_b32 v190, 0
  s_mul_i32 s56, s25, 163840
  s_mov_b32 s6, 163840
  s_mov_b32 s7, 0x20000
  s_mov_b32 s11, 0x20000
  s_mov_b32 s22, 2621440
  s_mov_b32 s23, 0x20000
  s_mov_b32 s18, 256
  s_mov_b32 s19, 0x20000
  s_waitcnt lgkmcnt(0)
  s_add_u32 s4, s54, s56
  s_addc_u32 s5, s55, 0
  s_mov_b32 s20, s54
  s_mov_b32 s21, s55
  s_mov_b32 s16, s36
  s_mov_b32 s17, s37
  s_or_b32 s3, s2, s24
  s_cmp_lg_u32 s3, 0
  s_cbranch_scc1 L_NT
  s_or_b32 s60, s60, 1
  s_or_b32 s61, s61, 0x80000000
  v_mov_b32 v168, s60
  v_mov_b32 v169, s61
  buffer_store_dwordx2 v[168:169], v190, s[16:19], 0 offen sc1
L_NT:
  buffer_load_dwordx2 v[130:131], v129, s[20:23], 0 offen offset:0
  buffer_load_dwordx2 v[132:133], v129, s[20:23], 0 offen offset:256
  buffer_load_dwordx2 v[134:135], v129, s[20:23], 0 offen offset:512
  buffer_load_dwordx2 v[136:137], v129, s[20:23], 0 offen offset:768
  buffer_load_dwordx2 v[138:139], v129, s[20:23], 0 offen offset:1024
  s_add_u32 m0, s27, 0
  s_lshl_b32 s28, s68, 7
  buffer_load_dwordx4 v2, s[4:7], s28 offen offset:0 lds
  buffer_load_dwordx4 v3, s[4:7], s28 offen offset:1024 lds
  buffer_load_dwordx4 v4, s[4:7], s28 offen offset:2048 lds
  s_add_u32 s68, s68, 1
  s_cmp_ge_u32 s68, 10
  s_cselect_b32 s3, 10, 0
  s_sub_u32 s68, s68, s3
  buffer_load_dwordx4 v5, s[4:7], s28 offen offset:3072 lds
  s_cmp_ge_u32 s26, 11
  s_cselect_b32 s40, s44, s40
  s_cselect_b32 s41, s45, s41
  s_cselect_b32 s42, s46, s42
  s_cselect_b32 s43, s47, s43
  s_cmp_ge_u32 s24, 2
  s_cselect_b32 s8, s42, s40
  s_cselect_b32 s9, s43, s41
  s_add_u32 s8, s8, s57
  s_addc_u32 s9, s9, 0
  s_add_u32 m0, s27, 65536
  s_nop 0
  buffer_load_dwordx4 v6, s[8:11], s101 offen offset:0 lds
  buffer_load_dwordx4 v7, s[8:11], s101 offen offset:1024 lds
  buffer_load_dwordx4 v8, s[8:11], s101 offen offset:2048 lds
  s_add_u32 s69, s69, 1
  s_cmp_ge_u32 s69, 10
  s_cselect_b32 s3, 10, 0
  s_sub_u32 s69, s69, s3
  buffer_load_dwordx4 v9, s[8:11], s101 offen offset:3072 lds
  v_lshlrev_b32 v128, 4, v128
  v_add_u32 v128, 65536, v128
  s_mov_b32 s37, s48
  s_cmp_ge_u32 s26, 11
  s_cbranch_scc1 L_SSM
L_FFN:
  s_add_u32 s31, s30, 128
  s_mul_i32 s3, s26, 320
  s_and_b32 s57, s26, 1
  s_xor_b32 s57, s57, 1
  s_lshl_b32 s57, s57, 8
  s_add_u32 s32, s3, s57
  s_add_u32 s63, s37, s34
  s_cmp_ge_u32 s63, 10
  s_cselect_b32 s63, 0, s63
  s_load_dwordx2 s[44:45], s[0:1], 96
  v_bfe_u32 v180, v1, 4, 1
  v_lshlrev_b32 v180, 1, v180
  v_xor_b32 v180, v180, v26
  v_lshlrev_b32 v180, 4, v180
  v_mul_u32_u24 v181, 1280, v24
  v_add_u32 v180, v180, v181
  v_xor_b32 v181, 64, v180
  v_add_u32 v181, 9216, v181
  v_xor_b32 v182, 0, v180
  v_add_u32 v182, 18432, v182
  v_xor_b32 v183, 64, v180
  v_add_u32 v183, 27648, v183
  s_getpc_b64 s[58:59]
L_PC1:
  s_and_b32 s3, s25, 7
  s_lshl_b32 s3, s3, 2
  s_add_u32 s3, s3, s24
  s_lshl_b32 s3, s3, 10
  v_and_b32 v191, 7, v1
  v_lshlrev_b32 v191, 7, v191
  v_add_u32 v191, s3, v191
  global_load_dword v187, v191, s[58:59]
  s_add_u32 s58, s58, L_STAGE2-L_PC1
  s_addc_u32 s59, s59, 0
  v_lshrrev_b32 v191, 1, v191
  global_load_dword v187, v191, s[58:59]
  s_mov_b32 s64, s38
  s_mov_b32 s65, s39
  s_mov_b32 s66, 3145728
  s_mov_b32 s67, 0x20000
  s_add_u32 s12, s38, 3145728
  s_addc_u32 s13, s39, 0
  s_mov_b32 s14, 12320768
  s_mov_b32 s15, 0x20000
  s_lshl_b32 s29, s25, 1
  s_add_u32 s29, s29, s34
  s_mul_i32 s57, s26, 25600
  s_mul_i32 s3, s35, 5120
  s_add_u32 s57, s57, s3
  s_add_u32 s57, s57, 131072
  v_cmp_lt_u32 s[58:59], 31, v1
  v_lshlrev_b32 v16, 4, v1
  v_add_u32 v17, 0x800, v16
  v_cndmask_b32 v17, v17, v16, s[58:59]
  v_cndmask_b32 v15, 1.0, 0, s[58:59]
  v_bfe_u32 v32, v1, 4, 1
  v_and_b32 v33, 15, v1
  v_mov_b32 v34, 0x3f803f80
  v_cmp_eq_u32 vcc, v32, v33
  s_nop 1
  v_cndmask_b32 v32, 0, v34, vcc
  v_mov_b32 v33, v32
  v_mov_b32 v34, v32
  v_mov_b32 v35, v32
  s_lshl_b32 s3, s34, 13
  v_and_b32 v36, 31, v1
  v_lshrrev_b32 v37, 5, v1
  v_bfe_u32 v38, v1, 1, 3
  v_xor_b32 v38, v38, v37
  v_lshlrev_b32 v38, 4, v38
  v_lshl_add_u32 v38, v36, 7, v38
  v_add_u32 v20, s3, v38
  v_xor_b32 v21, 32, v20
  v_xor_b32 v22, 64, v20
  v_xor_b32 v23, 96, v20
  s_lshl_b32 s3, s29, 10
  v_lshlrev_b32 v189, 4, v36
  v_add_u32 v189, s3, v189
  v_bfe_u32 v36, v1, 4, 1
  v_bfe_u32 v38, v1, 2, 2
  v_lshl_add_u32 v38, v37, 3, v38
  v_and_b32 v39, 1, v1
  v_bfe_u32 v40, v1, 1, 1
  v_lshlrev_b32 v39, 4, v39
  v_lshl_add_u32 v39, v40, 3, v39
  v_lshl_add_u32 v39, v36, 13, v39
  v_add_u32 v39, 65536, v39
  v_bfe_u32 v40, v1, 3, 1
  v_lshl_or_b32 v40, v36, 1, v40
  s_and_b32 s3, s24, 2
  v_xor_b32 v40, s3, v40
  v_lshlrev_b32 v40, 5, v40
  v_lshl_add_u32 v10, v38, 7, v39
  v_add_u32 v10, v10, v40
  v_xor_b32 v11, 32, v10
  v_xor_b32 v40, s35, v36
  v_lshlrev_b32 v40, 5, v40
  v_lshl_add_u32 v12, v38, 6, v39
  v_add_u32 v12, v12, v40
  v_subrev_u32 v12, 65536, v12
  v_and_b32 v38, 15, v1
  v_lshlrev_b32 v38, 4, v38
  v_lshl_add_u32 v38, v36, 10, v38
  v_lshl_add_u32 v14, v37, 8, v38
  s_mul_i32 s49, s29, 385024
  s_lshr_b32 s3, s30, 6
  s_add_u32 s3, s3, s35
  s_lshl_b32 s3, s3, 12
  s_add_u32 s50, s49, s3
  s_lshr_b32 s3, s31, 6
  s_add_u32 s3, s3, s35
  s_lshl_b32 s3, s3, 12
  s_add_u32 s51, s49, s3
  s_lshr_b32 s3, s32, 6
  s_lshl_b32 s3, s3, 12
  s_add_u32 s52, s3, s49
  s_lshl_b32 s3, s35, 9
  s_add_u32 s52, s52, s3
  s_mul_i32 s46, s25, 11
  s_add_u32 s46, s46, s26
  s_lshl_b32 s46, s46, 2
  s_add_u32 s46, s46, s24
  s_mul_hi_u32 s47, s46, 429496730
  s_mul_i32 s3, s47, 10
  s_sub_u32 s53, s46, s3
  s_cmp_lt_u32 s46, 540
  s_cselect_b32 s42, 2211840, 0
  s_cselect_b32 s22, 3850240, 0
  s_waitcnt lgkmcnt(0)
  s_mov_b32 s40, s44
  s_mov_b32 s41, s45
  s_mov_b32 s43, 0x20000
  s_add_u32 s20, s38, 15728640
  s_addc_u32 s21, s39, 0
  s_mul_i32 s46, s47, 40960
  s_lshl_b32 s3, s53, 7
  s_add_u32 s46, s46, s3
  s_lshl_b32 s53, s53, 2
  v_lshrrev_b32 v184, 4, v1
  v_bfe_u32 v185, v1, 2, 2
  v_lshl_add_u32 v185, v184, 3, v185
  v_and_b32 v184, 1, v184
  v_bfe_u32 v186, v1, 3, 1
  v_lshl_or_b32 v184, v184, 1, v186
  v_lshlrev_b32 v184, 5, v184
  v_lshl_add_u32 v184, v185, 7, v184
  v_and_b32 v185, 3, v1
  v_lshl_add_u32 v184, v185, 3, v184
  s_add_u32 s3, s27, 131072
  v_add_u32 v184, s3, v184
  v_xor_b32 v185, 32, v184
  v_xor_b32 v186, 64, v184
  v_xor_b32 v188, 96, v184
  v_lshrrev_b32 v178, 2, v1
  v_and_b32 v179, 3, v1
  v_mul_u32_u24 v178, 3456, v178
  s_and_b32 s3, s24, 2
  v_xor_b32 v179, s3, v179
  v_lshl_add_u32 v178, v179, 4, v178
  s_waitcnt vmcnt(10)
  v_lshlrev_b32 v64, 16, v130
  v_and_b32 v65, 0xffff0000, v130
  v_lshlrev_b32 v66, 16, v131
  v_and_b32 v67, 0xffff0000, v131
  v_lshlrev_b32 v68, 16, v132
  v_and_b32 v69, 0xffff0000, v132
  v_lshlrev_b32 v70, 16, v133
  v_and_b32 v71, 0xffff0000, v133
  v_lshlrev_b32 v72, 16, v134
  v_and_b32 v73, 0xffff0000, v134
  v_lshlrev_b32 v74, 16, v135
  v_and_b32 v75, 0xffff0000, v135
  v_lshlrev_b32 v76, 16, v136
  v_and_b32 v77, 0xffff0000, v136
  v_lshlrev_b32 v78, 16, v137
  v_and_b32 v79, 0xffff0000, v137
  v_lshlrev_b32 v80, 16, v138
  v_and_b32 v81, 0xffff0000, v138
  v_lshlrev_b32 v82, 16, v139
  v_and_b32 v83, 0xffff0000, v139
  v_pk_add_f32 v[160:161], v[64:65], v[66:67]
  v_pk_add_f32 v[162:163], v[68:69], v[70:71]
  v_pk_add_f32 v[160:161], v[160:161], v[72:73]
  v_pk_add_f32 v[162:163], v[162:163], v[74:75]
  v_pk_add_f32 v[160:161], v[160:161], v[76:77]
  v_pk_add_f32 v[162:163], v[162:163], v[78:79]
  v_pk_add_f32 v[160:161], v[160:161], v[80:81]
  v_pk_add_f32 v[162:163], v[162:163], v[82:83]
  v_pk_add_f32 v[160:161], v[160:161], v[162:163]
  v_add_f32 v160, v160, v161
  s_nop 1
  v_add_f32_dpp v160, v160, v160 row_ror:8 row_mask:0xf bank_mask:0xf
  s_nop 1
  v_add_f32_dpp v160, v160, v160 row_ror:4 row_mask:0xf bank_mask:0xf
  s_nop 1
  v_add_f32_dpp v160, v160, v160 row_ror:2 row_mask:0xf bank_mask:0xf
  s_nop 1
  v_add_f32_dpp v160, v160, v160 row_ror:1 row_mask:0xf bank_mask:0xf
  v_mov_b32 v161, v160
  s_nop 1
  v_permlane16_swap_b32 v160, v161
  v_add_f32 v160, v160, v161
  v_mul_f32 v160, 0x3acccccd, v160
  v_pk_add_f32 v[64:65], v[64:65], v[160:161] op_sel_hi:[1,0] neg_lo:[0,1] neg_hi:[0,1]
  v_pk_add_f32 v[66:67], v[66:67], v[160:161] op_sel_hi:[1,0] neg_lo:[0,1] neg_hi:[0,1]
  v_pk_add_f32 v[68:69], v[68:69], v[160:161] op_sel_hi:[1,0] neg_lo:[0,1] neg_hi:[0,1]
  v_pk_add_f32 v[70:71], v[70:71], v[160:161] op_sel_hi:[1,0] neg_lo:[0,1] neg_hi:[0,1]
  v_pk_add_f32 v[72:73], v[72:73], v[160:161] op_sel_hi:[1,0] neg_lo:[0,1] neg_hi:[0,1]
  v_pk_add_f32 v[74:75], v[74:75], v[160:161] op_sel_hi:[1,0] neg_lo:[0,1] neg_hi:[0,1]
  v_pk_add_f32 v[76:77], v[76:77], v[160:161] op_sel_hi:[1,0] neg_lo:[0,1] neg_hi:[0,1]
  v_pk_add_f32 v[78:79], v[78:79], v[160:161] op_sel_hi:[1,0] neg_lo:[0,1] neg_hi:[0,1]
  v_pk_add_f32 v[80:81], v[80:81], v[160:161] op_sel_hi:[1,0] neg_lo:[0,1] neg_hi:[0,1]
  v_pk_add_f32 v[82:83], v[82:83], v[160:161] op_sel_hi:[1,0] neg_lo:[0,1] neg_hi:[0,1]
  v_pk_mul_f32 v[162:163], v[64:65], v[64:65]
  v_pk_mul_f32 v[164:165], v[66:67], v[66:67]
  v_pk_fma_f32 v[162:163], v[68:69], v[68:69], v[162:163]
  v_pk_fma_f32 v[164:165], v[70:71], v[70:71], v[164:165]
  v_pk_fma_f32 v[162:163], v[72:73], v[72:73], v[162:163]
  v_pk_fma_f32 v[164:165], v[74:75], v[74:75], v[164:165]
  v_pk_fma_f32 v[162:163], v[76:77], v[76:77], v[162:163]
  v_pk_fma_f32 v[164:165], v[78:79], v[78:79], v[164:165]
  v_pk_fma_f32 v[162:163], v[80:81], v[80:81], v[162:163]
  v_pk_fma_f32 v[164:165], v[82:83], v[82:83], v[164:165]
  v_pk_add_f32 v[162:163], v[162:163], v[164:165]
  v_add_f32 v162, v162, v163
  s_nop 1
  v_add_f32_dpp v162, v162, v162 row_ror:8 row_mask:0xf bank_mask:0xf
  s_nop 1
  v_add_f32_dpp v162, v162, v162 row_ror:4 row_mask:0xf bank_mask:0xf
  s_nop 1
  v_add_f32_dpp v162, v162, v162 row_ror:2 row_mask:0xf bank_mask:0xf
  s_nop 1
  v_add_f32_dpp v162, v162, v162 row_ror:1 row_mask:0xf bank_mask:0xf
  v_mov_b32 v163, v162
  s_nop 1
  v_permlane16_swap_b32 v162, v163
  v_add_f32 v162, v162, v163
  v_mul_f32 v162, 0x3acccccd, v162
  v_cvt_pk_bf16_f32 v162, v162, v162
  v_and_b32 v162, 0xffff0000, v162
  v_add_f32 v162, 0x3727c5ac, v162
  v_cvt_pk_bf16_f32 v162, v162, v162
  v_and_b32 v162, 0xffff0000, v162
  v_sqrt_f32 v162, v162
  v_cvt_pk_bf16_f32 v160, v160, v160
  v_and_b32 v160, 0xffff0000, v160
  v_cvt_pk_bf16_f32 v161, v162, v162
  v_and_b32 v161, 0xffff0000, v161
  buffer_load_dwordx2 v[168:169], v190, s[16:19], 0 offen sc1
  s_add_u32 m0, s27, 16384
  s_lshl_b32 s28, s68, 7
  buffer_load_dwordx4 v2, s[4:7], s28 offen offset:0 lds
  buffer_load_dwordx4 v3, s[4:7], s28 offen offset:1024 lds
  buffer_load_dwordx4 v4, s[4:7], s28 offen offset:2048 lds
  s_add_u32 s68, s68, 1
  s_cmp_ge_u32 s68, 10
  s_cselect_b32 s3, 10, 0
  s_sub_u32 s68, s68, s3
  buffer_load_dwordx4 v5, s[4:7], s28 offen offset:3072 lds
  s_waitcnt lgkmcnt(0)
  s_waitcnt vmcnt(7)
  s_barrier
  ds_read_b64_tr_b16 v[48:49], v10 offset:0
  ds_read_b64_tr_b16 v[50:51], v10 offset:512
  ds_read_b128 a[0:3], v20 offset:0
  ds_read_b128 a[4:7], v20 offset:4096
  ds_read_b64_tr_b16 v[52:53], v11 offset:0
  ds_read_b64_tr_b16 v[54:55], v11 offset:512
  s_waitcnt lgkmcnt(3)
  v_mfma_f32_32x32x16_bf16 v[64:79], v[48:51], a[0:3], 0
  ds_read_b64_tr_b16 v[56:57], v10 offset:2048
  ds_read_b64_tr_b16 v[58:59], v10 offset:2560
  ds_read_b128 a[8:11], v21 offset:0
  s_add_u32 m0, s27, 81920
  s_mul_i32 s28, s69, 221184
  s_add_u32 s28, s28, s30
  buffer_load_dwordx4 v6, s[8:11], s28 offen offset:0 lds
  s_waitcnt lgkmcnt(5)
  v_mfma_f32_32x32x16_bf16 v[80:95], v[48:51], a[4:7], 0
  v_mfma_f32_16x16x32_bf16 v[24:27], v[32:35], v[48:51], 0
  ds_read_b128 a[12:15], v21 offset:4096
  buffer_load_dwordx4 v7, s[8:11], s28 offen offset:1024 lds
  s_waitcnt lgkmcnt(4)
  v_mfma_f32_32x32x16_bf16 v[96:111], v[52:55], a[0:3], 0
  ds_read_b64_tr_b16 v[60:61], v11 offset:2048
  ds_read_b64_tr_b16 v[62:63], v11 offset:2560
  ds_read_b128 a[16:19], v22 offset:0
  buffer_load_dwordx4 v8, s[8:11], s28 offen offset:2048 lds
  s_add_u32 s69, s69, 1
  s_cmp_ge_u32 s69, 10
  s_cselect_b32 s3, 10, 0
  s_sub_u32 s69, s69, s3
  v_mfma_f32_32x32x16_bf16 v[112:127], v[52:55], a[4:7], 0
  v_mfma_f32_16x16x32_bf16 v[28:31], v[32:35], v[52:55], 0
  ds_read_b128 a[20:23], v22 offset:4096
  buffer_load_dwordx4 v9, s[8:11], s28 offen offset:3072 lds
  s_waitcnt lgkmcnt(5)
  v_mfma_f32_32x32x16_bf16 v[64:79], v[56:59], a[8:11], v[64:79]
  ds_read_b64_tr_b16 v[48:49], v10 offset:4096
  ds_read_b64_tr_b16 v[50:51], v10 offset:4608
  ds_read_b128 a[24:27], v23 offset:0
  s_add_u32 m0, s27, 32768
  s_lshl_b32 s28, s68, 7
  buffer_load_dwordx4 v2, s[4:7], s28 offen offset:0 lds
  s_waitcnt lgkmcnt(7)
  v_mfma_f32_32x32x16_bf16 v[80:95], v[56:59], a[12:15], v[80:95]
  v_mfma_f32_16x16x32_bf16 v[24:27], v[32:35], v[56:59], v[24:27]
  ds_read_b128 a[28:31], v23 offset:4096
  buffer_load_dwordx4 v3, s[4:7], s28 offen offset:1024 lds
  s_waitcnt lgkmcnt(6)
  v_mfma_f32_32x32x16_bf16 v[96:111], v[60:63], a[8:11], v[96:111]
  ds_read_b64_tr_b16 v[52:53], v11 offset:4096
  ds_read_b64_tr_b16 v[54:55], v11 offset:4608
  buffer_load_dwordx4 v4, s[4:7], s28 offen offset:2048 lds
  s_add_u32 s68, s68, 1
  s_cmp_ge_u32 s68, 10
  s_cselect_b32 s3, 10, 0
  s_sub_u32 s68, s68, s3
  v_mfma_f32_32x32x16_bf16 v[112:127], v[60:63], a[12:15], v[112:127]
  v_mfma_f32_16x16x32_bf16 v[28:31], v[32:35], v[60:63], v[28:31]
  buffer_load_dwordx4 v5, s[4:7], s28 offen offset:3072 lds
  s_waitcnt lgkmcnt(4)
  v_mfma_f32_32x32x16_bf16 v[64:79], v[48:51], a[16:19], v[64:79]
  ds_read_b64_tr_b16 v[56:57], v10 offset:6144
  ds_read_b64_tr_b16 v[58:59], v10 offset:6656
  s_add_u32 m0, s27, 98304
  s_mul_i32 s28, s69, 221184
  s_add_u32 s28, s28, s30
  buffer_load_dwordx4 v6, s[8:11], s28 offen offset:0 lds
  v_mfma_f32_32x32x16_bf16 v[80:95], v[48:51], a[20:23], v[80:95]
  v_mfma_f32_16x16x32_bf16 v[24:27], v[32:35], v[48:51], v[24:27]
  ds_read_b64_tr_b16 v[60:61], v11 offset:6144
  ds_read_b64_tr_b16 v[62:63], v11 offset:6656
  buffer_load_dwordx4 v7, s[8:11], s28 offen offset:1024 lds
  s_waitcnt lgkmcnt(4)
  v_mfma_f32_32x32x16_bf16 v[96:111], v[52:55], a[16:19], v[96:111]
  buffer_load_dwordx4 v8, s[8:11], s28 offen offset:2048 lds
  s_add_u32 s69, s69, 1
  s_cmp_ge_u32 s69, 10
  s_cselect_b32 s3, 10, 0
  s_sub_u32 s69, s69, s3
  v_mfma_f32_32x32x16_bf16 v[112:127], v[52:55], a[20:23], v[112:127]
  v_mfma_f32_16x16x32_bf16 v[28:31], v[32:35], v[52:55], v[28:31]
  buffer_load_dwordx4 v9, s[8:11], s28 offen offset:3072 lds
  s_waitcnt lgkmcnt(2)
  v_mfma_f32_32x32x16_bf16 v[64:79], v[56:59], a[24:27], v[64:79]
  s_waitcnt vmcnt(8) lgkmcnt(0)
  s_barrier
  ds_read_b64_tr_b16 v[48:49], v10 offset:16384
  ds_read_b64_tr_b16 v[50:51], v10 offset:16896
  v_mfma_f32_32x32x16_bf16 v[80:95], v[56:59], a[28:31], v[80:95]
  v_mfma_f32_16x16x32_bf16 v[24:27], v[32:35], v[56:59], v[24:27]
  ds_read_b128 a[32:35], v20 offset:16384
  s_add_u32 m0, s27, 49152
  s_lshl_b32 s28, s68, 7
  buffer_load_dwordx4 v2, s[4:7], s28 offen offset:0 lds
  v_mfma_f32_32x32x16_bf16 v[96:111], v[60:63], a[24:27], v[96:111]
  ds_read_b64_tr_b16 v[52:53], v11 offset:16384
  ds_read_b64_tr_b16 v[54:55], v11 offset:16896
  ds_read_b128 a[36:39], v20 offset:20480
  buffer_load_dwordx4 v3, s[4:7], s28 offen offset:1024 lds
  v_mfma_f32_32x32x16_bf16 v[112:127], v[60:63], a[28:31], v[112:127]
  v_mfma_f32_16x16x32_bf16 v[28:31], v[32:35], v[60:63], v[28:31]
  s_waitcnt lgkmcnt(3)
  v_mfma_f32_32x32x16_bf16 v[64:79], v[48:51], a[32:35], v[64:79]
  ds_read_b64_tr_b16 v[56:57], v10 offset:18432
  ds_read_b64_tr_b16 v[58:59], v10 offset:18944
  ds_read_b128 a[40:43], v21 offset:16384
  buffer_load_dwordx4 v4, s[4:7], s28 offen offset:2048 lds
  s_add_u32 s68, s68, 1
  s_cmp_ge_u32 s68, 10
  s_cselect_b32 s3, 10, 0
  s_sub_u32 s68, s68, s3
  s_waitcnt lgkmcnt(3)
  v_mfma_f32_32x32x16_bf16 v[80:95], v[48:51], a[36:39], v[80:95]
  ds_read_b128 a[44:47], v21 offset:20480
  v_mfma_f32_32x32x16_bf16 v[96:111], v[52:55], a[32:35], v[96:111]
  ds_read_b64_tr_b16 v[60:61], v11 offset:18432
  ds_read_b64_tr_b16 v[62:63], v11 offset:18944
  ds_read_b128 a[48:51], v22 offset:16384
  buffer_load_dwordx4 v5, s[4:7], s28 offen offset:3072 lds
  v_mfma_f32_32x32x16_bf16 v[112:127], v[52:55], a[36:39], v[112:127]
  ds_read_b128 a[52:55], v22 offset:20480
  s_waitcnt lgkmcnt(5)
  v_mfma_f32_32x32x16_bf16 v[64:79], v[56:59], a[40:43], v[64:79]
  ds_read_b64_tr_b16 v[48:49], v10 offset:20480
  ds_read_b64_tr_b16 v[50:51], v10 offset:20992
  ds_read_b128 a[56:59], v23 offset:16384
  s_add_u32 m0, s27, 114688
  s_mul_i32 s28, s69, 221184
  s_add_u32 s28, s28, s30
  buffer_load_dwordx4 v6, s[8:11], s28 offen offset:0 lds
  s_waitcnt lgkmcnt(7)
  v_mfma_f32_32x32x16_bf16 v[80:95], v[56:59], a[44:47], v[80:95]
  ds_read_b128 a[60:63], v23 offset:20480
  buffer_load_dwordx4 v7, s[8:11], s28 offen offset:1024 lds
  s_waitcnt lgkmcnt(6)
  v_mfma_f32_32x32x16_bf16 v[96:111], v[60:63], a[40:43], v[96:111]
  ds_read_b64_tr_b16 v[52:53], v11 offset:20480
  ds_read_b64_tr_b16 v[54:55], v11 offset:20992
  v_mfma_f32_32x32x16_bf16 v[112:127], v[60:63], a[44:47], v[112:127]
  buffer_load_dwordx4 v8, s[8:11], s28 offen offset:2048 lds
  s_add_u32 s69, s69, 1
  s_cmp_ge_u32 s69, 10
  s_cselect_b32 s3, 10, 0
  s_sub_u32 s69, s69, s3
  s_waitcnt lgkmcnt(4)
  v_mfma_f32_32x32x16_bf16 v[64:79], v[48:51], a[48:51], v[64:79]
  ds_read_b64_tr_b16 v[56:57], v10 offset:22528
  ds_read_b64_tr_b16 v[58:59], v10 offset:23040
  v_mfma_f32_32x32x16_bf16 v[80:95], v[48:51], a[52:55], v[80:95]
  ds_read_b64_tr_b16 v[60:61], v11 offset:22528
  ds_read_b64_tr_b16 v[62:63], v11 offset:23040
  buffer_load_dwordx4 v9, s[8:11], s28 offen offset:3072 lds
  s_waitcnt lgkmcnt(4)
  v_mfma_f32_32x32x16_bf16 v[96:111], v[52:55], a[48:51], v[96:111]
  s_mov_b32 s62, 0
L_CHK2:
  v_min_u32 v191, v168, v169
  v_cmp_eq_u32 vcc, 0, v191
  s_cbranch_vccz L_OK2
  s_add_u32 s62, s62, 1
  s_cmp_lt_u32 s62, 0x40000
  s_cbranch_scc0 L_OK2
  s_sleep 2
  buffer_load_dwordx2 v[168:169], v190, s[16:19], 0 offen sc1
  s_waitcnt vmcnt(0)
  s_branch L_CHK2
L_OK2:
  v_readfirstlane_b32 s60, v168
  v_readfirstlane_b32 s61, v169
  s_nop 1
  v_mfma_f32_32x32x16_bf16 v[112:127], v[52:55], a[52:55], v[112:127]
  v_bitop3_b32 v162, v160, v161, s60 bitop3:0x96
  v_mov_b32 v163, s61
  s_waitcnt lgkmcnt(2)
  v_mfma_f32_32x32x16_bf16 v[64:79], v[56:59], a[56:59], v[64:79]
  s_waitcnt vmcnt(8) lgkmcnt(0)
  s_barrier
  ds_read_b64_tr_b16 v[48:49], v10 offset:32768
  ds_read_b64_tr_b16 v[50:51], v10 offset:33280
  buffer_store_dwordx4 v[160:163], v128, s[64:67], 0 offen offset:0 sc1
  v_mfma_f32_32x32x16_bf16 v[80:95], v[56:59], a[60:63], v[80:95]
  ds_read_b128 a[64:67], v20 offset:32768
  s_add_u32 m0, s27, 0
  s_lshl_b32 s28, s68, 7
  buffer_load_dwordx4 v2, s[4:7], s28 offen offset:0 lds
  v_mfma_f32_32x32x16_bf16 v[96:111], v[60:63], a[56:59], v[96:111]
  ds_read_b64_tr_b16 v[52:53], v11 offset:32768
  ds_read_b64_tr_b16 v[54:55], v11 offset:33280
  ds_read_b128 a[68:71], v20 offset:36864
  buffer_load_dwordx4 v3, s[4:7], s28 offen offset:1024 lds
  v_mfma_f32_32x32x16_bf16 v[112:127], v[60:63], a[60:63], v[112:127]
  v_bitop3_b32 v26, v24, v25, s60 bitop3:0x96
  v_mov_b32 v27, s61
  s_lshl_b32 s3, s37, 8
  s_add_u32 s3, s3, s57
  s_add_u32 s3, s3, 0
  s_mov_b64 exec, 0xffff
  buffer_store_dwordx4 v[24:27], v16, s[64:67], s3 offen sc1
  s_mov_b64 exec, -1
  s_waitcnt lgkmcnt(3)
  v_mfma_f32_32x32x16_bf16 v[64:79], v[48:51], a[64:67], v[64:79]
  ds_read_b64_tr_b16 v[56:57], v10 offset:34816
  ds_read_b64_tr_b16 v[58:59], v10 offset:35328
  ds_read_b128 a[72:75], v21 offset:32768
  buffer_load_dwordx4 v4, s[4:7], s28 offen offset:2048 lds
  s_add_u32 s68, s68, 1
  s_cmp_ge_u32 s68, 10
  s_cselect_b32 s3, 10, 0
  s_sub_u32 s68, s68, s3
  s_waitcnt lgkmcnt(3)
  v_mfma_f32_32x32x16_bf16 v[80:95], v[48:51], a[68:71], v[80:95]
  ds_read_b128 a[76:79], v21 offset:36864
  v_mfma_f32_32x32x16_bf16 v[96:111], v[52:55], a[64:67], v[96:111]
  ds_read_b64_tr_b16 v[60:61], v11 offset:34816
  ds_read_b64_tr_b16 v[62:63], v11 offset:35328
  ds_read_b128 a[80:83], v22 offset:32768
  buffer_load_dwordx4 v5, s[4:7], s28 offen offset:3072 lds
  v_mfma_f32_32x32x16_bf16 v[112:127], v[52:55], a[68:71], v[112:127]
  ds_read_b128 a[84:87], v22 offset:36864
  v_bitop3_b32 v30, v28, v29, s60 bitop3:0x96
  v_mov_b32 v31, s61
  s_lshl_b32 s3, s37, 8
  s_add_u32 s3, s3, s57
  s_add_u32 s3, s3, 2560
  s_mov_b64 exec, 0xffff
  buffer_store_dwordx4 v[28:31], v16, s[64:67], s3 offen sc1
  s_mov_b64 exec, -1
  s_waitcnt lgkmcnt(5)
  v_mfma_f32_32x32x16_bf16 v[64:79], v[56:59], a[72:75], v[64:79]
  ds_read_b64_tr_b16 v[48:49], v10 offset:36864
  ds_read_b64_tr_b16 v[50:51], v10 offset:37376
  ds_read_b128 a[88:91], v23 offset:32768
  s_add_u32 m0, s27, 65536
  s_mul_i32 s28, s69, 221184
  s_add_u32 s28, s28, s30
  buffer_load_dwordx4 v6, s[8:11], s28 offen offset:0 lds
  s_waitcnt lgkmcnt(7)
  v_mfma_f32_32x32x16_bf16 v[80:95], v[56:59], a[76:79], v[80:95]
  ds_read_b128 a[92:95], v23 offset:36864
  buffer_load_dwordx4 v7, s[8:11], s28 offen offset:1024 lds
  s_waitcnt lgkmcnt(6)
  v_mfma_f32_32x32x16_bf16 v[96:111], v[60:63], a[72:75], v[96:111]
  ds_read_b64_tr_b16 v[52:53], v11 offset:36864
  ds_read_b64_tr_b16 v[54:55], v11 offset:37376
  v_mfma_f32_32x32x16_bf16 v[112:127], v[60:63], a[76:79], v[112:127]
  buffer_load_dwordx4 v8, s[8:11], s28 offen offset:2048 lds
  s_add_u32 s69, s69, 1
  s_cmp_ge_u32 s69, 10
  s_cselect_b32 s3, 10, 0
  s_sub_u32 s69, s69, s3
  s_waitcnt lgkmcnt(4)
  v_mfma_f32_32x32x16_bf16 v[64:79], v[48:51], a[80:83], v[64:79]
  ds_read_b64_tr_b16 v[56:57], v10 offset:38912
  ds_read_b64_tr_b16 v[58:59], v10 offset:39424
  s_mov_b64 s[16:17], s[12:13]
  s_cmp_eq_u32 s26, 10
  s_cselect_b32 s18, 0, s14
  v_mfma_f32_32x32x16_bf16 v[80:95], v[48:51], a[84:87], v[80:95]
  ds_read_b64_tr_b16 v[60:61], v11 offset:38912
  ds_read_b64_tr_b16 v[62:63], v11 offset:39424
  buffer_load_dwordx4 v9, s[8:11], s28 offen offset:3072 lds
  s_waitcnt lgkmcnt(4)
  v_mfma_f32_32x32x16_bf16 v[96:111], v[52:55], a[80:83], v[96:111]
  v_mfma_f32_32x32x16_bf16 v[112:127], v[52:55], a[84:87], v[112:127]
  s_waitcnt lgkmcnt(2)
  v_mfma_f32_32x32x16_bf16 v[64:79], v[56:59], a[88:91], v[64:79]
  s_waitcnt vmcnt(11) lgkmcnt(0)
  s_barrier
  ds_read_b64_tr_b16 v[48:49], v10 offset:49152
  ds_read_b64_tr_b16 v[50:51], v10 offset:49664
  v_mfma_f32_32x32x16_bf16 v[80:95], v[56:59], a[92:95], v[80:95]
  ds_read_b128 a[96:99], v20 offset:49152
  s_add_u32 m0, s27, 16384
  s_lshl_b32 s28, s68, 7
  buffer_load_dwordx4 v2, s[4:7], s28 offen offset:0 lds
  v_mfma_f32_32x32x16_bf16 v[96:111], v[60:63], a[88:91], v[96:111]
  ds_read_b64_tr_b16 v[52:53], v11 offset:49152
  ds_read_b64_tr_b16 v[54:55], v11 offset:49664
  ds_read_b128 a[100:103], v20 offset:53248
  buffer_load_dwordx4 v3, s[4:7], s28 offen offset:1024 lds
  v_mfma_f32_32x32x16_bf16 v[112:127], v[60:63], a[92:95], v[112:127]
  buffer_load_dwordx4 v4, s[4:7], s28 offen offset:2048 lds
  s_add_u32 s68, s68, 1
  s_cmp_ge_u32 s68, 10
  s_cselect_b32 s3, 10, 0
  s_sub_u32 s68, s68, s3
  s_waitcnt lgkmcnt(3)
  v_mfma_f32_32x32x16_bf16 v[64:79], v[48:51], a[96:99], v[64:79]
  ds_read_b64_tr_b16 v[56:57], v10 offset:51200
  ds_read_b64_tr_b16 v[58:59], v10 offset:51712
  ds_read_b128 a[104:107], v21 offset:49152
  buffer_load_dwordx4 v5, s[4:7], s28 offen offset:3072 lds
  s_waitcnt lgkmcnt(3)
  v_mfma_f32_32x32x16_bf16 v[80:95], v[48:51], a[100:103], v[80:95]
  ds_read_b128 a[108:111], v21 offset:53248
  s_add_u32 m0, s27, 81920
  s_mul_i32 s28, s69, 221184
  s_add_u32 s28, s28, s30
  buffer_load_dwordx4 v6, s[8:11], s28 offen offset:0 lds
  v_mfma_f32_32x32x16_bf16 v[96:111], v[52:55], a[96:99], v[96:111]
  ds_read_b64_tr_b16 v[60:61], v11 offset:51200
  ds_read_b64_tr_b16 v[62:63], v11 offset:51712
  ds_read_b128 a[112:115], v22 offset:49152
  v_mfma_f32_32x32x16_bf16 v[112:127], v[52:55], a[100:103], v[112:127]
  ds_read_b128 a[116:119], v22 offset:53248
  buffer_load_dwordx4 v7, s[8:11], s28 offen offset:1024 lds
  s_waitcnt lgkmcnt(5)
  v_mfma_f32_32x32x16_bf16 v[64:79], v[56:59], a[104:107], v[64:79]
  ds_read_b64_tr_b16 v[48:49], v10 offset:53248
  ds_read_b64_tr_b16 v[50:51], v10 offset:53760
  ds_read_b128 a[120:123], v23 offset:49152
  buffer_load_dwordx4 v8, s[8:11], s28 offen offset:2048 lds
  s_add_u32 s69, s69, 1
  s_cmp_ge_u32 s69, 10
  s_cselect_b32 s3, 10, 0
  s_sub_u32 s69, s69, s3
  s_waitcnt lgkmcnt(7)
  v_mfma_f32_32x32x16_bf16 v[80:95], v[56:59], a[108:111], v[80:95]
  ds_read_b128 a[124:127], v23 offset:53248
  buffer_load_dwordx4 v9, s[8:11], s28 offen offset:3072 lds
  s_waitcnt lgkmcnt(6)
  v_mfma_f32_32x32x16_bf16 v[96:111], v[60:63], a[104:107], v[96:111]
  ds_read_b64_tr_b16 v[52:53], v11 offset:53248
  ds_read_b64_tr_b16 v[54:55], v11 offset:53760
  s_add_u32 m0, s27, 131072
  s_mov_b32 s28, s46
  buffer_load_dwordx4 v180, s[40:43], s28 offen offset:0 lds
  v_mfma_f32_32x32x16_bf16 v[112:127], v[60:63], a[108:111], v[112:127]
  buffer_load_dwordx4 v181, s[40:43], s28 offen offset:1024 lds
  s_waitcnt lgkmcnt(4)
  v_mfma_f32_32x32x16_bf16 v[64:79], v[48:51], a[112:115], v[64:79]
  ds_read_b64_tr_b16 v[56:57], v10 offset:55296
  ds_read_b64_tr_b16 v[58:59], v10 offset:55808
  v_mfma_f32_32x32x16_bf16 v[80:95], v[48:51], a[116:119], v[80:95]
  ds_read_b64_tr_b16 v[60:61], v11 offset:55296
  ds_read_b64_tr_b16 v[62:63], v11 offset:55808
  buffer_load_dwordx4 v182, s[40:43], s28 offen offset:2048 lds
  s_waitcnt lgkmcnt(4)
  v_mfma_f32_32x32x16_bf16 v[96:111], v[52:55], a[112:115], v[96:111]
  buffer_load_dwordx4 v183, s[40:43], s28 offen offset:3072 lds
  v_mfma_f32_32x32x16_bf16 v[112:127], v[52:55], a[116:119], v[112:127]
  s_waitcnt lgkmcnt(2)
  v_mfma_f32_32x32x16_bf16 v[64:79], v[56:59], a[120:123], v[64:79]
  s_waitcnt vmcnt(12) lgkmcnt(0)
  s_barrier
  ds_read_b64_tr_b16 v[48:49], v10 offset:0
  ds_read_b64_tr_b16 v[50:51], v10 offset:512
  v_mfma_f32_32x32x16_bf16 v[80:95], v[56:59], a[124:127], v[80:95]
  ds_read_b128 a[128:131], v20 offset:0
  s_add_u32 m0, s27, 32768
  s_lshl_b32 s28, s68, 7
  buffer_load_dwordx4 v2, s[4:7], s28 offen offset:0 lds
  v_mfma_f32_32x32x16_bf16 v[96:111], v[60:63], a[120:123], v[96:111]
  ds_read_b64_tr_b16 v[52:53], v11 offset:0
  ds_read_b64_tr_b16 v[54:55], v11 offset:512
  ds_read_b128 a[132:135], v20 offset:4096
  buffer_load_dwordx4 v3, s[4:7], s28 offen offset:1024 lds
  v_mfma_f32_32x32x16_bf16 v[112:127], v[60:63], a[124:127], v[112:127]
  s_waitcnt lgkmcnt(3)
  v_mfma_f32_32x32x16_bf16 v[64:79], v[48:51], a[128:131], v[64:79]
  ds_read_b64_tr_b16 v[56:57], v10 offset:2048
  ds_read_b64_tr_b16 v[58:59], v10 offset:2560
  ds_read_b128 a[136:139], v21 offset:0
  buffer_load_dwordx4 v4, s[4:7], s28 offen offset:2048 lds
  s_add_u32 s68, s68, 1
  s_cmp_ge_u32 s68, 10
  s_cselect_b32 s3, 10, 0
  s_sub_u32 s68, s68, s3
  s_waitcnt lgkmcnt(3)
  v_mfma_f32_32x32x16_bf16 v[80:95], v[48:51], a[132:135], v[80:95]
  ds_read_b128 a[140:143], v21 offset:4096
  v_mfma_f32_32x32x16_bf16 v[96:111], v[52:55], a[128:131], v[96:111]
  ds_read_b64_tr_b16 v[60:61], v11 offset:2048
  ds_read_b64_tr_b16 v[62:63], v11 offset:2560
  ds_read_b128 a[144:147], v22 offset:0
  buffer_load_dwordx4 v5, s[4:7], s28 offen offset:3072 lds
  v_mfma_f32_32x32x16_bf16 v[112:127], v[52:55], a[132:135], v[112:127]
  ds_read_b128 a[148:151], v22 offset:4096
  s_waitcnt lgkmcnt(5)
  v_mfma_f32_32x32x16_bf16 v[64:79], v[56:59], a[136:139], v[64:79]
  ds_read_b64_tr_b16 v[48:49], v10 offset:4096
  ds_read_b64_tr_b16 v[50:51], v10 offset:4608
  ds_read_b128 a[152:155], v23 offset:0
  s_add_u32 m0, s27, 98304
  s_mul_i32 s28, s69, 221184
  s_add_u32 s28, s28, s30
  buffer_load_dwordx4 v6, s[8:11], s28 offen offset:0 lds
  s_waitcnt lgkmcnt(7)
  v_mfma_f32_32x32x16_bf16 v[80:95], v[56:59], a[140:143], v[80:95]
  ds_read_b128 a[156:159], v23 offset:4096
  buffer_load_dwordx4 v7, s[8:11], s28 offen offset:1024 lds
  s_waitcnt lgkmcnt(6)
  v_mfma_f32_32x32x16_bf16 v[96:111], v[60:63], a[136:139], v[96:111]
  ds_read_b64_tr_b16 v[52:53], v11 offset:4096
  ds_read_b64_tr_b16 v[54:55], v11 offset:4608
  v_mfma_f32_32x32x16_bf16 v[112:127], v[60:63], a[140:143], v[112:127]
  buffer_load_dwordx4 v8, s[8:11], s28 offen offset:2048 lds
  s_add_u32 s69, s69, 1
  s_cmp_ge_u32 s69, 10
  s_cselect_b32 s3, 10, 0
  s_sub_u32 s69, s69, s3
  s_waitcnt lgkmcnt(4)
  v_mfma_f32_32x32x16_bf16 v[64:79], v[48:51], a[144:147], v[64:79]
  ds_read_b64_tr_b16 v[56:57], v10 offset:6144
  ds_read_b64_tr_b16 v[58:59], v10 offset:6656
  v_mfma_f32_32x32x16_bf16 v[80:95], v[48:51], a[148:151], v[80:95]
  ds_read_b64_tr_b16 v[60:61], v11 offset:6144
  ds_read_b64_tr_b16 v[62:63], v11 offset:6656
  buffer_load_dwordx4 v9, s[8:11], s28 offen offset:3072 lds
  s_waitcnt lgkmcnt(4)
  v_mfma_f32_32x32x16_bf16 v[96:111], v[52:55], a[144:147], v[96:111]
  v_mfma_f32_32x32x16_bf16 v[112:127], v[52:55], a[148:151], v[112:127]
  s_waitcnt lgkmcnt(2)
  v_mfma_f32_32x32x16_bf16 v[64:79], v[56:59], a[152:155], v[64:79]
  s_waitcnt vmcnt(12) lgkmcnt(0)
  s_barrier
  ds_read_b64_tr_b16 v[48:49], v10 offset:16384
  ds_read_b64_tr_b16 v[50:51], v10 offset:16896
  v_mfma_f32_32x32x16_bf16 v[80:95], v[56:59], a[156:159], v[80:95]
  ds_read_b128 a[160:163], v20 offset:16384
  s_add_u32 m0, s27, 49152
  s_lshl_b32 s28, s68, 7
  buffer_load_dwordx4 v2, s[4:7], s28 offen offset:0 lds
  v_mfma_f32_32x32x16_bf16 v[96:111], v[60:63], a[152:155], v[96:111]
  ds_read_b64_tr_b16 v[52:53], v11 offset:16384
  ds_read_b64_tr_b16 v[54:55], v11 offset:16896
  ds_read_b128 a[164:167], v20 offset:20480
  buffer_load_dwordx4 v3, s[4:7], s28 offen offset:1024 lds
  v_mfma_f32_32x32x16_bf16 v[112:127], v[60:63], a[156:159], v[112:127]
  s_waitcnt vmcnt(10)
  ds_read_b64_tr_b16 v[128:129], v184 offset:0
  ds_read_b64_tr_b16 v[130:131], v184 offset:512
  ds_read_b64_tr_b16 v[132:133], v185 offset:0
  ds_read_b64_tr_b16 v[134:135], v185 offset:512
  s_waitcnt lgkmcnt(7)
  v_mfma_f32_32x32x16_bf16 v[64:79], v[48:51], a[160:163], v[64:79]
  ds_read_b64_tr_b16 v[56:57], v10 offset:18432
  ds_read_b64_tr_b16 v[58:59], v10 offset:18944
  ds_read_b128 a[168:171], v21 offset:16384
  buffer_load_dwordx4 v4, s[4:7], s28 offen offset:2048 lds
  s_add_u32 s68, s68, 1
  s_cmp_ge_u32 s68, 10
  s_cselect_b32 s3, 10, 0
  s_sub_u32 s68, s68, s3
  s_waitcnt lgkmcnt(7)
  v_mfma_f32_32x32x16_bf16 v[80:95], v[48:51], a[164:167], v[80:95]
  ds_read_b128 a[172:175], v21 offset:20480
  ds_read_b64_tr_b16 v[136:137], v186 offset:0
  ds_read_b64_tr_b16 v[138:139], v186 offset:512
  v_mfma_f32_32x32x16_bf16 v[96:111], v[52:55], a[160:163], v[96:111]
  ds_read_b64_tr_b16 v[60:61], v11 offset:18432
  ds_read_b64_tr_b16 v[62:63], v11 offset:18944
  ds_read_b128 a[176:179], v22 offset:16384
  buffer_load_dwordx4 v5, s[4:7], s28 offen offset:3072 lds
  v_mfma_f32_32x32x16_bf16 v[112:127], v[52:55], a[164:167], v[112:127]
  ds_read_b128 a[180:183], v22 offset:20480
  ds_read_b64_tr_b16 v[140:141], v188 offset:0
  ds_read_b64_tr_b16 v[142:143], v188 offset:512
  s_mul_hi_u32 s3, s53, 0x33333334
  s_mul_i32 s54, s3, 476160
  s_lshl_b32 s3, s53, 10
  s_add_u32 s54, s54, s3
  s_mul_i32 s3, s47, 5120
  s_add_u32 s54, s54, s3
  s_add_u32 s53, s53, 1
  s_waitcnt lgkmcnt(14)
  buffer_store_dwordx4 v[128:131], v16, s[20:23], s54 offen sc1
  s_waitcnt lgkmcnt(9)
  v_mfma_f32_32x32x16_bf16 v[64:79], v[56:59], a[168:171], v[64:79]
  ds_read_b64_tr_b16 v[48:49], v10 offset:20480
  ds_read_b64_tr_b16 v[50:51], v10 offset:20992
  ds_read_b128 a[184:187], v23 offset:16384
  s_add_u32 m0, s27, 114688
  s_mul_i32 s28, s69, 221184
  s_add_u32 s28, s28, s30
  buffer_load_dwordx4 v6, s[8:11], s28 offen offset:0 lds
  s_waitcnt lgkmcnt(11)
  v_mfma_f32_32x32x16_bf16 v[80:95], v[56:59], a[172:175], v[80:95]
  ds_read_b128 a[188:191], v23 offset:20480
  buffer_load_dwordx4 v7, s[8:11], s28 offen offset:1024 lds
  s_waitcnt lgkmcnt(8)
  v_mfma_f32_32x32x16_bf16 v[96:111], v[60:63], a[168:171], v[96:111]
  ds_read_b64_tr_b16 v[52:53], v11 offset:20480
  ds_read_b64_tr_b16 v[54:55], v11 offset:20992
  v_mfma_f32_32x32x16_bf16 v[112:127], v[60:63], a[172:175], v[112:127]
  buffer_load_dwordx4 v8, s[8:11], s28 offen offset:2048 lds
  s_add_u32 s69, s69, 1
  s_cmp_ge_u32 s69, 10
  s_cselect_b32 s3, 10, 0
  s_sub_u32 s69, s69, s3
  s_waitcnt lgkmcnt(4)
  v_mfma_f32_32x32x16_bf16 v[64:79], v[48:51], a[176:179], v[64:79]
  ds_read_b64_tr_b16 v[56:57], v10 offset:22528
  ds_read_b64_tr_b16 v[58:59], v10 offset:23040
  s_mul_hi_u32 s3, s53, 0x33333334
  s_mul_i32 s54, s3, 476160
  s_lshl_b32 s3, s53, 10
  s_add_u32 s54, s54, s3
  s_mul_i32 s3, s47, 5120
  s_add_u32 s54, s54, s3
  s_add_u32 s53, s53, 1
  buffer_store_dwordx4 v[132:135], v16, s[20:23], s54 offen sc1
  v_mfma_f32_32x32x16_bf16 v[80:95], v[48:51], a[180:183], v[80:95]
  ds_read_b64_tr_b16 v[60:61], v11 offset:22528
  ds_read_b64_tr_b16 v[62:63], v11 offset:23040
  buffer_load_dwordx4 v9, s[8:11], s28 offen offset:3072 lds
  s_waitcnt lgkmcnt(4)
  v_mfma_f32_32x32x16_bf16 v[96:111], v[52:55], a[176:179], v[96:111]
  v_mfma_f32_32x32x16_bf16 v[112:127], v[52:55], a[180:183], v[112:127]
  s_waitcnt lgkmcnt(2)
  v_mfma_f32_32x32x16_bf16 v[64:79], v[56:59], a[184:187], v[64:79]
  s_waitcnt vmcnt(10) lgkmcnt(0)
  s_barrier
  ds_read_b64_tr_b16 v[48:49], v10 offset:32768
  ds_read_b64_tr_b16 v[50:51], v10 offset:33280
  v_mfma_f32_32x32x16_bf16 v[80:95], v[56:59], a[188:191], v[80:95]
  ds_read_b128 a[192:195], v20 offset:32768
  s_add_u32 m0, s27, 0
  s_lshl_b32 s28, s68, 7
  buffer_load_dwordx4 v2, s[4:7], s28 offen offset:0 lds
  v_mfma_f32_32x32x16_bf16 v[96:111], v[60:63], a[184:187], v[96:111]
  ds_read_b64_tr_b16 v[52:53], v11 offset:32768
  ds_read_b64_tr_b16 v[54:55], v11 offset:33280
  ds_read_b128 a[196:199], v20 offset:36864
  buffer_load_dwordx4 v3, s[4:7], s28 offen offset:1024 lds
  v_mfma_f32_32x32x16_bf16 v[112:127], v[60:63], a[188:191], v[112:127]
  s_mul_hi_u32 s3, s53, 0x33333334
  s_mul_i32 s54, s3, 476160
  s_lshl_b32 s3, s53, 10
  s_add_u32 s54, s54, s3
  s_mul_i32 s3, s47, 5120
  s_add_u32 s54, s54, s3
  s_add_u32 s53, s53, 1
  buffer_store_dwordx4 v[136:139], v16, s[20:23], s54 offen sc1
  s_waitcnt lgkmcnt(3)
  v_mfma_f32_32x32x16_bf16 v[64:79], v[48:51], a[192:195], v[64:79]
  ds_read_b64_tr_b16 v[56:57], v10 offset:34816
  ds_read_b64_tr_b16 v[58:59], v10 offset:35328
  ds_read_b128 a[200:203], v21 offset:32768
  buffer_load_dwordx4 v4, s[4:7], s28 offen offset:2048 lds
  s_add_u32 s68, s68, 1
  s_cmp_ge_u32 s68, 10
  s_cselect_b32 s3, 10, 0
  s_sub_u32 s68, s68, s3
  s_waitcnt lgkmcnt(3)
  v_mfma_f32_32x32x16_bf16 v[80:95], v[48:51], a[196:199], v[80:95]
  ds_read_b128 a[204:207], v21 offset:36864
  v_mfma_f32_32x32x16_bf16 v[96:111], v[52:55], a[192:195], v[96:111]
  ds_read_b64_tr_b16 v[60:61], v11 offset:34816
  ds_read_b64_tr_b16 v[62:63], v11 offset:35328
  ds_read_b128 a[208:211], v22 offset:32768
  buffer_load_dwordx4 v5, s[4:7], s28 offen offset:3072 lds
  v_mfma_f32_32x32x16_bf16 v[112:127], v[52:55], a[196:199], v[112:127]
  ds_read_b128 a[212:215], v22 offset:36864
  s_waitcnt lgkmcnt(5)
  v_mfma_f32_32x32x16_bf16 v[64:79], v[56:59], a[200:203], v[64:79]
  ds_read_b64_tr_b16 v[48:49], v10 offset:36864
  ds_read_b64_tr_b16 v[50:51], v10 offset:37376
  ds_read_b128 a[216:219], v23 offset:32768
  s_add_u32 m0, s27, 65536
  s_mul_i32 s28, s69, 221184
  s_add_u32 s28, s28, s30
  buffer_load_dwordx4 v6, s[8:11], s28 offen offset:0 lds
  s_waitcnt lgkmcnt(7)
  v_mfma_f32_32x32x16_bf16 v[80:95], v[56:59], a[204:207], v[80:95]
  ds_read_b128 a[220:223], v23 offset:36864
  buffer_load_dwordx4 v7, s[8:11], s28 offen offset:1024 lds
  s_waitcnt lgkmcnt(6)
  v_mfma_f32_32x32x16_bf16 v[96:111], v[60:63], a[200:203], v[96:111]
  ds_read_b64_tr_b16 v[52:53], v11 offset:36864
  ds_read_b64_tr_b16 v[54:55], v11 offset:37376
  s_mul_hi_u32 s3, s53, 0x33333334
  s_mul_i32 s54, s3, 476160
  s_lshl_b32 s3, s53, 10
  s_add_u32 s54, s54, s3
  s_mul_i32 s3, s47, 5120
  s_add_u32 s54, s54, s3
  s_add_u32 s53, s53, 1
  buffer_store_dwordx4 v[140:143], v16, s[20:23], s54 offen sc1
  v_mfma_f32_32x32x16_bf16 v[112:127], v[60:63], a[204:207], v[112:127]
  buffer_load_dwordx4 v8, s[8:11], s28 offen offset:2048 lds
  s_add_u32 s69, s69, 1
  s_cmp_ge_u32 s69, 10
  s_cselect_b32 s3, 10, 0
  s_sub_u32 s69, s69, s3
  s_waitcnt lgkmcnt(4)
  v_mfma_f32_32x32x16_bf16 v[64:79], v[48:51], a[208:211], v[64:79]
  ds_read_b64_tr_b16 v[56:57], v10 offset:38912
  ds_read_b64_tr_b16 v[58:59], v10 offset:39424
  s_add_u32 s54, s57, 0
  s_mul_i32 s3, s34, 2560
  s_add_u32 s54, s54, s3
  buffer_load_dwordx4 v[144:147], v16, s[64:67], s54 offen offset:0 sc1
  v_mfma_f32_32x32x16_bf16 v[80:95], v[48:51], a[212:215], v[80:95]
  ds_read_b64_tr_b16 v[60:61], v11 offset:38912
  ds_read_b64_tr_b16 v[62:63], v11 offset:39424
  buffer_load_dwordx4 v9, s[8:11], s28 offen offset:3072 lds
  s_waitcnt lgkmcnt(4)
  v_mfma_f32_32x32x16_bf16 v[96:111], v[52:55], a[208:211], v[96:111]
  s_add_u32 s54, s57, 0
  s_mul_i32 s3, s34, 2560
  s_add_u32 s54, s54, s3
  buffer_load_dwordx4 v[148:151], v16, s[64:67], s54 offen offset:1024 sc1
  v_mfma_f32_32x32x16_bf16 v[112:127], v[52:55], a[212:215], v[112:127]
  s_add_u32 s54, s57, 0
  s_mul_i32 s3, s34, 2560
  s_add_u32 s54, s54, s3
  buffer_load_dwordx4 v[152:155], v17, s[64:67], s54 offen offset:0 sc1
  s_waitcnt lgkmcnt(2)
  v_mfma_f32_32x32x16_bf16 v[64:79], v[56:59], a[216:219], v[64:79]
  s_waitcnt vmcnt(13) lgkmcnt(0)
  s_barrier
  ds_read_b64_tr_b16 v[48:49], v10 offset:49152
  ds_read_b64_tr_b16 v[50:51], v10 offset:49664
  v_mfma_f32_32x32x16_bf16 v[80:95], v[56:59], a[220:223], v[80:95]
  ds_read_b128 a[224:227], v20 offset:49152
  s_add_u32 m0, s27, 16384
  s_lshl_b32 s28, s68, 7
  buffer_load_dwordx4 v2, s[4:7], s28 offen offset:0 lds
  v_mfma_f32_32x32x16_bf16 v[96:111], v[60:63], a[216:219], v[96:111]
  ds_read_b64_tr_b16 v[52:53], v11 offset:49152
  ds_read_b64_tr_b16 v[54:55], v11 offset:49664
  ds_read_b128 a[228:231], v20 offset:53248
  buffer_load_dwordx4 v3, s[4:7], s28 offen offset:1024 lds
  v_mfma_f32_32x32x16_bf16 v[112:127], v[60:63], a[220:223], v[112:127]
  s_waitcnt lgkmcnt(3)
  v_mfma_f32_32x32x16_bf16 v[64:79], v[48:51], a[224:227], v[64:79]
  ds_read_b64_tr_b16 v[56:57], v10 offset:51200
  ds_read_b64_tr_b16 v[58:59], v10 offset:51712
  ds_read_b128 a[232:235], v21 offset:49152
  buffer_load_dwordx4 v4, s[4:7], s28 offen offset:2048 lds
  s_add_u32 s68, s68, 1
  s_cmp_ge_u32 s68, 10
  s_cselect_b32 s3, 10, 0
  s_sub_u32 s68, s68, s3
  s_waitcnt lgkmcnt(3)
  v_mfma_f32_32x32x16_bf16 v[80:95], v[48:51], a[228:231], v[80:95]
  ds_read_b128 a[236:239], v21 offset:53248
  v_mfma_f32_32x32x16_bf16 v[96:111], v[52:55], a[224:227], v[96:111]
  ds_read_b64_tr_b16 v[60:61], v11 offset:51200
  ds_read_b64_tr_b16 v[62:63], v11 offset:51712
  ds_read_b128 a[240:243], v22 offset:49152
  buffer_load_dwordx4 v5, s[4:7], s28 offen offset:3072 lds
  v_mfma_f32_32x32x16_bf16 v[112:127], v[52:55], a[228:231], v[112:127]
  ds_read_b128 a[244:247], v22 offset:53248
  s_waitcnt lgkmcnt(5)
  v_mfma_f32_32x32x16_bf16 v[64:79], v[56:59], a[232:235], v[64:79]
  ds_read_b64_tr_b16 v[48:49], v10 offset:53248
  ds_read_b64_tr_b16 v[50:51], v10 offset:53760
  ds_read_b128 a[248:251], v23 offset:49152
  s_add_u32 m0, s27, 81920
  s_mul_i32 s28, s69, 221184
  s_add_u32 s28, s28, s30
  buffer_load_dwordx4 v6, s[8:11], s28 offen offset:0 lds
  s_waitcnt lgkmcnt(7)
  v_mfma_f32_32x32x16_bf16 v[80:95], v[56:59], a[236:239], v[80:95]
  ds_read_b128 a[252:255], v23 offset:53248
  buffer_load_dwordx4 v7, s[8:11], s28 offen offset:1024 lds
  s_waitcnt lgkmcnt(6)
  v_mfma_f32_32x32x16_bf16 v[96:111], v[60:63], a[232:235], v[96:111]
  ds_read_b64_tr_b16 v[52:53], v11 offset:53248
  ds_read_b64_tr_b16 v[54:55], v11 offset:53760
  s_mov_b32 s54, 65536
  buffer_load_dwordx4 v[170:173], v189, s[64:67], s54 offen sc1
  buffer_load_dwordx4 v[174:177], v189, s[64:67], s54 offen offset:512 sc1
  v_mfma_f32_32x32x16_bf16 v[112:127], v[60:63], a[236:239], v[112:127]
  buffer_load_dwordx4 v8, s[8:11], s28 offen offset:2048 lds
  s_add_u32 s69, s69, 1
  s_cmp_ge_u32 s69, 10
  s_cselect_b32 s3, 10, 0
  s_sub_u32 s69, s69, s3
  s_waitcnt lgkmcnt(4)
  v_mfma_f32_32x32x16_bf16 v[64:79], v[48:51], a[240:243], v[64:79]
  ds_read_b64_tr_b16 v[56:57], v10 offset:55296
  ds_read_b64_tr_b16 v[58:59], v10 offset:55808
  v_mfma_f32_32x32x16_bf16 v[80:95], v[48:51], a[244:247], v[80:95]
  ds_read_b64_tr_b16 v[60:61], v11 offset:55296
  ds_read_b64_tr_b16 v[62:63], v11 offset:55808
  buffer_load_dwordx4 v9, s[8:11], s28 offen offset:3072 lds
  s_waitcnt lgkmcnt(4)
  v_mfma_f32_32x32x16_bf16 v[96:111], v[52:55], a[240:243], v[96:111]
  v_mfma_f32_32x32x16_bf16 v[112:127], v[52:55], a[244:247], v[112:127]
  s_waitcnt lgkmcnt(2)
  v_mfma_f32_32x32x16_bf16 v[64:79], v[56:59], a[248:251], v[64:79]
  s_waitcnt vmcnt(12) lgkmcnt(0)
  s_barrier
  ds_read_b64_tr_b16 v[48:49], v10 offset:0
  ds_read_b64_tr_b16 v[50:51], v10 offset:512
  s_mul_i32 s3, s25, 11
  s_add_u32 s3, s3, s26
  s_lshl_b32 s3, s3, 2
  s_add_u32 s54, s3, 4416
  s_cmp_eq_u32 s24, 0
  s_cselect_b32 s54, s54, 1073741824
  v_mov_b32 v128, s60
  v_mul_u32_u24 v129, 0, v1
  s_mov_b64 exec, 1
  buffer_store_dword v128, v129, s[64:67], s54 offen sc1
  s_mov_b64 exec, -1
  v_mfma_f32_32x32x16_bf16 v[80:95], v[56:59], a[252:255], v[80:95]
  ds_read_b128 v[192:195], v20 offset:0
  s_add_u32 m0, s27, 98304
  s_mul_i32 s28, s69, 221184
  s_add_u32 s28, s28, s31
  buffer_load_dwordx4 v6, s[8:11], s28 offen offset:0 lds
  v_mfma_f32_32x32x16_bf16 v[96:111], v[60:63], a[248:251], v[96:111]
  ds_read_b64_tr_b16 v[52:53], v11 offset:0
  ds_read_b64_tr_b16 v[54:55], v11 offset:512
  ds_read_b128 v[196:199], v20 offset:4096
  buffer_load_dwordx4 v7, s[8:11], s28 offen offset:1024 lds
  v_mfma_f32_32x32x16_bf16 v[112:127], v[60:63], a[252:255], v[112:127]
  s_waitcnt lgkmcnt(3)
  v_mfma_f32_32x32x16_bf16 v[64:79], v[48:51], v[192:195], v[64:79]
  ds_read_b64_tr_b16 v[56:57], v10 offset:2048
  ds_read_b64_tr_b16 v[58:59], v10 offset:2560
  ds_read_b128 v[200:203], v21 offset:0
  buffer_load_dwordx4 v8, s[8:11], s28 offen offset:2048 lds
  s_add_u32 s69, s69, 1
  s_cmp_ge_u32 s69, 10
  s_cselect_b32 s3, 10, 0
  s_sub_u32 s69, s69, s3
  s_waitcnt lgkmcnt(3)
  v_mfma_f32_32x32x16_bf16 v[80:95], v[48:51], v[196:199], v[80:95]
  ds_read_b128 v[204:207], v21 offset:4096
  v_mfma_f32_32x32x16_bf16 v[96:111], v[52:55], v[192:195], v[96:111]
  ds_read_b64_tr_b16 v[60:61], v11 offset:2048
  ds_read_b64_tr_b16 v[62:63], v11 offset:2560
  ds_read_b128 v[208:211], v22 offset:0
  buffer_load_dwordx4 v9, s[8:11], s28 offen offset:3072 lds
  v_mfma_f32_32x32x16_bf16 v[112:127], v[52:55], v[196:199], v[112:127]
  ds_read_b128 v[212:215], v22 offset:4096
  v_add_u32 v2, 0, v178
  v_add_u32 v3, 54272, v178
  v_add_u32 v4, 108544, v178
  s_waitcnt lgkmcnt(5)
  v_mfma_f32_32x32x16_bf16 v[64:79], v[56:59], v[200:203], v[64:79]
  ds_read_b64_tr_b16 v[48:49], v10 offset:4096
  ds_read_b64_tr_b16 v[50:51], v10 offset:4608
  ds_read_b128 v[216:219], v23 offset:0
  s_add_u32 m0, s27, 114688
  s_mul_i32 s28, s69, 221184
  s_add_u32 s28, s28, s31
  buffer_load_dwordx4 v6, s[8:11], s28 offen offset:0 lds
  s_waitcnt lgkmcnt(7)
  v_mfma_f32_32x32x16_bf16 v[80:95], v[56:59], v[204:207], v[80:95]
  ds_read_b128 v[220:223], v23 offset:4096
  buffer_load_dwordx4 v7, s[8:11], s28 offen offset:1024 lds
  s_waitcnt lgkmcnt(6)
  v_mfma_f32_32x32x16_bf16 v[96:111], v[60:63], v[200:203], v[96:111]
  ds_read_b64_tr_b16 v[52:53], v11 offset:4096
  ds_read_b64_tr_b16 v[54:55], v11 offset:4608
  v_add_u32 v5, 162816, v178
  s_waitcnt vmcnt(17)
  s_mov_b32 s62, 0
L_CHK3:
  v_bitop3_b32 v146, v144, v145, v146 bitop3:0x96
  v_bitop3_b32 v150, v148, v149, v150 bitop3:0x96
  v_bitop3_b32 v154, v152, v153, v154 bitop3:0x96
  v_cmp_ne_u64 s[54:55], s[60:61], v[146:147]
  v_cmp_ne_u64 vcc, s[60:61], v[150:151]
  s_or_b64 s[54:55], s[54:55], vcc
  v_cmp_ne_u64 vcc, s[60:61], v[154:155]
  s_or_b64 vcc, s[54:55], vcc
  s_cbranch_vccz L_OK3
  s_add_u32 s62, s62, 1
  s_cmp_lt_u32 s62, 0x40000
  s_cbranch_scc0 L_OK3
  s_sleep 2
  s_add_u32 s54, s57, 0
  s_mul_i32 s3, s34, 2560
  s_add_u32 s54, s54, s3
  buffer_load_dwordx4 v[144:147], v16, s[64:67], s54 offen offset:0 sc1
  s_add_u32 s54, s57, 0
  s_mul_i32 s3, s34, 2560
  s_add_u32 s54, s54, s3
  buffer_load_dwordx4 v[148:151], v16, s[64:67], s54 offen offset:1024 sc1
  s_add_u32 s54, s57, 0
  s_mul_i32 s3, s34, 2560
  s_add_u32 s54, s54, s3
  buffer_load_dwordx4 v[152:155], v17, s[64:67], s54 offen offset:0 sc1
  s_waitcnt vmcnt(0)
  s_branch L_CHK3
L_OK3:
  v_mfma_f32_32x32x16_bf16 v[112:127], v[60:63], v[204:207], v[112:127]
  buffer_load_dwordx4 v8, s[8:11], s28 offen offset:2048 lds
  s_add_u32 s69, s69, 1
  s_cmp_ge_u32 s69, 10
  s_cselect_b32 s3, 10, 0
  s_sub_u32 s69, s69, s3
  s_waitcnt lgkmcnt(4)
  v_mfma_f32_32x32x16_bf16 v[64:79], v[48:51], v[208:211], v[64:79]
  ds_read_b64_tr_b16 v[56:57], v10 offset:6144
  ds_read_b64_tr_b16 v[58:59], v10 offset:6656
  v_mfma_f32_32x32x16_bf16 v[80:95], v[48:51], v[212:215], v[80:95]
  ds_read_b64_tr_b16 v[60:61], v11 offset:6144
  ds_read_b64_tr_b16 v[62:63], v11 offset:6656
  buffer_load_dwordx4 v9, s[8:11], s28 offen offset:3072 lds
  v_add_f32 v144, v144, v148
  s_waitcnt lgkmcnt(4)
  v_mfma_f32_32x32x16_bf16 v[96:111], v[52:55], v[208:211], v[96:111]
  v_add_f32 v145, v145, v149
  v_fmac_f32 v144, v152, v15
  v_fmac_f32 v145, v153, v15
  v_mov_b32 v41, 0
  v_mov_b32 v43, 0
  v_mfma_f32_32x32x16_bf16 v[112:127], v[52:55], v[212:215], v[112:127]
  v_permlane16_swap_b32 v144, v145
  v_add_f32 v144, v144, v145
  v_mov_b32 v145, v144
  v_lshrrev_b32 v146, 2, v16
  s_nop 0
  s_waitcnt lgkmcnt(2)
  v_mfma_f32_32x32x16_bf16 v[64:79], v[56:59], v[216:219], v[64:79]
  s_waitcnt vmcnt(9) lgkmcnt(0)
  s_barrier
  ds_read_b64_tr_b16 v[48:49], v10 offset:16384
  ds_read_b64_tr_b16 v[50:51], v10 offset:16896
  v_permlane32_swap_b32 v144, v145
  v_mfma_f32_32x32x16_bf16 v[80:95], v[56:59], v[220:223], v[80:95]
  ds_read_b128 v[224:227], v20 offset:16384
  s_add_u32 m0, s27, 65536
  s_mul_i32 s28, s69, 221184
  s_add_u32 s28, s28, s31
  buffer_load_dwordx4 v6, s[8:11], s28 offen offset:0 lds
  v_mfma_f32_32x32x16_bf16 v[96:111], v[60:63], v[216:219], v[96:111]
  ds_read_b64_tr_b16 v[52:53], v11 offset:16384
  ds_read_b64_tr_b16 v[54:55], v11 offset:16896
  ds_read_b128 v[228:231], v20 offset:20480
  v_add_f32 v144, v144, v145
  v_cvt_pk_bf16_f32 v145, v144, v144
  v_mfma_f32_32x32x16_bf16 v[112:127], v[60:63], v[220:223], v[112:127]
  v_and_b32 v145, 0xffff0000, v145
  v_sub_f32 v144, v144, v145
  v_cvt_pk_bf16_f32 v144, v145, v144
  v_cndmask_b32 v144, v144, 0, s[58:59]
  s_lshl_b32 s3, s35, 9
  s_add_u32 s3, s3, 152576
  v_add_u32 v146, s3, v146
  s_lshl_b32 s3, s34, 8
  v_add_u32 v147, s3, v146
  s_waitcnt lgkmcnt(3)
  v_mfma_f32_32x32x16_bf16 v[64:79], v[48:51], v[224:227], v[64:79]
  ds_read_b64_tr_b16 v[56:57], v10 offset:18432
  ds_read_b64_tr_b16 v[58:59], v10 offset:18944
  ds_read_b128 v[232:235], v21 offset:16384
  s_waitcnt lgkmcnt(3)
  v_mfma_f32_32x32x16_bf16 v[80:95], v[48:51], v[228:231], v[80:95]
  ds_read_b128 v[236:239], v21 offset:20480
  buffer_load_dwordx4 v7, s[8:11], s28 offen offset:1024 lds
  ds_write_b32 v147, v144
  v_mfma_f32_32x32x16_bf16 v[96:111], v[52:55], v[224:227], v[96:111]
  ds_read_b64_tr_b16 v[60:61], v11 offset:18432
  ds_read_b64_tr_b16 v[62:63], v11 offset:18944
  ds_read_b128 v[240:243], v22 offset:16384
  s_mov_b32 s62, 0
L_CHK4:
  v_bitop3_b32 v172, v170, v171, v172 bitop3:0x96
  v_bitop3_b32 v176, v174, v175, v176 bitop3:0x96
  v_cmp_ne_u64 s[54:55], s[60:61], v[172:173]
  v_cmp_ne_u64 vcc, s[60:61], v[176:177]
  s_or_b64 vcc, s[54:55], vcc
  s_cbranch_vccz L_OK4
  s_add_u32 s62, s62, 1
  s_cmp_lt_u32 s62, 0x40000
  s_cbranch_scc0 L_OK4
  s_sleep 2
  s_mov_b32 s54, 65536
  buffer_load_dwordx4 v[170:173], v189, s[64:67], s54 offen sc1
  buffer_load_dwordx4 v[174:177], v189, s[64:67], s54 offen offset:512 sc1
  s_waitcnt vmcnt(0)
  s_branch L_CHK4
L_OK4:
  v_mfma_f32_32x32x16_bf16 v[112:127], v[52:55], v[228:231], v[112:127]
  ds_read_b128 v[244:247], v22 offset:20480
  v_cvt_pk_bf16_f32 v36, -v170, -v170
  s_waitcnt lgkmcnt(6)
  v_mfma_f32_32x32x16_bf16 v[64:79], v[56:59], v[232:235], v[64:79]
  ds_read_b64_tr_b16 v[48:49], v10 offset:20480
  ds_read_b64_tr_b16 v[50:51], v10 offset:20992
  ds_read_b128 v[248:251], v23 offset:16384
  v_mov_b32 v37, 0
  v_rcp_f32 v172, v171
  s_waitcnt lgkmcnt(8)
  v_mfma_f32_32x32x16_bf16 v[80:95], v[56:59], v[236:239], v[80:95]
  ds_read_b128 v[252:255], v23 offset:20480
  buffer_load_dwordx4 v8, s[8:11], s28 offen offset:2048 lds
  s_add_u32 s69, s69, 1
  s_cmp_ge_u32 s69, 10
  s_cselect_b32 s3, 10, 0
  s_sub_u32 s69, s69, s3
  s_waitcnt lgkmcnt(6)
  v_mfma_f32_32x32x16_bf16 v[96:111], v[60:63], v[232:235], v[96:111]
  ds_read_b64_tr_b16 v[52:53], v11 offset:20480
  ds_read_b64_tr_b16 v[54:55], v11 offset:20992
  v_cvt_pk_bf16_f32 v38, -v174, -v174
  v_mov_b32 v39, 0
  v_mfma_f32_32x32x16_bf16 v[112:127], v[60:63], v[236:239], v[112:127]
  v_rcp_f32 v176, v175
  v_mul_f32 v44, 0xc0135761, v172
  v_mul_f32 v45, v172, v172
  v_mul_f32 v46, v171, v171
  s_waitcnt lgkmcnt(4)
  v_mfma_f32_32x32x16_bf16 v[64:79], v[48:51], v[240:243], v[64:79]
  ds_read_b64_tr_b16 v[56:57], v10 offset:22528
  ds_read_b64_tr_b16 v[58:59], v10 offset:23040
  v_mul_f32 v45, 0x3d372713, v45
  v_mul_f32 v45, v45, v44
  v_mul_f32 v47, 0xc0135761, v176
  v_mfma_f32_32x32x16_bf16 v[80:95], v[48:51], v[244:247], v[80:95]
  ds_read_b64_tr_b16 v[60:61], v11 offset:22528
  ds_read_b64_tr_b16 v[62:63], v11 offset:23040
  buffer_load_dwordx4 v9, s[8:11], s28 offen offset:3072 lds
  v_mul_f32 v18, v176, v176
  s_waitcnt lgkmcnt(4)
  v_mfma_f32_32x32x16_bf16 v[96:111], v[52:55], v[240:243], v[96:111]
  v_mul_f32 v19, v175, v175
  v_mul_f32 v18, 0x3d372713, v18
  v_mul_f32 v18, v18, v47
  v_mfma_f32_32x32x16_bf16 v[112:127], v[52:55], v[244:247], v[112:127]
  s_waitcnt lgkmcnt(2)
  v_mfma_f32_32x32x16_bf16 v[64:79], v[56:59], v[248:251], v[64:79]
  s_waitcnt vmcnt(8) lgkmcnt(0)
  s_barrier
  ds_read_b64_tr_b16 v[48:49], v10 offset:32768
  ds_read_b64_tr_b16 v[50:51], v10 offset:33280
  ds_read_b32 v40, v146
  ds_read_b32 v42, v146 offset:256
  v_mfma_f32_32x32x16_bf16 v[80:95], v[56:59], v[252:255], v[80:95]
  s_add_u32 m0, s27, 81920
  s_mul_i32 s28, s69, 221184
  s_add_u32 s28, s28, s31
  buffer_load_dwordx4 v6, s[8:11], s28 offen offset:0 lds
  v_mfma_f32_32x32x16_bf16 v[96:111], v[60:63], v[248:251], v[96:111]
  ds_read_b64_tr_b16 v[52:53], v11 offset:32768
  ds_read_b64_tr_b16 v[54:55], v11 offset:33280
  v_mfma_f32_32x32x16_bf16 v[112:127], v[60:63], v[252:255], v[112:127]
  s_add_u32 m0, s27, 0
  s_mul_i32 s101, s63, 221184
  s_add_u32 s101, s101, s32
  buffer_load_dwordx4 v2, s[8:11], s101 offen offset:0 lds
  s_waitcnt lgkmcnt(2)
  s_nop 1
  v_mfma_f32_32x32x8_bf16 v[64:79], v[40:41], v[36:37], v[64:79]
  v_mfma_f32_32x32x8_bf16 v[80:95], v[40:41], v[38:39], v[80:95]
  v_mfma_f32_32x32x8_bf16 v[96:111], v[42:43], v[36:37], v[96:111]
  v_mfma_f32_32x32x8_bf16 v[112:127], v[42:43], v[38:39], v[112:127]
  v_mfma_f32_32x32x16_bf16 v[128:143], v[48:51], a[0:3], 0
  ds_read_b64_tr_b16 v[56:57], v10 offset:34816
  ds_read_b64_tr_b16 v[58:59], v10 offset:35328
  v_mfma_f32_32x32x16_bf16 v[144:159], v[48:51], a[4:7], 0
  v_mfma_f32_16x16x32_bf16 v[24:27], v[32:35], v[48:51], 0
  s_add_u32 m0, s27, 81920
  s_nop 0
  buffer_load_dwordx4 v7, s[8:11], s28 offen offset:1024 lds
  s_waitcnt lgkmcnt(2)
  v_mfma_f32_32x32x16_bf16 v[160:175], v[52:55], a[0:3], 0
  ds_read_b64_tr_b16 v[60:61], v11 offset:34816
  ds_read_b64_tr_b16 v[62:63], v11 offset:35328
  v_mfma_f32_32x32x16_bf16 v[176:191], v[52:55], a[4:7], 0
  v_mfma_f32_16x16x32_bf16 v[28:31], v[32:35], v[52:55], 0
  v_mul_f32 v20, v64, v64
  s_waitcnt lgkmcnt(2)
  v_mfma_f32_32x32x16_bf16 v[128:143], v[56:59], a[8:11], v[128:143]
  ds_read_b64_tr_b16 v[48:49], v10 offset:36864
  ds_read_b64_tr_b16 v[50:51], v10 offset:37376
  v_mul_f32 v21, v65, v65
  v_mul_f32 v22, v66, v66
  v_mul_f32 v23, v67, v67
  v_mul_f32 v72, v64, v72
  v_mfma_f32_32x32x16_bf16 v[144:159], v[56:59], a[12:15], v[144:159]
  v_mfma_f32_16x16x32_bf16 v[24:27], v[32:35], v[56:59], v[24:27]
  s_add_u32 m0, s27, 81920
  s_nop 0
  buffer_load_dwordx4 v8, s[8:11], s28 offen offset:2048 lds
  s_add_u32 s69, s69, 1
  s_cmp_ge_u32 s69, 10
  s_cselect_b32 s3, 10, 0
  s_sub_u32 s69, s69, s3
  s_waitcnt lgkmcnt(2)
  v_mfma_f32_32x32x16_bf16 v[160:175], v[60:63], a[8:11], v[160:175]
  ds_read_b64_tr_b16 v[52:53], v11 offset:36864
  ds_read_b64_tr_b16 v[54:55], v11 offset:37376
  v_mfma_f32_32x32x16_bf16 v[176:191], v[60:63], a[12:15], v[176:191]
  v_mfma_f32_16x16x32_bf16 v[28:31], v[32:35], v[60:63], v[28:31]
  s_waitcnt lgkmcnt(2)
  v_mfma_f32_32x32x16_bf16 v[128:143], v[48:51], a[16:19], v[128:143]
  ds_read_b64_tr_b16 v[56:57], v10 offset:38912
  ds_read_b64_tr_b16 v[58:59], v10 offset:39424
  s_add_u32 m0, s27, 0
  s_nop 0
  buffer_load_dwordx4 v3, s[8:11], s101 offen offset:1024 lds
  v_mfma_f32_32x32x16_bf16 v[144:159], v[48:51], a[20:23], v[144:159]
  v_mfma_f32_16x16x32_bf16 v[24:27], v[32:35], v[48:51], v[24:27]
  ds_read_b64_tr_b16 v[60:61], v11 offset:38912
  ds_read_b64_tr_b16 v[62:63], v11 offset:39424
  s_add_u32 m0, s27, 81920
  s_nop 0
  buffer_load_dwordx4 v9, s[8:11], s28 offen offset:3072 lds
  s_waitcnt lgkmcnt(4)
  v_mfma_f32_32x32x16_bf16 v[160:175], v[52:55], a[16:19], v[160:175]
  v_mul_f32 v73, v65, v73
  v_mfma_f32_32x32x16_bf16 v[176:191], v[52:55], a[20:23], v[176:191]
  v_mfma_f32_16x16x32_bf16 v[28:31], v[32:35], v[52:55], v[28:31]
  v_mul_f32 v74, v66, v74
  s_waitcnt lgkmcnt(2)
  v_mfma_f32_32x32x16_bf16 v[128:143], v[56:59], a[24:27], v[128:143]
  s_waitcnt vmcnt(10) lgkmcnt(0)
  s_barrier
  ds_read_b64_tr_b16 v[48:49], v10 offset:49152
  ds_read_b64_tr_b16 v[50:51], v10 offset:49664
  v_mul_f32 v75, v67, v75
  v_fma_f32 v20, v20, v45, v44
  v_mfma_f32_32x32x16_bf16 v[144:159], v[56:59], a[28:31], v[144:159]
  v_mfma_f32_16x16x32_bf16 v[24:27], v[32:35], v[56:59], v[24:27]
  s_add_u32 m0, s27, 98304
  s_mul_i32 s28, s69, 221184
  s_add_u32 s28, s28, s31
  buffer_load_dwordx4 v6, s[8:11], s28 offen offset:0 lds
  v_mfma_f32_32x32x16_bf16 v[160:175], v[60:63], a[24:27], v[160:175]
  ds_read_b64_tr_b16 v[52:53], v11 offset:49152
  ds_read_b64_tr_b16 v[54:55], v11 offset:49664
  v_mfma_f32_32x32x16_bf16 v[176:191], v[60:63], a[28:31], v[176:191]
  v_mfma_f32_16x16x32_bf16 v[28:31], v[32:35], v[60:63], v[28:31]
  v_fma_f32 v21, v21, v45, v44
  s_waitcnt lgkmcnt(2)
  v_mfma_f32_32x32x16_bf16 v[128:143], v[48:51], a[32:35], v[128:143]
  ds_read_b64_tr_b16 v[56:57], v10 offset:51200
  ds_read_b64_tr_b16 v[58:59], v10 offset:51712
  v_fma_f32 v22, v22, v45, v44
  v_fma_f32 v23, v23, v45, v44
  v_mul_f32 v76, v68, v76
  v_mul_f32 v77, v69, v77
  v_mfma_f32_32x32x16_bf16 v[144:159], v[48:51], a[36:39], v[144:159]
  s_add_u32 m0, s27, 0
  s_nop 0
  buffer_load_dwordx4 v4, s[8:11], s101 offen offset:2048 lds
  s_add_u32 s63, s63, 2
  s_cmp_ge_u32 s63, 10
  s_cselect_b32 s3, 10, 0
  s_sub_u32 s63, s63, s3
  s_add_u32 m0, s27, 98304
  s_nop 0
  buffer_load_dwordx4 v7, s[8:11], s28 offen offset:1024 lds
  s_waitcnt lgkmcnt(2)
  v_mfma_f32_32x32x16_bf16 v[160:175], v[52:55], a[32:35], v[160:175]
  ds_read_b64_tr_b16 v[60:61], v11 offset:51200
  ds_read_b64_tr_b16 v[62:63], v11 offset:51712
  v_mfma_f32_32x32x16_bf16 v[176:191], v[52:55], a[36:39], v[176:191]
  v_mul_f32 v78, v70, v78
  v_mul_f32 v79, v71, v79
  v_mul_f32 v64, v64, v20
  v_mul_f32 v65, v65, v21
  s_waitcnt lgkmcnt(2)
  v_mfma_f32_32x32x16_bf16 v[128:143], v[56:59], a[40:43], v[128:143]
  ds_read_b64_tr_b16 v[48:49], v10 offset:53248
  ds_read_b64_tr_b16 v[50:51], v10 offset:53760
  v_mul_f32 v66, v66, v22
  v_mul_f32 v67, v67, v23
  v_mul_f32 v20, v68, v68
  v_exp_f32 v64, v64
  v_mfma_f32_32x32x16_bf16 v[144:159], v[56:59], a[44:47], v[144:159]
  s_add_u32 m0, s27, 98304
  s_nop 0
  buffer_load_dwordx4 v8, s[8:11], s28 offen offset:2048 lds
  s_add_u32 s69, s69, 1
  s_cmp_ge_u32 s69, 10
  s_cselect_b32 s3, 10, 0
  s_sub_u32 s69, s69, s3
  s_waitcnt lgkmcnt(2)
  v_mfma_f32_32x32x16_bf16 v[160:175], v[60:63], a[40:43], v[160:175]
  ds_read_b64_tr_b16 v[52:53], v11 offset:53248
  ds_read_b64_tr_b16 v[54:55], v11 offset:53760
  v_mul_f32 v21, v69, v69
  v_mfma_f32_32x32x16_bf16 v[176:191], v[60:63], a[44:47], v[176:191]
  v_exp_f32 v65, v65
  v_mul_f32 v22, v70, v70
  v_exp_f32 v66, v66
  s_waitcnt lgkmcnt(2)
  v_mfma_f32_32x32x16_bf16 v[128:143], v[48:51], a[48:51], v[128:143]
  ds_read_b64_tr_b16 v[56:57], v10 offset:55296
  ds_read_b64_tr_b16 v[58:59], v10 offset:55808
  v_mul_f32 v23, v71, v71
  v_exp_f32 v67, v67
  v_fma_f32 v20, v20, v45, v44
  v_mfma_f32_32x32x16_bf16 v[144:159], v[48:51], a[52:55], v[144:159]
  ds_read_b64_tr_b16 v[60:61], v11 offset:55296
  ds_read_b64_tr_b16 v[62:63], v11 offset:55808
  s_add_u32 m0, s27, 98304
  s_nop 0
  buffer_load_dwordx4 v9, s[8:11], s28 offen offset:3072 lds
  s_waitcnt lgkmcnt(4)
  v_mfma_f32_32x32x16_bf16 v[160:175], v[52:55], a[48:51], v[160:175]
  s_add_u32 m0, s27, 0
  s_nop 0
  buffer_load_dwordx4 v5, s[8:11], s101 offen offset:3072 lds
  v_fma_f32 v21, v21, v45, v44
  v_mfma_f32_32x32x16_bf16 v[176:191], v[52:55], a[52:55], v[176:191]
  v_fma_f32 v22, v22, v45, v44
  v_fma_f32 v23, v23, v45, v44
  v_fma_f32 v64, v64, v46, v46
  v_fma_f32 v65, v65, v46, v46
  v_fma_f32 v66, v66, v46, v46
  s_waitcnt lgkmcnt(2)
  v_mfma_f32_32x32x16_bf16 v[128:143], v[56:59], a[56:59], v[128:143]
  s_waitcnt vmcnt(12) lgkmcnt(0)
  s_barrier
  ds_read_b64_tr_b16 v[48:49], v10 offset:0
  ds_read_b64_tr_b16 v[50:51], v10 offset:512
  v_fma_f32 v67, v67, v46, v46
  v_mul_f32 v68, v68, v20
  v_mfma_f32_32x32x16_bf16 v[144:159], v[56:59], a[60:63], v[144:159]
  s_add_u32 m0, s27, 114688
  s_mul_i32 s28, s69, 221184
  s_add_u32 s28, s28, s31
  buffer_load_dwordx4 v6, s[8:11], s28 offen offset:0 lds
  v_mfma_f32_32x32x16_bf16 v[160:175], v[60:63], a[56:59], v[160:175]
  ds_read_b64_tr_b16 v[52:53], v11 offset:0
  ds_read_b64_tr_b16 v[54:55], v11 offset:512
  v_rcp_f32 v64, v64
  v_mul_f32 v69, v69, v21
  v_rcp_f32 v65, v65
  v_mfma_f32_32x32x16_bf16 v[176:191], v[60:63], a[60:63], v[176:191]
  v_bitop3_b32 v26, v24, v25, s60 bitop3:0x96
  v_mov_b32 v27, s61
  s_lshl_b32 s3, s37, 8
  s_add_u32 s3, s3, s57
  s_add_u32 s3, s3, 10240
  s_mov_b64 exec, 0xffff
  buffer_store_dwordx4 v[24:27], v16, s[64:67], s3 offen sc1
  s_mov_b64 exec, -1
  s_waitcnt lgkmcnt(2)
  v_mfma_f32_32x32x16_bf16 v[128:143], v[48:51], a[64:67], v[128:143]
  ds_read_b64_tr_b16 v[56:57], v10 offset:2048
  ds_read_b64_tr_b16 v[58:59], v10 offset:2560
  v_mfma_f32_32x32x16_bf16 v[144:159], v[48:51], a[68:71], v[144:159]
  s_add_u32 m0, s27, 114688
  s_nop 0
  buffer_load_dwordx4 v7, s[8:11], s28 offen offset:1024 lds
  v_bitop3_b32 v30, v28, v29, s60 bitop3:0x96
  s_waitcnt lgkmcnt(2)
  v_mfma_f32_32x32x16_bf16 v[160:175], v[52:55], a[64:67], v[160:175]
  ds_read_b64_tr_b16 v[60:61], v11 offset:2048
  ds_read_b64_tr_b16 v[62:63], v11 offset:2560
  v_mov_b32 v31, s61
  s_lshl_b32 s3, s37, 8
  s_add_u32 s3, s3, s57
  s_add_u32 s3, s3, 12800
  s_mov_b64 exec, 0xffff
  buffer_store_dwordx4 v[28:31], v16, s[64:67], s3 offen sc1
  s_mov_b64 exec, -1
  v_mfma_f32_32x32x16_bf16 v[176:191], v[52:55], a[68:71], v[176:191]
  s_add_u32 m0, s27, 16384
  s_mul_i32 s101, s63, 221184
  s_add_u32 s101, s101, s32
  buffer_load_dwordx4 v2, s[8:11], s101 offen offset:0 lds
  s_waitcnt lgkmcnt(2)
  v_mfma_f32_32x32x16_bf16 v[128:143], v[56:59], a[72:75], v[128:143]
  ds_read_b64_tr_b16 v[48:49], v10 offset:4096
  ds_read_b64_tr_b16 v[50:51], v10 offset:4608
  v_mfma_f32_32x32x16_bf16 v[144:159], v[56:59], a[76:79], v[144:159]
  s_add_u32 m0, s27, 114688
  s_nop 0
  buffer_load_dwordx4 v8, s[8:11], s28 offen offset:2048 lds
  s_add_u32 s69, s69, 1
  s_cmp_ge_u32 s69, 10
  s_cselect_b32 s3, 10, 0
  s_sub_u32 s69, s69, s3
  s_waitcnt lgkmcnt(2)
  v_mfma_f32_32x32x16_bf16 v[160:175], v[60:63], a[72:75], v[160:175]
  ds_read_b64_tr_b16 v[52:53], v11 offset:4096
  ds_read_b64_tr_b16 v[54:55], v11 offset:4608
  v_mul_f32 v70, v70, v22
  v_rcp_f32 v66, v66
  v_mfma_f32_32x32x16_bf16 v[176:191], v[60:63], a[76:79], v[176:191]
  v_mul_f32 v71, v71, v23
  v_rcp_f32 v67, v67
  v_exp_f32 v68, v68
  s_waitcnt lgkmcnt(2)
  v_mfma_f32_32x32x16_bf16 v[128:143], v[48:51], a[80:83], v[128:143]
  ds_read_b64_tr_b16 v[56:57], v10 offset:6144
  ds_read_b64_tr_b16 v[58:59], v10 offset:6656
  v_mul_f32 v72, v72, v64
  v_exp_f32 v69, v69
  v_mul_f32 v73, v73, v65
  v_mfma_f32_32x32x16_bf16 v[144:159], v[48:51], a[84:87], v[144:159]
  ds_read_b64_tr_b16 v[60:61], v11 offset:6144
  ds_read_b64_tr_b16 v[62:63], v11 offset:6656
  s_add_u32 m0, s27, 114688
  s_nop 0
  buffer_load_dwordx4 v9, s[8:11], s28 offen offset:3072 lds
  s_waitcnt lgkmcnt(4)
  v_mfma_f32_32x32x16_bf16 v[160:175], v[52:55], a[80:83], v[160:175]
  v_exp_f32 v70, v70
  v_mul_f32 v74, v74, v66
  v_exp_f32 v71, v71
  v_mfma_f32_32x32x16_bf16 v[176:191], v[52:55], a[84:87], v[176:191]
  v_mul_f32 v75, v75, v67
  v_cvt_pk_bf16_f32 v64, v72, v73
  v_cvt_pk_bf16_f32 v65, v74, v75
  v_fma_f32 v68, v68, v46, v46
  v_fma_f32 v69, v69, v46, v46
  s_waitcnt lgkmcnt(2)
  v_mfma_f32_32x32x16_bf16 v[128:143], v[56:59], a[88:91], v[128:143]
  s_waitcnt vmcnt(13) lgkmcnt(0)
  s_barrier
  ds_read_b64_tr_b16 v[48:49], v10 offset:16384
  ds_read_b64_tr_b16 v[50:51], v10 offset:16896
  s_add_u32 m0, s27, 16384
  s_nop 0
  buffer_load_dwordx4 v3, s[8:11], s101 offen offset:1024 lds
  v_mfma_f32_32x32x16_bf16 v[144:159], v[56:59], a[92:95], v[144:159]
  s_add_u32 m0, s27, 65536
  s_mul_i32 s28, s69, 221184
  s_add_u32 s28, s28, s31
  buffer_load_dwordx4 v6, s[8:11], s28 offen offset:0 lds
  v_mfma_f32_32x32x16_bf16 v[160:175], v[60:63], a[88:91], v[160:175]
  ds_read_b64_tr_b16 v[52:53], v11 offset:16384
  ds_read_b64_tr_b16 v[54:55], v11 offset:16896
  v_fma_f32 v70, v70, v46, v46
  v_fma_f32 v71, v71, v46, v46
  v_mfma_f32_32x32x16_bf16 v[176:191], v[60:63], a[92:95], v[176:191]
  v_rcp_f32 v68, v68
  v_rcp_f32 v69, v69
  v_rcp_f32 v70, v70
  s_waitcnt lgkmcnt(2)
  v_mfma_f32_32x32x16_bf16 v[128:143], v[48:51], a[96:99], v[128:143]
  ds_read_b64_tr_b16 v[56:57], v10 offset:18432
  ds_read_b64_tr_b16 v[58:59], v10 offset:18944
  v_rcp_f32 v71, v71
  v_mul_f32 v76, v76, v68
  v_mfma_f32_32x32x16_bf16 v[144:159], v[48:51], a[100:103], v[144:159]
  s_add_u32 m0, s27, 65536
  s_nop 0
  buffer_load_dwordx4 v7, s[8:11], s28 offen offset:1024 lds
  v_mul_f32 v77, v77, v69
  s_waitcnt lgkmcnt(2)
  v_mfma_f32_32x32x16_bf16 v[160:175], v[52:55], a[96:99], v[160:175]
  ds_read_b64_tr_b16 v[60:61], v11 offset:18432
  ds_read_b64_tr_b16 v[62:63], v11 offset:18944
  v_mul_f32 v78, v78, v70
  v_mul_f32 v79, v79, v71
  v_cvt_pk_bf16_f32 v66, v76, v77
  v_cvt_pk_bf16_f32 v67, v78, v79
  v_mfma_f32_32x32x16_bf16 v[176:191], v[52:55], a[100:103], v[176:191]
  buffer_store_dwordx4 v[64:67], v14, s[12:15], s50 offen offset:0 sc1
  v_mul_f32 v20, v80, v80
  v_mul_f32 v21, v81, v81
  v_mul_f32 v22, v82, v82
  s_waitcnt lgkmcnt(2)
  v_mfma_f32_32x32x16_bf16 v[128:143], v[56:59], a[104:107], v[128:143]
  ds_read_b64_tr_b16 v[48:49], v10 offset:20480
  ds_read_b64_tr_b16 v[50:51], v10 offset:20992
  v_mul_f32 v23, v83, v83
  v_mul_f32 v88, v80, v88
  v_mul_f32 v89, v81, v89
  v_mul_f32 v90, v82, v90
  v_mfma_f32_32x32x16_bf16 v[144:159], v[56:59], a[108:111], v[144:159]
  s_add_u32 m0, s27, 16384
  s_nop 0
  buffer_load_dwordx4 v4, s[8:11], s101 offen offset:2048 lds
  s_add_u32 s63, s63, 2
  s_cmp_ge_u32 s63, 10
  s_cselect_b32 s3, 10, 0
  s_sub_u32 s63, s63, s3
  s_add_u32 m0, s27, 65536
  s_nop 0
  buffer_load_dwordx4 v8, s[8:11], s28 offen offset:2048 lds
  s_add_u32 s69, s69, 1
  s_cmp_ge_u32 s69, 10
  s_cselect_b32 s3, 10, 0
  s_sub_u32 s69, s69, s3
  s_waitcnt lgkmcnt(2)
  v_mfma_f32_32x32x16_bf16 v[160:175], v[60:63], a[104:107], v[160:175]
  ds_read_b64_tr_b16 v[52:53], v11 offset:20480
  ds_read_b64_tr_b16 v[54:55], v11 offset:20992
  v_mfma_f32_32x32x16_bf16 v[176:191], v[60:63], a[108:111], v[176:191]
  v_mul_f32 v91, v83, v91
  s_waitcnt lgkmcnt(2)
  v_mfma_f32_32x32x16_bf16 v[128:143], v[48:51], a[112:115], v[128:143]
  ds_read_b64_tr_b16 v[56:57], v10 offset:22528
  ds_read_b64_tr_b16 v[58:59], v10 offset:23040
  v_fma_f32 v20, v20, v18, v47
  v_fma_f32 v21, v21, v18, v47
  v_fma_f32 v22, v22, v18, v47
  v_fma_f32 v23, v23, v18, v47
  v_mfma_f32_32x32x16_bf16 v[144:159], v[48:51], a[116:119], v[144:159]
  ds_read_b64_tr_b16 v[60:61], v11 offset:22528
  ds_read_b64_tr_b16 v[62:63], v11 offset:23040
  s_add_u32 m0, s27, 65536
  s_nop 0
  buffer_load_dwordx4 v9, s[8:11], s28 offen offset:3072 lds
  s_waitcnt lgkmcnt(4)
  v_mfma_f32_32x32x16_bf16 v[160:175], v[52:55], a[112:115], v[160:175]
  v_mul_f32 v92, v84, v92
  v_mul_f32 v93, v85, v93
  v_mul_f32 v94, v86, v94
  v_mul_f32 v95, v87, v95
  v_mul_f32 v80, v80, v20
  v_mfma_f32_32x32x16_bf16 v[176:191], v[52:55], a[116:119], v[176:191]
  v_mul_f32 v81, v81, v21
  v_mul_f32 v82, v82, v22
  v_mul_f32 v83, v83, v23
  v_mul_f32 v20, v84, v84
  v_exp_f32 v80, v80
  s_waitcnt lgkmcnt(2)
  v_mfma_f32_32x32x16_bf16 v[128:143], v[56:59], a[120:123], v[128:143]
  s_waitcnt vmcnt(15) lgkmcnt(0)
  s_barrier
  ds_read_b64_tr_b16 v[48:49], v10 offset:32768
  ds_read_b64_tr_b16 v[50:51], v10 offset:33280
  v_mul_f32 v21, v85, v85
  v_mfma_f32_32x32x16_bf16 v[144:159], v[56:59], a[124:127], v[144:159]
  s_add_u32 m0, s27, 81920
  s_mul_i32 s28, s69, 221184
  s_add_u32 s28, s28, s31
  buffer_load_dwordx4 v6, s[8:11], s28 offen offset:0 lds
  v_mfma_f32_32x32x16_bf16 v[160:175], v[60:63], a[120:123], v[160:175]
  ds_read_b64_tr_b16 v[52:53], v11 offset:32768
  ds_read_b64_tr_b16 v[54:55], v11 offset:33280
  s_add_u32 m0, s27, 16384
  s_nop 0
  buffer_load_dwordx4 v5, s[8:11], s101 offen offset:3072 lds
  v_mfma_f32_32x32x16_bf16 v[176:191], v[60:63], a[124:127], v[176:191]
  v_exp_f32 v81, v81
  v_mul_f32 v22, v86, v86
  v_exp_f32 v82, v82
  s_waitcnt lgkmcnt(2)
  v_mfma_f32_32x32x16_bf16 v[128:143], v[48:51], a[128:131], v[128:143]
  ds_read_b64_tr_b16 v[56:57], v10 offset:34816
  ds_read_b64_tr_b16 v[58:59], v10 offset:35328
  v_mul_f32 v23, v87, v87
  v_exp_f32 v83, v83
  v_fma_f32 v20, v20, v18, v47
  v_mfma_f32_32x32x16_bf16 v[144:159], v[48:51], a[132:135], v[144:159]
  s_add_u32 m0, s27, 81920
  s_nop 0
  buffer_load_dwordx4 v7, s[8:11], s28 offen offset:1024 lds
  v_fma_f32 v21, v21, v18, v47
  s_waitcnt lgkmcnt(2)
  v_mfma_f32_32x32x16_bf16 v[160:175], v[52:55], a[128:131], v[160:175]
  ds_read_b64_tr_b16 v[60:61], v11 offset:34816
  ds_read_b64_tr_b16 v[62:63], v11 offset:35328
  v_fma_f32 v22, v22, v18, v47
  v_fma_f32 v23, v23, v18, v47
  v_fma_f32 v80, v80, v19, v19
  v_fma_f32 v81, v81, v19, v19
  v_mfma_f32_32x32x16_bf16 v[176:191], v[52:55], a[132:135], v[176:191]
  v_fma_f32 v82, v82, v19, v19
  v_fma_f32 v83, v83, v19, v19
  v_mul_f32 v84, v84, v20
  v_rcp_f32 v80, v80
  s_waitcnt lgkmcnt(2)
  v_mfma_f32_32x32x16_bf16 v[128:143], v[56:59], a[136:139], v[128:143]
  ds_read_b64_tr_b16 v[48:49], v10 offset:36864
  ds_read_b64_tr_b16 v[50:51], v10 offset:37376
  v_mul_f32 v85, v85, v21
  v_rcp_f32 v81, v81
  v_mul_f32 v86, v86, v22
  v_mfma_f32_32x32x16_bf16 v[144:159], v[56:59], a[140:143], v[144:159]
  s_add_u32 m0, s27, 81920
  s_nop 0
  buffer_load_dwordx4 v8, s[8:11], s28 offen offset:2048 lds
  s_add_u32 s69, s69, 1
  s_cmp_ge_u32 s69, 10
  s_cselect_b32 s3, 10, 0
  s_sub_u32 s69, s69, s3
  s_waitcnt lgkmcnt(2)
  v_mfma_f32_32x32x16_bf16 v[160:175], v[60:63], a[136:139], v[160:175]
  ds_read_b64_tr_b16 v[52:53], v11 offset:36864
  ds_read_b64_tr_b16 v[54:55], v11 offset:37376
  v_rcp_f32 v82, v82
  v_mfma_f32_32x32x16_bf16 v[176:191], v[60:63], a[140:143], v[176:191]
  s_add_u32 m0, s27, 32768
  s_mul_i32 s101, s63, 221184
  s_add_u32 s101, s101, s32
  buffer_load_dwordx4 v2, s[8:11], s101 offen offset:0 lds
  s_waitcnt lgkmcnt(2)
  v_mfma_f32_32x32x16_bf16 v[128:143], v[48:51], a[144:147], v[128:143]
  ds_read_b64_tr_b16 v[56:57], v10 offset:38912
  ds_read_b64_tr_b16 v[58:59], v10 offset:39424
  v_mul_f32 v87, v87, v23
  v_rcp_f32 v83, v83
  v_exp_f32 v84, v84
  v_mfma_f32_32x32x16_bf16 v[144:159], v[48:51], a[148:151], v[144:159]
  ds_read_b64_tr_b16 v[60:61], v11 offset:38912
  ds_read_b64_tr_b16 v[62:63], v11 offset:39424
  s_add_u32 m0, s27, 81920
  s_nop 0
  buffer_load_dwordx4 v9, s[8:11], s28 offen offset:3072 lds
  s_waitcnt lgkmcnt(4)
  v_mfma_f32_32x32x16_bf16 v[160:175], v[52:55], a[144:147], v[160:175]
  v_mul_f32 v88, v88, v80
  v_exp_f32 v85, v85
  v_mul_f32 v89, v89, v81
  v_mfma_f32_32x32x16_bf16 v[176:191], v[52:55], a[148:151], v[176:191]
  v_exp_f32 v86, v86
  v_mul_f32 v90, v90, v82
  v_exp_f32 v87, v87
  s_waitcnt lgkmcnt(2)
  v_mfma_f32_32x32x16_bf16 v[128:143], v[56:59], a[152:155], v[128:143]
  s_waitcnt vmcnt(13) lgkmcnt(0)
  s_barrier
  ds_read_b64_tr_b16 v[48:49], v10 offset:49152
  ds_read_b64_tr_b16 v[50:51], v10 offset:49664
  v_mul_f32 v91, v91, v83
  v_cvt_pk_bf16_f32 v80, v88, v89
  v_mfma_f32_32x32x16_bf16 v[144:159], v[56:59], a[156:159], v[144:159]
  s_add_u32 m0, s27, 98304
  s_mul_i32 s28, s69, 221184
  s_add_u32 s28, s28, s31
  buffer_load_dwordx4 v6, s[8:11], s28 offen offset:0 lds
  v_mfma_f32_32x32x16_bf16 v[160:175], v[60:63], a[152:155], v[160:175]
  ds_read_b64_tr_b16 v[52:53], v11 offset:49152
  ds_read_b64_tr_b16 v[54:55], v11 offset:49664
  v_cvt_pk_bf16_f32 v81, v90, v91
  v_fma_f32 v84, v84, v19, v19
  v_fma_f32 v85, v85, v19, v19
  v_fma_f32 v86, v86, v19, v19
  v_mfma_f32_32x32x16_bf16 v[176:191], v[60:63], a[156:159], v[176:191]
  v_fma_f32 v87, v87, v19, v19
  v_rcp_f32 v84, v84
  v_rcp_f32 v85, v85
  s_waitcnt lgkmcnt(2)
  v_mfma_f32_32x32x16_bf16 v[128:143], v[48:51], a[160:163], v[128:143]
  ds_read_b64_tr_b16 v[56:57], v10 offset:51200
  ds_read_b64_tr_b16 v[58:59], v10 offset:51712
  s_add_u32 m0, s27, 32768
  s_nop 0
  buffer_load_dwordx4 v3, s[8:11], s101 offen offset:1024 lds
  v_mfma_f32_32x32x16_bf16 v[144:159], v[48:51], a[164:167], v[144:159]
  s_add_u32 m0, s27, 98304
  s_nop 0
  buffer_load_dwordx4 v7, s[8:11], s28 offen offset:1024 lds
  v_rcp_f32 v86, v86
  s_waitcnt lgkmcnt(2)
  v_mfma_f32_32x32x16_bf16 v[160:175], v[52:55], a[160:163], v[160:175]
  ds_read_b64_tr_b16 v[60:61], v11 offset:51200
  ds_read_b64_tr_b16 v[62:63], v11 offset:51712
  v_rcp_f32 v87, v87
  v_mul_f32 v92, v92, v84
  v_mfma_f32_32x32x16_bf16 v[176:191], v[52:55], a[164:167], v[176:191]
  v_mul_f32 v93, v93, v85
  v_mul_f32 v94, v94, v86
  v_mul_f32 v95, v95, v87
  v_cvt_pk_bf16_f32 v82, v92, v93
  v_cvt_pk_bf16_f32 v83, v94, v95
  s_waitcnt lgkmcnt(2)
  v_mfma_f32_32x32x16_bf16 v[128:143], v[56:59], a[168:171], v[128:143]
  ds_read_b64_tr_b16 v[48:49], v10 offset:53248
  ds_read_b64_tr_b16 v[50:51], v10 offset:53760
  buffer_store_dwordx4 v[80:83], v14, s[12:15], s50 offen offset:2048 sc1
  v_mul_f32 v20, v112, v112
  v_mul_f32 v21, v113, v113
  v_mfma_f32_32x32x16_bf16 v[144:159], v[56:59], a[172:175], v[144:159]
  s_add_u32 m0, s27, 98304
  s_nop 0
  buffer_load_dwordx4 v8, s[8:11], s28 offen offset:2048 lds
  s_add_u32 s69, s69, 1
  s_cmp_ge_u32 s69, 10
  s_cselect_b32 s3, 10, 0
  s_sub_u32 s69, s69, s3
  s_waitcnt lgkmcnt(2)
  v_mfma_f32_32x32x16_bf16 v[160:175], v[60:63], a[168:171], v[160:175]
  ds_read_b64_tr_b16 v[52:53], v11 offset:53248
  ds_read_b64_tr_b16 v[54:55], v11 offset:53760
  v_mul_f32 v22, v114, v114
  v_mul_f32 v23, v115, v115
  v_mfma_f32_32x32x16_bf16 v[176:191], v[60:63], a[172:175], v[176:191]
  v_mul_f32 v120, v112, v120
  v_mul_f32 v121, v113, v121
  v_mul_f32 v122, v114, v122
  v_mul_f32 v123, v115, v123
  v_fma_f32 v20, v20, v18, v47
  s_waitcnt lgkmcnt(2)
  v_mfma_f32_32x32x16_bf16 v[128:143], v[48:51], a[176:179], v[128:143]
  ds_read_b64_tr_b16 v[56:57], v10 offset:55296
  ds_read_b64_tr_b16 v[58:59], v10 offset:55808
  s_cmp_eq_u32 s24, 0
  s_cselect_b32 s54, 0, 1
  s_lshl_b32 s54, s54, 30
  s_add_u32 s54, s54, 4096
  buffer_load_dwordx4 v[40:43], v16, s[64:67], s54 offen sc1
  v_mfma_f32_32x32x16_bf16 v[144:159], v[48:51], a[180:183], v[144:159]
  ds_read_b64_tr_b16 v[60:61], v11 offset:55296
  ds_read_b64_tr_b16 v[62:63], v11 offset:55808
  s_add_u32 m0, s27, 32768
  s_nop 0
  buffer_load_dwordx4 v4, s[8:11], s101 offen offset:2048 lds
  s_add_u32 s63, s63, 2
  s_cmp_ge_u32 s63, 10
  s_cselect_b32 s3, 10, 0
  s_sub_u32 s63, s63, s3
  s_add_u32 m0, s27, 98304
  s_nop 0
  buffer_load_dwordx4 v9, s[8:11], s28 offen offset:3072 lds
  s_waitcnt lgkmcnt(4)
  v_mfma_f32_32x32x16_bf16 v[160:175], v[52:55], a[176:179], v[160:175]
  v_mfma_f32_32x32x16_bf16 v[176:191], v[52:55], a[180:183], v[176:191]
  v_fma_f32 v21, v21, v18, v47
  v_fma_f32 v22, v22, v18, v47
  v_fma_f32 v23, v23, v18, v47
  v_mul_f32 v124, v116, v124
  s_waitcnt lgkmcnt(2)
  v_mfma_f32_32x32x16_bf16 v[128:143], v[56:59], a[184:187], v[128:143]
  s_waitcnt vmcnt(14) lgkmcnt(0)
  s_barrier
  ds_read_b64_tr_b16 v[48:49], v10 offset:0
  ds_read_b64_tr_b16 v[50:51], v10 offset:512
  v_mul_f32 v125, v117, v125
  v_mul_f32 v126, v118, v126
  v_mfma_f32_32x32x16_bf16 v[144:159], v[56:59], a[188:191], v[144:159]
  s_add_u32 m0, s27, 114688
  s_mul_i32 s28, s69, 221184
  s_add_u32 s28, s28, s31
  buffer_load_dwordx4 v6, s[8:11], s28 offen offset:0 lds
  v_mfma_f32_32x32x16_bf16 v[160:175], v[60:63], a[184:187], v[160:175]
  ds_read_b64_tr_b16 v[52:53], v11 offset:0
  ds_read_b64_tr_b16 v[54:55], v11 offset:512
  v_mul_f32 v127, v119, v127
  v_mul_f32 v112, v112, v20
  v_mul_f32 v113, v113, v21
  v_mul_f32 v114, v114, v22
  v_mfma_f32_32x32x16_bf16 v[176:191], v[60:63], a[188:191], v[176:191]
  v_mul_f32 v115, v115, v23
  v_mul_f32 v20, v116, v116
  v_exp_f32 v112, v112
  v_mul_f32 v21, v117, v117
  s_waitcnt lgkmcnt(2)
  v_mfma_f32_32x32x16_bf16 v[128:143], v[48:51], a[192:195], v[128:143]
  ds_read_b64_tr_b16 v[56:57], v10 offset:2048
  ds_read_b64_tr_b16 v[58:59], v10 offset:2560
  v_exp_f32 v113, v113
  v_mul_f32 v22, v118, v118
  v_exp_f32 v114, v114
  v_mfma_f32_32x32x16_bf16 v[144:159], v[48:51], a[196:199], v[144:159]
  s_add_u32 m0, s27, 114688
  s_nop 0
  buffer_load_dwordx4 v7, s[8:11], s28 offen offset:1024 lds
  s_waitcnt lgkmcnt(2)
  v_mfma_f32_32x32x16_bf16 v[160:175], v[52:55], a[192:195], v[160:175]
  ds_read_b64_tr_b16 v[60:61], v11 offset:2048
  ds_read_b64_tr_b16 v[62:63], v11 offset:2560
  s_add_u32 m0, s27, 32768
  s_nop 0
  buffer_load_dwordx4 v5, s[8:11], s101 offen offset:3072 lds
  v_mfma_f32_32x32x16_bf16 v[176:191], v[52:55], a[196:199], v[176:191]
  v_mul_f32 v23, v119, v119
  v_exp_f32 v115, v115
  v_fma_f32 v20, v20, v18, v47
  v_fma_f32 v21, v21, v18, v47
  s_waitcnt lgkmcnt(2)
  v_mfma_f32_32x32x16_bf16 v[128:143], v[56:59], a[200:203], v[128:143]
  ds_read_b64_tr_b16 v[48:49], v10 offset:4096
  ds_read_b64_tr_b16 v[50:51], v10 offset:4608
  v_fma_f32 v22, v22, v18, v47
  v_fma_f32 v23, v23, v18, v47
  v_fma_f32 v112, v112, v19, v19
  v_fma_f32 v113, v113, v19, v19
  v_mfma_f32_32x32x16_bf16 v[144:159], v[56:59], a[204:207], v[144:159]
  s_add_u32 m0, s27, 114688
  s_nop 0
  buffer_load_dwordx4 v8, s[8:11], s28 offen offset:2048 lds
  s_add_u32 s69, s69, 1
  s_cmp_ge_u32 s69, 10
  s_cselect_b32 s3, 10, 0
  s_sub_u32 s69, s69, s3
  s_waitcnt lgkmcnt(2)
  v_mfma_f32_32x32x16_bf16 v[160:175], v[60:63], a[200:203], v[160:175]
  ds_read_b64_tr_b16 v[52:53], v11 offset:4096
  ds_read_b64_tr_b16 v[54:55], v11 offset:4608
  v_fma_f32 v114, v114, v19, v19
  v_fma_f32 v115, v115, v19, v19
  v_mfma_f32_32x32x16_bf16 v[176:191], v[60:63], a[204:207], v[176:191]
  v_mul_f32 v116, v116, v20
  v_rcp_f32 v112, v112
  v_mul_f32 v117, v117, v21
  v_rcp_f32 v113, v113
  s_waitcnt lgkmcnt(2)
  v_mfma_f32_32x32x16_bf16 v[128:143], v[48:51], a[208:211], v[128:143]
  ds_read_b64_tr_b16 v[56:57], v10 offset:6144
  ds_read_b64_tr_b16 v[58:59], v10 offset:6656
  v_mul_f32 v118, v118, v22
  v_rcp_f32 v114, v114
  v_mfma_f32_32x32x16_bf16 v[144:159], v[48:51], a[212:215], v[144:159]
  ds_read_b64_tr_b16 v[60:61], v11 offset:6144
  ds_read_b64_tr_b16 v[62:63], v11 offset:6656
  s_add_u32 m0, s27, 114688
  s_nop 0
  buffer_load_dwordx4 v9, s[8:11], s28 offen offset:3072 lds
  s_waitcnt lgkmcnt(4)
  v_mfma_f32_32x32x16_bf16 v[160:175], v[52:55], a[208:211], v[160:175]
  v_mul_f32 v119, v119, v23
  v_rcp_f32 v115, v115
  v_exp_f32 v116, v116
  v_mfma_f32_32x32x16_bf16 v[176:191], v[52:55], a[212:215], v[176:191]
  s_add_u32 m0, s27, 49152
  s_mul_i32 s101, s63, 221184
  s_add_u32 s101, s101, s32
  buffer_load_dwordx4 v2, s[8:11], s101 offen offset:0 lds
  s_waitcnt lgkmcnt(2)
  v_mfma_f32_32x32x16_bf16 v[128:143], v[56:59], a[216:219], v[128:143]
  s_waitcnt vmcnt(14) lgkmcnt(0)
  s_barrier
  ds_read_b64_tr_b16 v[48:49], v10 offset:16384
  ds_read_b64_tr_b16 v[50:51], v10 offset:16896
  v_mul_f32 v120, v120, v112
  v_exp_f32 v117, v117
  v_mfma_f32_32x32x16_bf16 v[144:159], v[56:59], a[220:223], v[144:159]
  v_mul_f32 v121, v121, v113
  v_exp_f32 v118, v118
  v_mul_f32 v122, v122, v114
  v_mfma_f32_32x32x16_bf16 v[160:175], v[60:63], a[216:219], v[160:175]
  ds_read_b64_tr_b16 v[52:53], v11 offset:16384
  ds_read_b64_tr_b16 v[54:55], v11 offset:16896
  v_exp_f32 v119, v119
  v_mul_f32 v123, v123, v115
  v_cvt_pk_bf16_f32 v112, v120, v121
  v_mfma_f32_32x32x16_bf16 v[176:191], v[60:63], a[220:223], v[176:191]
  v_cvt_pk_bf16_f32 v113, v122, v123
  v_fma_f32 v116, v116, v19, v19
  v_fma_f32 v117, v117, v19, v19
  v_fma_f32 v118, v118, v19, v19
  v_fma_f32 v119, v119, v19, v19
  s_waitcnt lgkmcnt(2)
  v_mfma_f32_32x32x16_bf16 v[128:143], v[48:51], a[224:227], v[128:143]
  ds_read_b64_tr_b16 v[56:57], v10 offset:18432
  ds_read_b64_tr_b16 v[58:59], v10 offset:18944
  v_rcp_f32 v116, v116
  v_rcp_f32 v117, v117
  v_mfma_f32_32x32x16_bf16 v[144:159], v[48:51], a[228:231], v[144:159]
  v_rcp_f32 v118, v118
  v_rcp_f32 v119, v119
  v_mul_f32 v124, v124, v116
  s_waitcnt lgkmcnt(2)
  v_mfma_f32_32x32x16_bf16 v[160:175], v[52:55], a[224:227], v[160:175]
  ds_read_b64_tr_b16 v[60:61], v11 offset:18432
  ds_read_b64_tr_b16 v[62:63], v11 offset:18944
  v_mul_f32 v125, v125, v117
  v_mul_f32 v126, v126, v118
  v_mul_f32 v127, v127, v119
  v_cvt_pk_bf16_f32 v114, v124, v125
  v_mfma_f32_32x32x16_bf16 v[176:191], v[52:55], a[228:231], v[176:191]
  v_cvt_pk_bf16_f32 v115, v126, v127
  buffer_store_dwordx4 v[112:115], v14, s[12:15], s50 offen offset:2560 sc1
  s_cmp_lg_u32 s24, 0
  s_cbranch_scc1 L_W5
  s_waitcnt vmcnt(9)
  s_mov_b32 s62, 0
L_CHK6:
  v_xor_b32 v40, s60, v40
  v_xor_b32 v41, s60, v41
  v_xor_b32 v42, s60, v42
  v_xor_b32 v43, s60, v43
  v_or3_b32 v40, v40, v41, v42
  v_or_b32 v40, v40, v43
  v_cmp_ne_u32 vcc, 0, v40
  s_cbranch_vccz L_OK6
  s_add_u32 s62, s62, 1
  s_cmp_lt_u32 s62, 0x40000
  s_cbranch_scc0 L_OK6
  s_sleep 8
  s_cmp_eq_u32 s24, 0
  s_cselect_b32 s54, 0, 1
  s_lshl_b32 s54, s54, 30
  s_add_u32 s54, s54, 4096
  buffer_load_dwordx4 v[40:43], v16, s[64:67], s54 offen sc1
  s_waitcnt vmcnt(0)
  s_branch L_CHK6
L_OK6:
L_W5:
  s_waitcnt lgkmcnt(2)
  v_mfma_f32_32x32x16_bf16 v[128:143], v[56:59], a[232:235], v[128:143]
  ds_read_b64_tr_b16 v[48:49], v10 offset:20480
  ds_read_b64_tr_b16 v[50:51], v10 offset:20992
  s_add_u32 m0, s27, 49152
  s_nop 0
  buffer_load_dwordx4 v3, s[8:11], s101 offen offset:1024 lds
  v_mfma_f32_32x32x16_bf16 v[144:159], v[56:59], a[236:239], v[144:159]
  s_waitcnt lgkmcnt(2)
  v_mfma_f32_32x32x16_bf16 v[160:175], v[60:63], a[232:235], v[160:175]
  ds_read_b64_tr_b16 v[52:53], v11 offset:20480
  ds_read_b64_tr_b16 v[54:55], v11 offset:20992
  s_add_u32 s54, s57, 10240
  s_mul_i32 s3, s34, 2560
  s_add_u32 s54, s54, s3
  buffer_load_dwordx4 v[64:67], v16, s[64:67], s54 offen offset:0 sc1
  v_mfma_f32_32x32x16_bf16 v[176:191], v[60:63], a[236:239], v[176:191]
  s_add_u32 s54, s57, 10240
  s_mul_i32 s3, s34, 2560
  s_add_u32 s54, s54, s3
  buffer_load_dwordx4 v[68:71], v16, s[64:67], s54 offen offset:1024 sc1
  s_waitcnt lgkmcnt(2)
  v_mfma_f32_32x32x16_bf16 v[128:143], v[48:51], a[240:243], v[128:143]
  ds_read_b64_tr_b16 v[56:57], v10 offset:22528
  ds_read_b64_tr_b16 v[58:59], v10 offset:23040
  s_add_u32 s54, s57, 10240
  s_mul_i32 s3, s34, 2560
  s_add_u32 s54, s54, s3
  buffer_load_dwordx4 v[72:75], v17, s[64:67], s54 offen offset:0 sc1
  v_mfma_f32_32x32x16_bf16 v[144:159], v[48:51], a[244:247], v[144:159]
  ds_read_b64_tr_b16 v[60:61], v11 offset:22528
  ds_read_b64_tr_b16 v[62:63], v11 offset:23040
  ds_read_b64_tr_b16 v[28:29], v12 offset:0
  ds_read_b64_tr_b16 v[30:31], v12 offset:256
  s_waitcnt lgkmcnt(6)
  v_mfma_f32_32x32x16_bf16 v[160:175], v[52:55], a[240:243], v[160:175]
  v_mul_f32 v20, v96, v96
  v_mul_f32 v21, v97, v97
  v_mul_f32 v22, v98, v98
  v_mul_f32 v23, v99, v99
  v_mul_f32 v104, v96, v104
  v_mul_f32 v105, v97, v105
  v_mfma_f32_32x32x16_bf16 v[176:191], v[52:55], a[244:247], v[176:191]
  v_mul_f32 v106, v98, v106
  v_mul_f32 v107, v99, v107
  s_waitcnt lgkmcnt(0)
  v_mfma_f32_16x16x32_bf16 v[24:27], v[32:35], v[28:31], 0
  v_mfma_f32_32x32x16_bf16 v[128:143], v[56:59], a[248:251], v[128:143]
  s_waitcnt vmcnt(11)
  s_barrier
  ds_read_b64_tr_b16 v[48:49], v10 offset:32768
  ds_read_b64_tr_b16 v[50:51], v10 offset:33280
  v_mfma_f32_32x32x16_bf16 v[144:159], v[56:59], a[252:255], v[144:159]
  s_add_u32 m0, s27, 49152
  s_nop 0
  buffer_load_dwordx4 v4, s[8:11], s101 offen offset:2048 lds
  s_add_u32 s63, s63, 2
  s_cmp_ge_u32 s63, 10
  s_cselect_b32 s3, 10, 0
  s_sub_u32 s63, s63, s3
  v_mfma_f32_32x32x16_bf16 v[160:175], v[60:63], a[248:251], v[160:175]
  ds_read_b64_tr_b16 v[52:53], v11 offset:32768
  ds_read_b64_tr_b16 v[54:55], v11 offset:33280
  ds_read_b64_tr_b16 v[28:29], v12 offset:1024
  ds_read_b64_tr_b16 v[30:31], v12 offset:1280
  v_mfma_f32_32x32x16_bf16 v[176:191], v[60:63], a[252:255], v[176:191]
  v_fma_f32 v20, v20, v45, v44
  v_fma_f32 v21, v21, v45, v44
  v_fma_f32 v22, v22, v45, v44
  v_fma_f32 v23, v23, v45, v44
  v_mul_f32 v108, v100, v108
  s_waitcnt lgkmcnt(4)
  v_mfma_f32_32x32x16_bf16 v[128:143], v[48:51], v[192:195], v[128:143]
  ds_read_b64_tr_b16 v[56:57], v10 offset:34816
  ds_read_b64_tr_b16 v[58:59], v10 offset:35328
  v_mul_f32 v109, v101, v109
  v_mul_f32 v110, v102, v110
  v_mul_f32 v111, v103, v111
  s_waitcnt lgkmcnt(2)
  v_mfma_f32_16x16x32_bf16 v[24:27], v[32:35], v[28:31], v[24:27]
  v_mfma_f32_32x32x16_bf16 v[144:159], v[48:51], v[196:199], v[144:159]
  ds_read_b64_tr_b16 v[28:29], v12 offset:2048
  v_mfma_f32_32x32x16_bf16 v[160:175], v[52:55], v[192:195], v[160:175]
  ds_read_b64_tr_b16 v[60:61], v11 offset:34816
  ds_read_b64_tr_b16 v[62:63], v11 offset:35328
  ds_read_b64_tr_b16 v[30:31], v12 offset:2304
  v_mul_f32 v96, v96, v20
  v_mul_f32 v97, v97, v21
  v_mul_f32 v98, v98, v22
  v_mfma_f32_32x32x16_bf16 v[176:191], v[52:55], v[196:199], v[176:191]
  v_mul_f32 v99, v99, v23
  v_mul_f32 v20, v100, v100
  v_exp_f32 v96, v96
  v_mul_f32 v21, v101, v101
  s_waitcnt lgkmcnt(4)
  v_mfma_f32_32x32x16_bf16 v[128:143], v[56:59], v[200:203], v[128:143]
  ds_read_b64_tr_b16 v[48:49], v10 offset:36864
  ds_read_b64_tr_b16 v[50:51], v10 offset:37376
  v_exp_f32 v97, v97
  s_waitcnt lgkmcnt(2)
  v_mfma_f32_16x16x32_bf16 v[24:27], v[32:35], v[28:31], v[24:27]
  v_mfma_f32_32x32x16_bf16 v[144:159], v[56:59], v[204:207], v[144:159]
  ds_read_b64_tr_b16 v[28:29], v12 offset:3072
  ds_read_b64_tr_b16 v[30:31], v12 offset:3328
  v_mfma_f32_32x32x16_bf16 v[160:175], v[60:63], v[200:203], v[160:175]
  ds_read_b64_tr_b16 v[52:53], v11 offset:36864
  ds_read_b64_tr_b16 v[54:55], v11 offset:37376
  s_add_u32 m0, s27, 49152
  s_nop 0
  buffer_load_dwordx4 v5, s[8:11], s101 offen offset:3072 lds
  v_mfma_f32_32x32x16_bf16 v[176:191], v[60:63], v[204:207], v[176:191]
  v_mul_f32 v22, v102, v102
  v_exp_f32 v98, v98
  v_mul_f32 v23, v103, v103
  v_exp_f32 v99, v99
  s_waitcnt lgkmcnt(4)
  v_mfma_f32_32x32x16_bf16 v[128:143], v[48:51], v[208:211], v[128:143]
  ds_read_b64_tr_b16 v[56:57], v10 offset:38912
  ds_read_b64_tr_b16 v[58:59], v10 offset:39424
  v_fma_f32 v20, v20, v45, v44
  v_fma_f32 v21, v21, v45, v44
  v_fma_f32 v22, v22, v45, v44
  v_mfma_f32_32x32x16_bf16 v[144:159], v[48:51], v[212:215], v[144:159]
  ds_read_b64_tr_b16 v[60:61], v11 offset:38912
  ds_read_b64_tr_b16 v[62:63], v11 offset:39424
  v_fma_f32 v23, v23, v45, v44
  s_waitcnt lgkmcnt(6)
  v_mfma_f32_16x16x32_bf16 v[24:27], v[32:35], v[28:31], v[24:27]
  s_waitcnt lgkmcnt(4)
  v_mfma_f32_32x32x16_bf16 v[160:175], v[52:55], v[208:211], v[160:175]
  v_fma_f32 v96, v96, v46, v46
  v_fma_f32 v97, v97, v46, v46
  v_fma_f32 v98, v98, v46, v46
  v_mfma_f32_32x32x16_bf16 v[176:191], v[52:55], v[212:215], v[176:191]
  v_fma_f32 v99, v99, v46, v46
  v_mul_f32 v100, v100, v20
  v_rcp_f32 v96, v96
  v_mul_f32 v101, v101, v21
  s_waitcnt lgkmcnt(2)
  v_mfma_f32_32x32x16_bf16 v[128:143], v[56:59], v[216:219], v[128:143]
  s_waitcnt vmcnt(8) lgkmcnt(0)
  s_barrier
  ds_read_b64_tr_b16 v[48:49], v10 offset:49152
  ds_read_b64_tr_b16 v[50:51], v10 offset:49664
  v_rcp_f32 v97, v97
  v_mfma_f32_32x32x16_bf16 v[144:159], v[56:59], v[220:223], v[144:159]
  v_mul_f32 v102, v102, v22
  v_rcp_f32 v98, v98
  v_mul_f32 v103, v103, v23
  v_rcp_f32 v99, v99
  v_mfma_f32_32x32x16_bf16 v[160:175], v[60:63], v[216:219], v[160:175]
  ds_read_b64_tr_b16 v[52:53], v11 offset:49152
  ds_read_b64_tr_b16 v[54:55], v11 offset:49664
  s_mul_i32 s3, s35, 2560
  s_sub_u32 s3, 20480, s3
  s_add_u32 s57, s57, s3
  v_mfma_f32_32x32x16_bf16 v[176:191], v[60:63], v[220:223], v[176:191]
  v_bitop3_b32 v26, v24, v25, s60 bitop3:0x96
  v_mov_b32 v27, s61
  s_lshl_b32 s3, s37, 8
  s_add_u32 s3, s3, s57
  s_add_u32 s3, s3, 0
  s_mov_b64 exec, 0xffff
  buffer_store_dwordx4 v[24:27], v16, s[64:67], s3 offen sc1
  s_mov_b64 exec, -1
  s_waitcnt lgkmcnt(2)
  v_mfma_f32_32x32x16_bf16 v[128:143], v[48:51], v[224:227], v[128:143]
  ds_read_b64_tr_b16 v[56:57], v10 offset:51200
  ds_read_b64_tr_b16 v[58:59], v10 offset:51712
  v_mfma_f32_32x32x16_bf16 v[144:159], v[48:51], v[228:231], v[144:159]
  s_mul_i32 s3, s35, 2560
  s_sub_u32 s3, 20480, s3
  s_sub_u32 s57, s57, s3
  s_waitcnt vmcnt(3)
  s_mov_b32 s62, 0
L_CHK7:
  v_bitop3_b32 v66, v64, v65, v66 bitop3:0x96
  v_bitop3_b32 v70, v68, v69, v70 bitop3:0x96
  v_bitop3_b32 v74, v72, v73, v74 bitop3:0x96
  v_cmp_ne_u64 s[54:55], s[60:61], v[66:67]
  v_cmp_ne_u64 vcc, s[60:61], v[70:71]
  s_or_b64 s[54:55], s[54:55], vcc
  v_cmp_ne_u64 vcc, s[60:61], v[74:75]
  s_or_b64 vcc, s[54:55], vcc
  s_cbranch_vccz L_OK7
  s_add_u32 s62, s62, 1
  s_cmp_lt_u32 s62, 0x40000
  s_cbranch_scc0 L_OK7
  s_sleep 2
  s_add_u32 s54, s57, 10240
  s_mul_i32 s3, s34, 2560
  s_add_u32 s54, s54, s3
  buffer_load_dwordx4 v[64:67], v16, s[64:67], s54 offen offset:0 sc1
  s_add_u32 s54, s57, 10240
  s_mul_i32 s3, s34, 2560
  s_add_u32 s54, s54, s3
  buffer_load_dwordx4 v[68:71], v16, s[64:67], s54 offen offset:1024 sc1
  s_add_u32 s54, s57, 10240
  s_mul_i32 s3, s34, 2560
  s_add_u32 s54, s54, s3
  buffer_load_dwordx4 v[72:75], v17, s[64:67], s54 offen offset:0 sc1
  s_waitcnt vmcnt(0)
  s_branch L_CHK7
L_OK7:
  s_waitcnt lgkmcnt(2)
  v_mfma_f32_32x32x16_bf16 v[160:175], v[52:55], v[224:227], v[160:175]
  ds_read_b64_tr_b16 v[60:61], v11 offset:51200
  ds_read_b64_tr_b16 v[62:63], v11 offset:51712
  v_mfma_f32_32x32x16_bf16 v[176:191], v[52:55], v[228:231], v[176:191]
  v_add_f32 v64, v64, v68
  v_add_f32 v65, v65, v69
  v_fmac_f32 v64, v72, v15
  v_fmac_f32 v65, v73, v15
  v_mov_b32 v41, 0
  s_waitcnt lgkmcnt(2)
  v_mfma_f32_32x32x16_bf16 v[128:143], v[56:59], v[232:235], v[128:143]
  ds_read_b64_tr_b16 v[48:49], v10 offset:53248
  ds_read_b64_tr_b16 v[50:51], v10 offset:53760
  v_mov_b32 v43, 0
  v_permlane16_swap_b32 v64, v65
  v_add_f32 v64, v64, v65
  v_mov_b32 v65, v64
  v_mfma_f32_32x32x16_bf16 v[144:159], v[56:59], v[236:239], v[144:159]
  v_lshrrev_b32 v66, 2, v16
  s_nop 0
  v_permlane32_swap_b32 v64, v65
  v_add_f32 v64, v64, v65
  v_cvt_pk_bf16_f32 v65, v64, v64
  s_waitcnt lgkmcnt(2)
  v_mfma_f32_32x32x16_bf16 v[160:175], v[60:63], v[232:235], v[160:175]
  ds_read_b64_tr_b16 v[52:53], v11 offset:53248
  ds_read_b64_tr_b16 v[54:55], v11 offset:53760
  v_and_b32 v65, 0xffff0000, v65
  v_sub_f32 v64, v64, v65
  v_cvt_pk_bf16_f32 v64, v65, v64
  v_cndmask_b32 v64, v64, 0, s[58:59]
  v_mfma_f32_32x32x16_bf16 v[176:191], v[60:63], v[236:239], v[176:191]
  s_lshl_b32 s3, s35, 9
  s_add_u32 s3, s3, 152576
  v_add_u32 v66, s3, v66
  s_lshl_b32 s3, s34, 8
  v_add_u32 v67, s3, v66
  s_waitcnt lgkmcnt(2)
  v_mfma_f32_32x32x16_bf16 v[128:143], v[48:51], v[240:243], v[128:143]
  ds_read_b64_tr_b16 v[56:57], v10 offset:55296
  ds_read_b64_tr_b16 v[58:59], v10 offset:55808
  ds_write_b32 v67, v64
  v_exp_f32 v100, v100
  v_mul_f32 v104, v104, v96
  v_mfma_f32_32x32x16_bf16 v[144:159], v[48:51], v[244:247], v[144:159]
  ds_read_b64_tr_b16 v[60:61], v11 offset:55296
  ds_read_b64_tr_b16 v[62:63], v11 offset:55808
  v_exp_f32 v101, v101
  v_mul_f32 v105, v105, v97
  s_waitcnt lgkmcnt(5)
  v_mfma_f32_32x32x16_bf16 v[160:175], v[52:55], v[240:243], v[160:175]
  v_exp_f32 v102, v102
  v_mul_f32 v106, v106, v98
  v_exp_f32 v103, v103
  v_mul_f32 v107, v107, v99
  v_mfma_f32_32x32x16_bf16 v[176:191], v[52:55], v[244:247], v[176:191]
  v_cvt_pk_bf16_f32 v96, v104, v105
  v_cvt_pk_bf16_f32 v97, v106, v107
  v_fma_f32 v100, v100, v46, v46
  v_fma_f32 v101, v101, v46, v46
  v_fma_f32 v102, v102, v46, v46
  s_waitcnt lgkmcnt(3)
  v_mfma_f32_32x32x16_bf16 v[128:143], v[56:59], v[248:251], v[128:143]
  s_waitcnt lgkmcnt(0)
  s_barrier
  ds_read_b64_tr_b16 v[48:49], v12 offset:0
  ds_read_b64_tr_b16 v[50:51], v12 offset:256
  v_fma_f32 v103, v103, v46, v46
  v_rcp_f32 v100, v100
  v_mfma_f32_32x32x16_bf16 v[144:159], v[56:59], v[252:255], v[144:159]
  v_rcp_f32 v101, v101
  v_rcp_f32 v102, v102
  v_mfma_f32_32x32x16_bf16 v[160:175], v[60:63], v[248:251], v[160:175]
  ds_read_b64_tr_b16 v[52:53], v12 offset:1024
  ds_read_b64_tr_b16 v[54:55], v12 offset:1280
  v_rcp_f32 v103, v103
  v_mul_f32 v108, v108, v100
  v_mul_f32 v109, v109, v101
  v_mfma_f32_32x32x16_bf16 v[176:191], v[60:63], v[252:255], v[176:191]
  v_mul_f32 v110, v110, v102
  v_mul_f32 v111, v111, v103
  v_cvt_pk_bf16_f32 v98, v108, v109
  v_cvt_pk_bf16_f32 v99, v110, v111
  buffer_store_dwordx4 v[96:99], v14, s[12:15], s50 offen offset:512 sc1
  s_and_b32 s96, s2, 3
  s_lshl_b32 s96, s96, 2
  s_bfe_u32 s98, s2, 0x20003
  s_add_u32 s96, s96, s98
  s_lshr_b32 s97, s2, 5
  s_lshl_b32 s98, s98, 1
  s_add_u32 s98, s98, s97
  s_mul_i32 s3, s97, 481280
  s_add_u32 s3, s3, 15728640
  s_add_u32 s92, s38, s3
  s_addc_u32 s93, s39, 0
  s_mov_b32 s94, 481280
  s_mov_b32 s95, 0x20000
  s_mul_i32 s3, s98, 43
  s_lshr_b32 s3, s3, 7
  s_mul_i32 s3, s3, 3
  s_sub_u32 s3, s98, s3
  v_add_u32 v24, s3, v1
  v_subrev_u32 v25, 3, v24
  v_cmp_gt_u32 vcc, 3, v24
  s_nop 1
  v_cndmask_b32 v13, v25, v24, vcc
  v_add_u32 v24, s98, v1
  v_and_b32 v24, 1, v24
  v_cmp_gt_u32 vcc, 3, v1
  s_nop 1
  v_cndmask_b32 v13, v24, v13, vcc
  s_mul_i32 s3, s98, 13
  s_lshr_b32 s3, s3, 6
  s_mul_i32 s3, s3, 5
  s_sub_u32 s3, s98, s3
  s_sub_u32 s3, s3, 5
  v_add_u32 v24, s3, v1
  v_subrev_u32 v25, 5, v24
  v_cmp_gt_u32 vcc, 5, v24
  s_nop 1
  v_cndmask_b32 v24, v25, v24, vcc
  v_subrev_u32 v26, 5, v1
  v_cmp_gt_u32 vcc, 5, v26
  s_nop 1
  v_cndmask_b32 v13, v13, v24, vcc
  v_lshlrev_b32 v13, 2, v13
  v_add_u32 v13, s24, v13
  v_and_b32 v24, 1, v13
  v_mad_u32_u24 v24, v13, 5, v24
  v_add_u32 v25, 2, v24
  v_cmp_gt_u32 vcc, 3, v1
  s_nop 1
  v_cndmask_b32 v24, v25, v24, vcc
  v_lshlrev_b32 v25, 1, v13
  v_add_u32 v25, 54, v25
  v_cmp_gt_u32 vcc, 5, v26
  s_nop 1
  v_cndmask_b32 v24, v24, v25, vcc
  v_add_u32 v25, 40, v24
  v_mul_u32_u24 v26, 10, v13
  v_subrev_u32 v26, 26, v26
  v_cmp_gt_u32 vcc, 3, v13
  s_nop 1
  v_cndmask_b32 v25, v26, v25, vcc
  v_cmp_gt_u32 vcc, 10, v1
  s_nop 1
  v_cndmask_b32 v24, v25, v24, vcc
  s_bfe_u32 s3, s2, 0x10002
  v_add_u32 v24, s3, v24
  v_mov_b32 v25, 0x10000
  v_cmp_eq_u32 vcc, 11, v13
  v_cmp_gt_u32 s[54:55], 3, v1
  s_and_b64 vcc, vcc, s[54:55]
  s_nop 0
  v_cndmask_b32 v13, v24, v25, vcc
  v_lshlrev_b32 v13, 10, v13
  ds_read_b32 v40, v66
  ds_read_b32 v42, v66 offset:256
  s_waitcnt lgkmcnt(0)
  s_nop 1
  v_mfma_f32_32x32x8_bf16 v[128:143], v[40:41], v[36:37], v[128:143]
  v_mfma_f32_32x32x8_bf16 v[144:159], v[40:41], v[38:39], v[144:159]
  v_mfma_f32_32x32x8_bf16 v[160:175], v[42:43], v[36:37], v[160:175]
  v_mfma_f32_32x32x8_bf16 v[176:191], v[42:43], v[38:39], v[176:191]
  v_mfma_f32_32x32x16_bf16 v[64:79], v[48:51], a[0:3], 0
  ds_read_b64_tr_b16 v[56:57], v12 offset:2048
  ds_read_b64_tr_b16 v[58:59], v12 offset:2304
  s_mul_i32 s3, s35, 2560
  s_sub_u32 s3, 20480, s3
  s_add_u32 s57, s57, s3
  v_mfma_f32_32x32x16_bf16 v[80:95], v[48:51], a[4:7], 0
  v_mfma_f32_32x32x16_bf16 v[64:79], v[52:55], a[8:11], v[64:79]
  ds_read_b64_tr_b16 v[60:61], v12 offset:3072
  ds_read_b64_tr_b16 v[62:63], v12 offset:3328
  v_mfma_f32_32x32x16_bf16 v[80:95], v[52:55], a[12:15], v[80:95]
  v_mul_f32 v20, v128, v128
  v_mul_f32 v21, v129, v129
  v_mul_f32 v22, v130, v130
  v_mul_f32 v23, v131, v131
  v_mul_f32 v136, v128, v136
  s_waitcnt lgkmcnt(2)
  v_mfma_f32_32x32x16_bf16 v[64:79], v[56:59], a[16:19], v[64:79]
  ds_read_b64_tr_b16 v[48:49], v12 offset:4096
  ds_read_b64_tr_b16 v[50:51], v12 offset:4352
  v_mul_f32 v137, v129, v137
  v_mul_f32 v138, v130, v138
  v_mul_f32 v139, v131, v139
  v_fma_f32 v20, v20, v45, v44
  v_mfma_f32_32x32x16_bf16 v[80:95], v[56:59], a[20:23], v[80:95]
  v_fma_f32 v21, v21, v45, v44
  v_fma_f32 v22, v22, v45, v44
  v_fma_f32 v23, v23, v45, v44
  v_mul_f32 v140, v132, v140
  v_mul_f32 v141, v133, v141
  s_waitcnt lgkmcnt(2)
  v_mfma_f32_32x32x16_bf16 v[64:79], v[60:63], a[24:27], v[64:79]
  ds_read_b64_tr_b16 v[52:53], v12 offset:5120
  ds_read_b64_tr_b16 v[54:55], v12 offset:5376
  v_mul_f32 v142, v134, v142
  v_mul_f32 v143, v135, v143
  v_mul_f32 v128, v128, v20
  v_mul_f32 v129, v129, v21
  v_mfma_f32_32x32x16_bf16 v[80:95], v[60:63], a[28:31], v[80:95]
  v_mul_f32 v130, v130, v22
  v_mul_f32 v131, v131, v23
  v_mul_f32 v20, v132, v132
  v_exp_f32 v128, v128
  s_waitcnt lgkmcnt(2)
  v_mfma_f32_32x32x16_bf16 v[64:79], v[48:51], a[32:35], v[64:79]
  ds_read_b64_tr_b16 v[56:57], v12 offset:6144
  ds_read_b64_tr_b16 v[58:59], v12 offset:6400
  v_mul_f32 v21, v133, v133
  v_exp_f32 v129, v129
  v_mul_f32 v22, v134, v134
  v_mfma_f32_32x32x16_bf16 v[80:95], v[48:51], a[36:39], v[80:95]
  ds_read_b64_tr_b16 v[60:61], v12 offset:7168
  ds_read_b64_tr_b16 v[62:63], v12 offset:7424
  v_exp_f32 v130, v130
  v_mul_f32 v23, v135, v135
  s_waitcnt lgkmcnt(4)
  v_mfma_f32_32x32x16_bf16 v[64:79], v[52:55], a[40:43], v[64:79]
  v_exp_f32 v131, v131
  v_fma_f32 v20, v20, v45, v44
  v_fma_f32 v21, v21, v45, v44
  v_fma_f32 v22, v22, v45, v44
  v_fma_f32 v23, v23, v45, v44
  v_mfma_f32_32x32x16_bf16 v[80:95], v[52:55], a[44:47], v[80:95]
  s_waitcnt vmcnt(0)
  v_fma_f32 v128, v128, v46, v46
  v_fma_f32 v129, v129, v46, v46
  v_fma_f32 v130, v130, v46, v46
  v_fma_f32 v131, v131, v46, v46
  s_waitcnt lgkmcnt(2)
  v_mfma_f32_32x32x16_bf16 v[64:79], v[56:59], a[48:51], v[64:79]
  s_waitcnt lgkmcnt(0)
  s_barrier
  ds_read_b64_tr_b16 v[48:49], v12 offset:16384
  ds_read_b64_tr_b16 v[50:51], v12 offset:16640
  v_mul_f32 v132, v132, v20
  v_rcp_f32 v128, v128
  v_mfma_f32_32x32x16_bf16 v[80:95], v[56:59], a[52:55], v[80:95]
  s_add_u32 m0, s27, 0
  s_mul_i32 s101, s63, 221184
  s_add_u32 s101, s101, s32
  buffer_load_dwordx4 v2, s[8:11], s101 offen offset:0 lds
  s_lshl_b32 s3, s25, 11
  s_lshl_b32 s54, s26, 2
  s_add_u32 s54, s54, s3
  s_add_u32 s54, s54, 720896
  s_cmp_eq_u32 s24, 0
  s_cselect_b32 s54, s54, 1073741824
  v_mov_b32 v24, s60
  v_mul_u32_u24 v25, 128, v1
  s_mov_b64 exec, 65535
  buffer_store_dword v24, v25, s[64:67], s54 offen sc1
  s_mov_b64 exec, -1
  v_mfma_f32_32x32x16_bf16 v[64:79], v[60:63], a[56:59], v[64:79]
  ds_read_b64_tr_b16 v[52:53], v12 offset:17408
  ds_read_b64_tr_b16 v[54:55], v12 offset:17664
  v_mfma_f32_32x32x16_bf16 v[80:95], v[60:63], a[60:63], v[80:95]
  s_waitcnt lgkmcnt(2)
  v_mfma_f32_32x32x16_bf16 v[64:79], v[48:51], a[64:67], v[64:79]
  ds_read_b64_tr_b16 v[56:57], v12 offset:18432
  ds_read_b64_tr_b16 v[58:59], v12 offset:18688
  v_mul_f32 v133, v133, v21
  v_rcp_f32 v129, v129
  v_mfma_f32_32x32x16_bf16 v[80:95], v[48:51], a[68:71], v[80:95]
  buffer_load_dwordx4 v3, s[8:11], s101 offen offset:1024 lds
  v_mul_f32 v134, v134, v22
  v_rcp_f32 v130, v130
  s_waitcnt lgkmcnt(2)
  v_mfma_f32_32x32x16_bf16 v[64:79], v[52:55], a[72:75], v[64:79]
  ds_read_b64_tr_b16 v[60:61], v12 offset:19456
  ds_read_b64_tr_b16 v[62:63], v12 offset:19712
  v_mul_f32 v135, v135, v23
  v_rcp_f32 v131, v131
  v_mfma_f32_32x32x16_bf16 v[80:95], v[52:55], a[76:79], v[80:95]
  v_exp_f32 v132, v132
  v_mul_f32 v136, v136, v128
  v_exp_f32 v133, v133
  s_waitcnt lgkmcnt(2)
  v_mfma_f32_32x32x16_bf16 v[64:79], v[56:59], a[80:83], v[64:79]
  ds_read_b64_tr_b16 v[48:49], v12 offset:20480
  ds_read_b64_tr_b16 v[50:51], v12 offset:20736
  v_readlane_b32 s99, v13, 0
  s_nop 3
  s_mul_i32 s99, s99, 5
  v_mfma_f32_32x32x16_bf16 v[80:95], v[56:59], a[84:87], v[80:95]
  buffer_load_dwordx4 v4, s[8:11], s101 offen offset:2048 lds
  s_add_u32 s63, s63, 2
  s_cmp_ge_u32 s63, 10
  s_cselect_b32 s3, 10, 0
  s_sub_u32 s63, s63, s3
  s_waitcnt lgkmcnt(2)
  v_mfma_f32_32x32x16_bf16 v[64:79], v[60:63], a[88:91], v[64:79]
  ds_read_b64_tr_b16 v[52:53], v12 offset:21504
  ds_read_b64_tr_b16 v[54:55], v12 offset:21760
  v_mul_f32 v137, v137, v129
  v_exp_f32 v134, v134
  v_mul_f32 v138, v138, v130
  v_mfma_f32_32x32x16_bf16 v[80:95], v[60:63], a[92:95], v[80:95]
  buffer_load_dwordx4 a[0:3], v16, s[92:95], s99 offen offset:0 sc1
  v_readlane_b32 s100, v13, 1
  v_exp_f32 v135, v135
  s_waitcnt lgkmcnt(2)
  v_mfma_f32_32x32x16_bf16 v[64:79], v[48:51], a[96:99], v[64:79]
  ds_read_b64_tr_b16 v[56:57], v12 offset:22528
  ds_read_b64_tr_b16 v[58:59], v12 offset:22784
  v_mul_f32 v139, v139, v131
  v_cvt_pk_bf16_f32 v128, v136, v137
  v_cvt_pk_bf16_f32 v129, v138, v139
  v_fma_f32 v132, v132, v46, v46
  v_mfma_f32_32x32x16_bf16 v[80:95], v[48:51], a[100:103], v[80:95]
  ds_read_b64_tr_b16 v[60:61], v12 offset:23552
  ds_read_b64_tr_b16 v[62:63], v12 offset:23808
  buffer_load_dwordx4 v5, s[8:11], s101 offen offset:3072 lds
  v_fma_f32 v133, v133, v46, v46
  s_waitcnt lgkmcnt(4)
  v_mfma_f32_32x32x16_bf16 v[64:79], v[52:55], a[104:107], v[64:79]
  buffer_load_dwordx4 a[4:7], v16, s[92:95], s99 offen offset:1024 sc1
  v_fma_f32 v134, v134, v46, v46
  v_fma_f32 v135, v135, v46, v46
  v_rcp_f32 v132, v132
  v_mfma_f32_32x32x16_bf16 v[80:95], v[52:55], a[108:111], v[80:95]
  v_rcp_f32 v133, v133
  v_rcp_f32 v134, v134
  v_rcp_f32 v135, v135
  s_waitcnt lgkmcnt(2)
  v_mfma_f32_32x32x16_bf16 v[64:79], v[56:59], a[112:115], v[64:79]
  s_waitcnt lgkmcnt(0)
  s_barrier
  ds_read_b64_tr_b16 v[48:49], v12 offset:32768
  ds_read_b64_tr_b16 v[50:51], v12 offset:33024
  v_mul_f32 v140, v140, v132
  v_mfma_f32_32x32x16_bf16 v[80:95], v[56:59], a[116:119], v[80:95]
  buffer_load_dwordx4 a[8:11], v16, s[92:95], s99 offen offset:2048 sc1
  s_mul_i32 s100, s100, 5
  v_mul_f32 v141, v141, v133
  v_mul_f32 v142, v142, v134
  v_mfma_f32_32x32x16_bf16 v[64:79], v[60:63], a[120:123], v[64:79]
  ds_read_b64_tr_b16 v[52:53], v12 offset:33792
  ds_read_b64_tr_b16 v[54:55], v12 offset:34048
  v_mul_f32 v143, v143, v135
  v_cvt_pk_bf16_f32 v130, v140, v141
  v_cvt_pk_bf16_f32 v131, v142, v143
  buffer_store_dwordx4 v[128:131], v14, s[12:15], s51 offen offset:0 sc1
  v_mfma_f32_32x32x16_bf16 v[80:95], v[60:63], a[124:127], v[80:95]
  s_add_u32 s54, s57, 0
  buffer_load_dwordx4 v[96:99], v16, s[64:67], s54 offen offset:0 sc1
  s_waitcnt lgkmcnt(2)
  v_mfma_f32_32x32x16_bf16 v[64:79], v[48:51], a[128:131], v[64:79]
  ds_read_b64_tr_b16 v[56:57], v12 offset:34816
  ds_read_b64_tr_b16 v[58:59], v12 offset:35072
  buffer_load_dwordx4 a[12:15], v16, s[92:95], s99 offen offset:3072 sc1
  s_add_u32 s54, s57, 0
  buffer_load_dwordx4 v[100:103], v16, s[64:67], s54 offen offset:1024 sc1
  v_mfma_f32_32x32x16_bf16 v[80:95], v[48:51], a[132:135], v[80:95]
  s_add_u32 s54, s57, 0
  buffer_load_dwordx4 v[104:107], v17, s[64:67], s54 offen offset:0 sc1
  s_waitcnt lgkmcnt(2)
  v_mfma_f32_32x32x16_bf16 v[64:79], v[52:55], a[136:139], v[64:79]
  ds_read_b64_tr_b16 v[60:61], v12 offset:35840
  ds_read_b64_tr_b16 v[62:63], v12 offset:36096
  v_mul_f32 v20, v144, v144
  v_mfma_f32_32x32x16_bf16 v[80:95], v[52:55], a[140:143], v[80:95]
  s_add_u32 s99, s99, 4096
  buffer_load_dwordx4 a[16:19], v16, s[92:95], s99 offen offset:0 sc1
  v_mul_f32 v21, v145, v145
  v_mul_f32 v22, v146, v146
  s_waitcnt lgkmcnt(2)
  v_mfma_f32_32x32x16_bf16 v[64:79], v[56:59], a[144:147], v[64:79]
  ds_read_b64_tr_b16 v[48:49], v12 offset:36864
  ds_read_b64_tr_b16 v[50:51], v12 offset:37120
  v_mul_f32 v23, v147, v147
  v_mul_f32 v152, v144, v152
  v_mul_f32 v153, v145, v153
  v_mul_f32 v154, v146, v154
  v_mfma_f32_32x32x16_bf16 v[80:95], v[56:59], a[148:151], v[80:95]
  v_mul_f32 v155, v147, v155
  v_fma_f32 v20, v20, v18, v47
  v_fma_f32 v21, v21, v18, v47
  v_fma_f32 v22, v22, v18, v47
  v_fma_f32 v23, v23, v18, v47
  s_waitcnt lgkmcnt(2)
  v_mfma_f32_32x32x16_bf16 v[64:79], v[60:63], a[152:155], v[64:79]
  ds_read_b64_tr_b16 v[52:53], v12 offset:37888
  ds_read_b64_tr_b16 v[54:55], v12 offset:38144
  buffer_load_dwordx4 a[20:23], v16, s[92:95], s100 offen offset:0 sc1
  v_readlane_b32 s99, v13, 2
  v_mul_f32 v156, v148, v156
  v_mfma_f32_32x32x16_bf16 v[80:95], v[60:63], a[156:159], v[80:95]
  v_mul_f32 v157, v149, v157
  v_mul_f32 v158, v150, v158
  v_mul_f32 v159, v151, v159
  v_mul_f32 v144, v144, v20
  v_mul_f32 v145, v145, v21
  s_waitcnt lgkmcnt(2)
  v_mfma_f32_32x32x16_bf16 v[64:79], v[48:51], a[160:163], v[64:79]
  ds_read_b64_tr_b16 v[56:57], v12 offset:38912
  ds_read_b64_tr_b16 v[58:59], v12 offset:39168
  v_mul_f32 v146, v146, v22
  v_mul_f32 v147, v147, v23
  v_mul_f32 v20, v148, v148
  v_exp_f32 v144, v144
  v_mfma_f32_32x32x16_bf16 v[80:95], v[48:51], a[164:167], v[80:95]
  ds_read_b64_tr_b16 v[60:61], v12 offset:39936
  ds_read_b64_tr_b16 v[62:63], v12 offset:40192
  buffer_load_dwordx4 a[24:27], v16, s[92:95], s100 offen offset:1024 sc1
  s_waitcnt lgkmcnt(4)
  v_mfma_f32_32x32x16_bf16 v[64:79], v[52:55], a[168:171], v[64:79]
  v_mul_f32 v21, v149, v149
  v_exp_f32 v145, v145
  v_mul_f32 v22, v150, v150
  v_exp_f32 v146, v146
  v_mfma_f32_32x32x16_bf16 v[80:95], v[52:55], a[172:175], v[80:95]
  v_mul_f32 v23, v151, v151
  v_exp_f32 v147, v147
  v_fma_f32 v20, v20, v18, v47
  v_fma_f32 v21, v21, v18, v47
  s_waitcnt lgkmcnt(2)
  v_mfma_f32_32x32x16_bf16 v[64:79], v[56:59], a[176:179], v[64:79]
  s_waitcnt lgkmcnt(0)
  s_barrier
  ds_read_b64_tr_b16 v[48:49], v12 offset:49152
  ds_read_b64_tr_b16 v[50:51], v12 offset:49408
  buffer_load_dwordx4 a[28:31], v16, s[92:95], s100 offen offset:2048 sc1
  s_mul_i32 s99, s99, 5
  v_mfma_f32_32x32x16_bf16 v[80:95], v[56:59], a[180:183], v[80:95]
  v_fma_f32 v22, v22, v18, v47
  v_fma_f32 v23, v23, v18, v47
  v_fma_f32 v144, v144, v19, v19
  v_fma_f32 v145, v145, v19, v19
  v_mfma_f32_32x32x16_bf16 v[64:79], v[60:63], a[184:187], v[64:79]
  ds_read_b64_tr_b16 v[52:53], v12 offset:50176
  ds_read_b64_tr_b16 v[54:55], v12 offset:50432
  v_fma_f32 v146, v146, v19, v19
  v_fma_f32 v147, v147, v19, v19
  v_mul_f32 v148, v148, v20
  v_rcp_f32 v144, v144
  v_mfma_f32_32x32x16_bf16 v[80:95], v[60:63], a[188:191], v[80:95]
  buffer_load_dwordx4 a[32:35], v16, s[92:95], s100 offen offset:3072 sc1
  v_mul_f32 v149, v149, v21
  v_rcp_f32 v145, v145
  s_waitcnt lgkmcnt(2)
  v_mfma_f32_32x32x16_bf16 v[64:79], v[48:51], a[192:195], v[64:79]
  ds_read_b64_tr_b16 v[56:57], v12 offset:51200
  ds_read_b64_tr_b16 v[58:59], v12 offset:51456
  v_mul_f32 v150, v150, v22
  v_rcp_f32 v146, v146
  v_mfma_f32_32x32x16_bf16 v[80:95], v[48:51], a[196:199], v[80:95]
  v_mul_f32 v151, v151, v23
  v_rcp_f32 v147, v147
  v_exp_f32 v148, v148
  s_waitcnt lgkmcnt(2)
  v_mfma_f32_32x32x16_bf16 v[64:79], v[52:55], a[200:203], v[64:79]
  ds_read_b64_tr_b16 v[60:61], v12 offset:52224
  ds_read_b64_tr_b16 v[62:63], v12 offset:52480
  s_add_u32 s100, s100, 4096
  buffer_load_dwordx4 a[36:39], v16, s[92:95], s100 offen offset:0 sc1
  v_mul_f32 v152, v152, v144
  v_mfma_f32_32x32x16_bf16 v[80:95], v[52:55], a[204:207], v[80:95]
  v_exp_f32 v149, v149
  v_mul_f32 v153, v153, v145
  v_exp_f32 v150, v150
  s_waitcnt lgkmcnt(2)
  v_mfma_f32_32x32x16_bf16 v[64:79], v[56:59], a[208:211], v[64:79]
  ds_read_b64_tr_b16 v[48:49], v12 offset:53248
  ds_read_b64_tr_b16 v[50:51], v12 offset:53504
  v_mul_f32 v154, v154, v146
  v_exp_f32 v151, v151
  v_mul_f32 v155, v155, v147
  v_mfma_f32_32x32x16_bf16 v[80:95], v[56:59], a[212:215], v[80:95]
  buffer_load_dwordx4 a[40:43], v16, s[92:95], s99 offen offset:0 sc1
  v_readlane_b32 s100, v13, 3
  v_cvt_pk_bf16_f32 v144, v152, v153
  v_cvt_pk_bf16_f32 v145, v154, v155
  s_waitcnt lgkmcnt(2)
  v_mfma_f32_32x32x16_bf16 v[64:79], v[60:63], a[216:219], v[64:79]
  ds_read_b64_tr_b16 v[52:53], v12 offset:54272
  ds_read_b64_tr_b16 v[54:55], v12 offset:54528
  v_fma_f32 v148, v148, v19, v19
  v_fma_f32 v149, v149, v19, v19
  v_fma_f32 v150, v150, v19, v19
  v_fma_f32 v151, v151, v19, v19
  v_mfma_f32_32x32x16_bf16 v[80:95], v[60:63], a[220:223], v[80:95]
  v_rcp_f32 v148, v148
  v_rcp_f32 v149, v149
  v_rcp_f32 v150, v150
  s_waitcnt lgkmcnt(2)
  v_mfma_f32_32x32x16_bf16 v[64:79], v[48:51], a[224:227], v[64:79]
  ds_read_b64_tr_b16 v[56:57], v12 offset:55296
  ds_read_b64_tr_b16 v[58:59], v12 offset:55552
  buffer_load_dwordx4 a[44:47], v16, s[92:95], s99 offen offset:1024 sc1
  v_rcp_f32 v151, v151
  v_mfma_f32_32x32x16_bf16 v[80:95], v[48:51], a[228:231], v[80:95]
  ds_read_b64_tr_b16 v[60:61], v12 offset:56320
  ds_read_b64_tr_b16 v[62:63], v12 offset:56576
  v_mul_f32 v156, v156, v148
  v_mul_f32 v157, v157, v149
  v_mul_f32 v158, v158, v150
  s_waitcnt lgkmcnt(4)
  v_mfma_f32_32x32x16_bf16 v[64:79], v[52:55], a[232:235], v[64:79]
  v_mul_f32 v159, v159, v151
  v_cvt_pk_bf16_f32 v146, v156, v157
  v_cvt_pk_bf16_f32 v147, v158, v159
  buffer_store_dwordx4 v[144:147], v14, s[12:15], s51 offen offset:2048 sc1
  s_waitcnt vmcnt(9)
  s_mov_b32 s62, 0
L_CHK8:
  v_bitop3_b32 v98, v96, v97, v98 bitop3:0x96
  v_bitop3_b32 v102, v100, v101, v102 bitop3:0x96
  v_bitop3_b32 v106, v104, v105, v106 bitop3:0x96
  v_cmp_ne_u64 s[54:55], s[60:61], v[98:99]
  v_cmp_ne_u64 vcc, s[60:61], v[102:103]
  s_or_b64 s[54:55], s[54:55], vcc
  v_cmp_ne_u64 vcc, s[60:61], v[106:107]
  s_or_b64 vcc, s[54:55], vcc
  s_cbranch_vccz L_OK8
  s_add_u32 s62, s62, 1
  s_cmp_lt_u32 s62, 0x40000
  s_cbranch_scc0 L_OK8
  s_sleep 2
  s_add_u32 s54, s57, 0
  buffer_load_dwordx4 v[96:99], v16, s[64:67], s54 offen offset:0 sc1
  s_add_u32 s54, s57, 0
  buffer_load_dwordx4 v[100:103], v16, s[64:67], s54 offen offset:1024 sc1
  s_add_u32 s54, s57, 0
  buffer_load_dwordx4 v[104:107], v17, s[64:67], s54 offen offset:0 sc1
  s_waitcnt vmcnt(0)
  s_branch L_CHK8
L_OK8:
  v_mfma_f32_32x32x16_bf16 v[80:95], v[52:55], a[236:239], v[80:95]
  buffer_load_dwordx4 a[48:51], v16, s[92:95], s99 offen offset:2048 sc1
  s_mul_i32 s100, s100, 5
  s_waitcnt lgkmcnt(2)
  v_mfma_f32_32x32x16_bf16 v[64:79], v[56:59], a[240:243], v[64:79]
  s_waitcnt lgkmcnt(0)
  s_barrier
  ds_read_b64_tr_b16 v[48:49], v12 offset:0
  ds_read_b64_tr_b16 v[50:51], v12 offset:256
  v_mfma_f32_32x32x16_bf16 v[80:95], v[56:59], a[244:247], v[80:95]
  v_add_f32 v96, v96, v100
  v_add_f32 v97, v97, v101
  v_fmac_f32 v96, v104, v15
  v_fmac_f32 v97, v105, v15
  v_mov_b32 v41, 0
  v_mfma_f32_32x32x16_bf16 v[64:79], v[60:63], a[248:251], v[64:79]
  ds_read_b64_tr_b16 v[52:53], v12 offset:1024
  ds_read_b64_tr_b16 v[54:55], v12 offset:1280
  buffer_load_dwordx4 a[52:55], v16, s[92:95], s99 offen offset:3072 sc1
  v_mov_b32 v43, 0
  v_permlane16_swap_b32 v96, v97
  v_mfma_f32_32x32x16_bf16 v[80:95], v[60:63], a[252:255], v[80:95]
  v_add_f32 v96, v96, v97
  v_mov_b32 v97, v96
  v_lshrrev_b32 v98, 2, v16
  s_nop 0
  v_permlane32_swap_b32 v96, v97
  s_waitcnt lgkmcnt(2)
  v_mfma_f32_32x32x16_bf16 v[64:79], v[48:51], v[192:195], v[64:79]
  ds_read_b64_tr_b16 v[56:57], v12 offset:2048
  ds_read_b64_tr_b16 v[58:59], v12 offset:2304
  v_add_f32 v96, v96, v97
  v_cvt_pk_bf16_f32 v97, v96, v96
  v_and_b32 v97, 0xffff0000, v97
  v_sub_f32 v96, v96, v97
  v_mfma_f32_32x32x16_bf16 v[80:95], v[48:51], v[196:199], v[80:95]
  s_add_u32 s99, s99, 4096
  buffer_load_dwordx4 a[56:59], v16, s[92:95], s99 offen offset:0 sc1
  v_cvt_pk_bf16_f32 v96, v97, v96
  v_cndmask_b32 v40, v96, 0, s[58:59]
  s_waitcnt lgkmcnt(2)
  v_mfma_f32_32x32x16_bf16 v[64:79], v[52:55], v[200:203], v[64:79]
  ds_read_b64_tr_b16 v[60:61], v12 offset:3072
  ds_read_b64_tr_b16 v[62:63], v12 offset:3328
  s_load_dwordx2 s[6:7], s[0:1], 0
  s_load_dwordx2 s[4:5], s[0:1], 64
  s_load_dwordx2 s[34:35], s[0:1], 104
  s_bfe_u32 s53, s2, 0x10002
  s_lshl_b32 s3, s96, 3
  s_add_u32 s57, s3, s97
  s_lshl_b32 s3, s57, 1
  s_add_u32 s3, s3, s53
  s_lshl_b32 s3, s3, 7
  s_add_u32 s56, s3, 32768
  s_cmp_eq_u32 s24, 0
  s_cselect_b32 s36, s56, 1073741824
  v_and_b32 v28, 15, v1
  v_lshlrev_b32 v28, 2, v28
  s_add_u32 s3, s56, 688128
  buffer_load_dword v29, v28, s[64:67], s3 offen sc1
  s_lshl_b32 s55, s96, 1
  s_mul_i32 s55, s55, 385024
  s_add_u32 s55, s55, 3145728
  s_add_u32 s8, s38, s55
  s_addc_u32 s9, s39, 0
  s_mov_b32 s10, 770048
  s_mov_b32 s11, 0x20000
  s_mul_i32 s49, s53, 385024
  s_sub_u32 s48, 385024, s49
  v_readlane_b32 s40, v13, 0
  s_nop 1
  s_lshl_b32 s40, s40, 2
  s_add_u32 s40, s40, s48
  v_readlane_b32 s41, v13, 1
  s_nop 1
  s_lshl_b32 s41, s41, 2
  s_add_u32 s41, s41, s48
  v_readlane_b32 s42, v13, 2
  s_nop 1
  s_lshl_b32 s42, s42, 2
  s_add_u32 s42, s42, s48
  v_readlane_b32 s43, v13, 0
  s_nop 1
  s_lshl_b32 s43, s43, 2
  s_add_u32 s43, s43, s49
  v_mfma_f32_32x32x16_bf16 v[80:95], v[52:55], v[204:207], v[80:95]
  s_waitcnt lgkmcnt(2)
  v_mfma_f32_32x32x16_bf16 v[64:79], v[56:59], v[208:211], v[64:79]
  ds_read_b64_tr_b16 v[48:49], v12 offset:4096
  ds_read_b64_tr_b16 v[50:51], v12 offset:4352
  buffer_load_dwordx4 a[60:63], v16, s[92:95], s100 offen offset:0 sc1
  v_readlane_b32 s99, v13, 4
  v_mfma_f32_32x32x16_bf16 v[80:95], v[56:59], v[212:215], v[80:95]
  v_mul_f32 v20, v160, v160
  s_waitcnt lgkmcnt(2)
  v_mfma_f32_32x32x16_bf16 v[64:79], v[60:63], v[216:219], v[64:79]
  ds_read_b64_tr_b16 v[52:53], v12 offset:5120
  ds_read_b64_tr_b16 v[54:55], v12 offset:5376
  v_mul_f32 v21, v161, v161
  v_mul_f32 v22, v162, v162
  v_mul_f32 v23, v163, v163
  v_mul_f32 v168, v160, v168
  v_mfma_f32_32x32x16_bf16 v[80:95], v[60:63], v[220:223], v[80:95]
  buffer_load_dwordx4 a[64:67], v16, s[92:95], s100 offen offset:1024 sc1
  v_mul_f32 v169, v161, v169
  v_mul_f32 v170, v162, v170
  v_mul_f32 v171, v163, v171
  s_waitcnt lgkmcnt(2)
  v_mfma_f32_32x32x16_bf16 v[64:79], v[48:51], v[224:227], v[64:79]
  ds_read_b64_tr_b16 v[56:57], v12 offset:6144
  ds_read_b64_tr_b16 v[58:59], v12 offset:6400
  v_fma_f32 v20, v20, v45, v44
  v_fma_f32 v21, v21, v45, v44
  v_fma_f32 v22, v22, v45, v44
  v_fma_f32 v23, v23, v45, v44
  v_mfma_f32_32x32x16_bf16 v[80:95], v[48:51], v[228:231], v[80:95]
  ds_read_b64_tr_b16 v[60:61], v12 offset:7168
  ds_read_b64_tr_b16 v[62:63], v12 offset:7424
  v_mul_f32 v172, v164, v172
  v_mul_f32 v173, v165, v173
  v_mul_f32 v174, v166, v174
  s_waitcnt lgkmcnt(4)
  v_mfma_f32_32x32x16_bf16 v[64:79], v[52:55], v[232:235], v[64:79]
  buffer_load_dwordx4 a[68:71], v16, s[92:95], s100 offen offset:2048 sc1
  s_mul_i32 s99, s99, 5
  v_mul_f32 v175, v167, v175
  v_mul_f32 v160, v160, v20
  v_mul_f32 v161, v161, v21
  v_mfma_f32_32x32x16_bf16 v[80:95], v[52:55], v[236:239], v[80:95]
  v_mul_f32 v162, v162, v22
  v_mul_f32 v163, v163, v23
  v_mul_f32 v20, v164, v164
  v_exp_f32 v160, v160
  s_waitcnt lgkmcnt(2)
  v_mfma_f32_32x32x16_bf16 v[64:79], v[56:59], v[240:243], v[64:79]
  v_mul_f32 v21, v165, v165
  v_exp_f32 v161, v161
  v_mul_f32 v22, v166, v166
  v_exp_f32 v162, v162
  v_mfma_f32_32x32x16_bf16 v[80:95], v[56:59], v[244:247], v[80:95]
  buffer_load_dwordx4 a[72:75], v16, s[92:95], s100 offen offset:3072 sc1
  v_mul_f32 v23, v167, v167
  v_exp_f32 v163, v163
  s_waitcnt lgkmcnt(0)
  v_mfma_f32_32x32x16_bf16 v[64:79], v[60:63], v[248:251], v[64:79]
  v_fma_f32 v20, v20, v45, v44
  v_fma_f32 v21, v21, v45, v44
  v_fma_f32 v22, v22, v45, v44
  v_fma_f32 v23, v23, v45, v44
  v_fma_f32 v160, v160, v46, v46
  v_fma_f32 v161, v161, v46, v46
  v_mfma_f32_32x32x16_bf16 v[80:95], v[60:63], v[252:255], v[80:95]
  v_fma_f32 v162, v162, v46, v46
  v_fma_f32 v163, v163, v46, v46
  v_mul_f32 v164, v164, v20
  v_rcp_f32 v160, v160
  v_mul_f32 v165, v165, v21
  s_nop 1
  v_mfma_f32_32x32x8_bf16 v[64:79], v[40:41], v[36:37], v[64:79]
  v_mfma_f32_32x32x8_bf16 v[80:95], v[40:41], v[38:39], v[80:95]
  v_rcp_f32 v161, v161
  v_mul_f32 v166, v166, v22
  v_rcp_f32 v162, v162
  v_mul_f32 v167, v167, v23
  v_rcp_f32 v163, v163
  v_exp_f32 v164, v164
  v_mul_f32 v168, v168, v160
  v_exp_f32 v165, v165
  v_mul_f32 v169, v169, v161
  s_add_u32 s100, s100, 4096
  buffer_load_dwordx4 a[76:79], v16, s[92:95], s100 offen offset:0 sc1
  v_exp_f32 v166, v166
  v_mul_f32 v170, v170, v162
  v_exp_f32 v167, v167
  v_mul_f32 v171, v171, v163
  v_cvt_pk_bf16_f32 v160, v168, v169
  v_cvt_pk_bf16_f32 v161, v170, v171
  v_fma_f32 v164, v164, v46, v46
  v_fma_f32 v165, v165, v46, v46
  v_fma_f32 v166, v166, v46, v46
  buffer_load_dwordx4 a[80:83], v16, s[92:95], s99 offen offset:0 sc1
  v_readlane_b32 s100, v13, 10
  v_fma_f32 v167, v167, v46, v46
  v_rcp_f32 v164, v164
  v_rcp_f32 v165, v165
  v_rcp_f32 v166, v166
  v_rcp_f32 v167, v167
  v_mul_f32 v172, v172, v164
  v_mul_f32 v173, v173, v165
  v_mul_f32 v174, v174, v166
  v_mul_f32 v175, v175, v167
  buffer_load_dwordx4 a[84:87], v16, s[92:95], s99 offen offset:1024 sc1
  v_cvt_pk_bf16_f32 v162, v172, v173
  v_cvt_pk_bf16_f32 v163, v174, v175
  buffer_store_dwordx4 v[160:163], v14, s[12:15], s51 offen offset:512 sc1
  v_mul_f32 v20, v176, v176
  v_mul_f32 v21, v177, v177
  v_mul_f32 v22, v178, v178
  v_mul_f32 v23, v179, v179
  v_mul_f32 v184, v176, v184
  v_mul_f32 v185, v177, v185
  buffer_load_dwordx4 a[88:91], v16, s[92:95], s99 offen offset:2048 sc1
  s_mul_i32 s100, s100, 5
  v_mul_f32 v186, v178, v186
  v_mul_f32 v187, v179, v187
  v_fma_f32 v20, v20, v18, v47
  v_fma_f32 v21, v21, v18, v47
  v_fma_f32 v22, v22, v18, v47
  v_fma_f32 v23, v23, v18, v47
  v_mul_f32 v188, v180, v188
  v_mul_f32 v189, v181, v189
  v_mul_f32 v190, v182, v190
  buffer_load_dwordx4 a[92:95], v16, s[92:95], s99 offen offset:3072 sc1
  v_mul_f32 v191, v183, v191
  v_mul_f32 v176, v176, v20
  v_mul_f32 v177, v177, v21
  v_mul_f32 v178, v178, v22
  v_mul_f32 v179, v179, v23
  v_mul_f32 v20, v180, v180
  v_exp_f32 v176, v176
  v_mul_f32 v21, v181, v181
  v_exp_f32 v177, v177
  s_add_u32 s99, s99, 4096
  buffer_load_dwordx4 a[96:99], v16, s[92:95], s99 offen offset:0 sc1
  v_mul_f32 v22, v182, v182
  v_exp_f32 v178, v178
  v_mul_f32 v23, v183, v183
  v_exp_f32 v179, v179
  v_fma_f32 v20, v20, v18, v47
  v_fma_f32 v21, v21, v18, v47
  v_fma_f32 v22, v22, v18, v47
  v_fma_f32 v23, v23, v18, v47
  v_fma_f32 v176, v176, v19, v19
  buffer_load_dwordx4 a[200:203], v16, s[92:95], s100 offen offset:0 sc1
  v_fma_f32 v177, v177, v19, v19
  v_fma_f32 v178, v178, v19, v19
  v_fma_f32 v179, v179, v19, v19
  v_mul_f32 v180, v180, v20
  v_rcp_f32 v176, v176
  v_mul_f32 v181, v181, v21
  v_rcp_f32 v177, v177
  v_mul_f32 v182, v182, v22
  v_rcp_f32 v178, v178
  buffer_load_dwordx4 a[204:207], v16, s[92:95], s100 offen offset:1024 sc1
  v_mul_f32 v183, v183, v23
  v_rcp_f32 v179, v179
  v_exp_f32 v180, v180
  v_mul_f32 v184, v184, v176
  v_exp_f32 v181, v181
  v_mul_f32 v185, v185, v177
  v_exp_f32 v182, v182
  v_mul_f32 v186, v186, v178
  v_exp_f32 v183, v183
  buffer_load_dwordx4 a[208:211], v16, s[92:95], s100 offen offset:2048 sc1
  v_mul_f32 v187, v187, v179
  v_cvt_pk_bf16_f32 v176, v184, v185
  v_cvt_pk_bf16_f32 v177, v186, v187
  v_fma_f32 v180, v180, v19, v19
  v_fma_f32 v181, v181, v19, v19
  v_fma_f32 v182, v182, v19, v19
  v_fma_f32 v183, v183, v19, v19
  v_rcp_f32 v180, v180
  v_rcp_f32 v181, v181
  buffer_load_dwordx4 a[212:215], v16, s[92:95], s100 offen offset:3072 sc1
  v_rcp_f32 v182, v182
  v_rcp_f32 v183, v183
  v_mul_f32 v188, v188, v180
  v_mul_f32 v189, v189, v181
  v_mul_f32 v190, v190, v182
  v_mul_f32 v191, v191, v183
  v_cvt_pk_bf16_f32 v178, v188, v189
  v_cvt_pk_bf16_f32 v179, v190, v191
  buffer_store_dwordx4 v[176:179], v14, s[12:15], s51 offen offset:2560 sc1
  s_add_u32 s100, s100, 4096
  buffer_load_dwordx4 a[216:219], v16, s[92:95], s100 offen offset:0 sc1
  s_waitcnt vmcnt(17)
  s_mov_b32 s62, 0
L_CHK9:
  v_cmp_ne_u32 vcc, s60, v29
  s_and_b64 vcc, vcc, 0x7ff
  s_cbranch_vccz L_OK9
  s_add_u32 s62, s62, 1
  s_cmp_lt_u32 s62, 0x40000
  s_cbranch_scc0 L_OK9
  s_sleep 2
  s_add_u32 s3, s56, 688128
  buffer_load_dword v29, v28, s[64:67], s3 offen sc1
  s_waitcnt vmcnt(0)
  s_branch L_CHK9
L_OK9:
  v_mul_f32 v20, v64, v64
  v_mul_f32 v21, v65, v65
  v_mul_f32 v22, v66, v66
  v_mul_f32 v23, v67, v67
  v_mul_f32 v72, v64, v72
  v_mul_f32 v73, v65, v73
  v_mul_f32 v74, v66, v74
  v_mul_f32 v75, v67, v75
  v_fma_f32 v20, v20, v45, v44
  buffer_load_dwordx4 a[160:163], v16, s[8:11], s40 offen offset:0 sc1
  v_fma_f32 v21, v21, v45, v44
  v_fma_f32 v22, v22, v45, v44
  v_fma_f32 v23, v23, v45, v44
  v_mul_f32 v76, v68, v76
  v_mul_f32 v77, v69, v77
  v_mul_f32 v78, v70, v78
  v_mul_f32 v79, v71, v79
  v_mul_f32 v64, v64, v20
  v_mul_f32 v65, v65, v21
  buffer_load_dwordx4 a[164:167], v16, s[8:11], s40 offen offset:1024 sc1
  v_mul_f32 v66, v66, v22
  v_mul_f32 v67, v67, v23
  v_mul_f32 v20, v68, v68
  v_exp_f32 v64, v64
  v_mul_f32 v21, v69, v69
  v_exp_f32 v65, v65
  v_mul_f32 v22, v70, v70
  v_exp_f32 v66, v66
  v_mul_f32 v23, v71, v71
  buffer_load_dwordx4 a[168:171], v16, s[8:11], s40 offen offset:2048 sc1
  v_exp_f32 v67, v67
  v_fma_f32 v20, v20, v45, v44
  v_fma_f32 v21, v21, v45, v44
  v_fma_f32 v22, v22, v45, v44
  v_fma_f32 v23, v23, v45, v44
  v_fma_f32 v64, v64, v46, v46
  v_fma_f32 v65, v65, v46, v46
  v_fma_f32 v66, v66, v46, v46
  v_fma_f32 v67, v67, v46, v46
  buffer_load_dwordx4 a[172:175], v16, s[8:11], s40 offen offset:3072 sc1
  v_readlane_b32 s40, v13, 1
  s_nop 1
  s_lshl_b32 s40, s40, 2
  s_add_u32 s40, s40, s49
  v_mul_f32 v68, v68, v20
  v_rcp_f32 v64, v64
  v_mul_f32 v69, v69, v21
  v_rcp_f32 v65, v65
  v_mul_f32 v70, v70, v22
  v_rcp_f32 v66, v66
  v_mul_f32 v71, v71, v23
  v_rcp_f32 v67, v67
  v_exp_f32 v68, v68
  buffer_load_dwordx4 a[176:179], v16, s[8:11], s41 offen offset:0 sc1
  v_mul_f32 v72, v72, v64
  v_exp_f32 v69, v69
  v_mul_f32 v73, v73, v65
  v_exp_f32 v70, v70
  v_mul_f32 v74, v74, v66
  v_exp_f32 v71, v71
  v_mul_f32 v75, v75, v67
  v_cvt_pk_bf16_f32 v64, v72, v73
  v_cvt_pk_bf16_f32 v65, v74, v75
  buffer_load_dwordx4 a[180:183], v16, s[8:11], s41 offen offset:1024 sc1
  v_fma_f32 v68, v68, v46, v46
  v_fma_f32 v69, v69, v46, v46
  v_fma_f32 v70, v70, v46, v46
  v_fma_f32 v71, v71, v46, v46
  v_rcp_f32 v68, v68
  v_rcp_f32 v69, v69
  v_rcp_f32 v70, v70
  v_rcp_f32 v71, v71
  v_mul_f32 v76, v76, v68
  buffer_load_dwordx4 a[184:187], v16, s[8:11], s41 offen offset:2048 sc1
  v_mul_f32 v77, v77, v69
  v_mul_f32 v78, v78, v70
  v_mul_f32 v79, v79, v71
  v_cvt_pk_bf16_f32 v66, v76, v77
  v_cvt_pk_bf16_f32 v67, v78, v79
  v_mul_f32 v20, v80, v80
  v_mul_f32 v21, v81, v81
  v_mul_f32 v22, v82, v82
  v_mul_f32 v23, v83, v83
  buffer_load_dwordx4 a[188:191], v16, s[8:11], s41 offen offset:3072 sc1
  v_readlane_b32 s41, v13, 2
  s_nop 1
  s_lshl_b32 s41, s41, 2
  s_add_u32 s41, s41, s49
  v_mul_f32 v88, v80, v88
  v_mul_f32 v89, v81, v89
  v_mul_f32 v90, v82, v90
  v_mul_f32 v91, v83, v91
  v_fma_f32 v20, v20, v18, v47
  v_fma_f32 v21, v21, v18, v47
  v_fma_f32 v22, v22, v18, v47
  v_fma_f32 v23, v23, v18, v47
  v_mul_f32 v92, v84, v92
  buffer_load_dwordx4 a[192:195], v16, s[8:11], s42 offen offset:0 sc1
  v_mul_f32 v93, v85, v93
  v_mul_f32 v94, v86, v94
  v_mul_f32 v95, v87, v95
  v_mul_f32 v80, v80, v20
  v_mul_f32 v81, v81, v21
  v_mul_f32 v82, v82, v22
  v_mul_f32 v83, v83, v23
  v_mul_f32 v20, v84, v84
  v_exp_f32 v80, v80
  buffer_load_dwordx4 a[196:199], v16, s[8:11], s42 offen offset:1024 sc1
  v_mul_f32 v21, v85, v85
  v_exp_f32 v81, v81
  v_mul_f32 v22, v86, v86
  v_exp_f32 v82, v82
  v_mul_f32 v23, v87, v87
  v_exp_f32 v83, v83
  v_fma_f32 v20, v20, v18, v47
  v_fma_f32 v21, v21, v18, v47
  v_fma_f32 v22, v22, v18, v47
  buffer_load_dwordx4 a[240:243], v16, s[8:11], s42 offen offset:2048 sc1
  v_fma_f32 v23, v23, v18, v47
  v_fma_f32 v80, v80, v19, v19
  v_fma_f32 v81, v81, v19, v19
  v_fma_f32 v82, v82, v19, v19
  v_fma_f32 v83, v83, v19, v19
  v_mul_f32 v84, v84, v20
  v_rcp_f32 v80, v80
  v_mul_f32 v85, v85, v21
  v_rcp_f32 v81, v81
  buffer_load_dwordx4 a[244:247], v16, s[8:11], s42 offen offset:3072 sc1
  v_readlane_b32 s42, v13, 3
  s_nop 1
  s_lshl_b32 s42, s42, 2
  s_add_u32 s42, s42, s48
  v_mul_f32 v86, v86, v22
  v_rcp_f32 v82, v82
  v_mul_f32 v87, v87, v23
  v_rcp_f32 v83, v83
  v_exp_f32 v84, v84
  v_mul_f32 v88, v88, v80
  v_exp_f32 v85, v85
  v_mul_f32 v89, v89, v81
  v_exp_f32 v86, v86
  buffer_load_dwordx4 a[248:251], v16, s[8:11], s43 offen offset:0 sc1
  v_mul_f32 v90, v90, v82
  v_exp_f32 v87, v87
  v_mul_f32 v91, v91, v83
  v_cvt_pk_bf16_f32 v80, v88, v89
  v_cvt_pk_bf16_f32 v81, v90, v91
  v_fma_f32 v84, v84, v19, v19
  v_fma_f32 v85, v85, v19, v19
  v_fma_f32 v86, v86, v19, v19
  v_fma_f32 v87, v87, v19, v19
  buffer_load_dwordx4 a[252:255], v16, s[8:11], s43 offen offset:1024 sc1
  v_rcp_f32 v84, v84
  v_rcp_f32 v85, v85
  v_rcp_f32 v86, v86
  v_rcp_f32 v87, v87
  v_mul_f32 v92, v92, v84
  v_mul_f32 v93, v93, v85
  v_mul_f32 v94, v94, v86
  v_mul_f32 v95, v95, v87
  v_cvt_pk_bf16_f32 v82, v92, v93
  v_cvt_pk_bf16_f32 v83, v94, v95
  s_waitcnt vmcnt(15)
  buffer_store_dwordx4 v[64:67], v14, s[16:19], s52 offen offset:0 sc1
  buffer_store_dwordx4 v[80:83], v14, s[16:19], s52 offen offset:2048 sc1
  s_barrier
  s_lshl_b32 s3, s25, 11
  s_lshl_b32 s54, s26, 2
  s_add_u32 s54, s54, s3
  s_add_u32 s54, s54, 753664
  s_cmp_eq_u32 s24, 0
  s_cselect_b32 s54, s54, 1073741824
  v_mov_b32 v24, s60
  v_mul_u32_u24 v25, 128, v1
  s_mov_b64 exec, 65535
  buffer_store_dword v24, v25, s[64:67], s54 offen sc1
  s_mov_b64 exec, -1
  s_mov_b32 s3, 1073741824
  buffer_load_dword v30, v16, s[64:67], s3 offen
  s_mov_b32 s3, 1073741824
  buffer_load_dword v30, v16, s[64:67], s3 offen
  s_mov_b32 s3, 1073741824
  buffer_load_dword v30, v16, s[64:67], s3 offen
  s_mov_b32 s3, 1073741824
  buffer_load_dword v30, v16, s[64:67], s3 offen
  s_mov_b32 s3, 1073741824
  buffer_load_dword v30, v16, s[64:67], s3 offen
  s_branch L_STAGE2
L_SSM:
  s_load_dwordx4 s[40:43], s[0:1], 40
  s_load_dwordx4 s[48:51], s[0:1], 8
  s_load_dwordx2 s[52:53], s[0:1], 56
  s_getpc_b64 s[58:59]
L_PC10:
  s_and_b32 s3, s25, 7
  s_lshl_b32 s3, s3, 2
  s_add_u32 s3, s3, s24
  s_lshl_b32 s3, s3, 10
  v_and_b32 v191, 7, v1
  v_lshlrev_b32 v191, 7, v191
  v_add_u32 v191, s3, v191
  global_load_dword v187, v191, s[58:59]
  s_mov_b32 s64, s38
  s_mov_b32 s65, s39
  s_mov_b32 s66, 3145728
  s_mov_b32 s67, 0x20000
  s_add_u32 s12, s38, 3145728
  s_addc_u32 s13, s39, 0
  s_mov_b32 s14, 12320768
  s_mov_b32 s15, 0x20000
  s_lshl_b32 s29, s25, 1
  s_add_u32 s29, s29, s34
  s_mul_i32 s57, s26, 25600
  s_mul_i32 s3, s35, 5120
  s_add_u32 s57, s57, s3
  s_add_u32 s57, s57, 131072
  v_cmp_lt_u32 s[58:59], 31, v1
  v_lshlrev_b32 v16, 4, v1
  v_add_u32 v17, 0x800, v16
  v_cndmask_b32 v17, v17, v16, s[58:59]
  v_cndmask_b32 v15, 1.0, 0, s[58:59]
  v_bfe_u32 v32, v1, 4, 1
  v_and_b32 v33, 15, v1
  v_mov_b32 v34, 0x3f803f80
  v_cmp_eq_u32 vcc, v32, v33
  s_nop 1
  v_cndmask_b32 v32, 0, v34, vcc
  v_mov_b32 v33, v32
  v_mov_b32 v34, v32
  v_mov_b32 v35, v32
  s_lshl_b32 s3, s33, 2
  s_add_u32 s36, s3, s35
  s_lshl_b32 s3, s34, 13
  v_lshrrev_b32 v37, 5, v1
  v_bfe_u32 v36, v1, 1, 1
  v_bfe_u32 v38, v1, 3, 2
  v_lshl_add_u32 v36, v38, 1, v36
  v_and_b32 v39, 1, v1
  v_bfe_u32 v40, v1, 2, 1
  v_lshlrev_b32 v40, 5, v40
  v_lshl_add_u32 v178, v36, 1, v40
  v_add_u32 v178, v178, v39
  v_lshl_add_u32 v36, v39, 4, v36
  v_add_u32 v36, v36, v40
  v_lshl_or_b32 v38, v39, 2, v38
  v_xor_b32 v38, v38, v37
  v_lshlrev_b32 v38, 4, v38
  v_lshl_add_u32 v38, v36, 7, v38
  v_add_u32 v20, s3, v38
  v_xor_b32 v21, 32, v20
  v_xor_b32 v22, 64, v20
  v_xor_b32 v23, 96, v20
  s_lshl_b32 s3, s29, 10
  v_lshlrev_b32 v189, 4, v36
  v_add_u32 v189, s3, v189
  v_and_b32 v179, 31, v1
  v_bfe_u32 v38, v1, 1, 3
  v_xor_b32 v38, v38, v37
  v_lshlrev_b32 v38, 4, v38
  v_lshl_add_u32 v38, v179, 7, v38
  s_lshl_b32 s3, s35, 12
  s_add_u32 s3, s3, 65536
  v_add_u32 v10, s3, v38
  v_xor_b32 v11, 32, v10
  v_xor_b32 v12, 64, v10
  v_xor_b32 v13, 96, v10
  s_lshl_b32 s3, s36, 5
  v_add_u32 v0, s3, v179
  v_lshlrev_b32 v0, 1, v0
  v_lshlrev_b32 v14, 4, v1
  s_mul_i32 s46, s25, 5
  s_add_u32 s46, s46, s33
  s_and_b32 s47, s46, 7
  s_lshr_b32 s46, s46, 3
  s_lshl_b32 s46, s46, 2
  s_lshl_b32 s3, s34, 1
  s_add_u32 s46, s46, s3
  s_add_u32 s46, s46, s35
  s_waitcnt lgkmcnt(0)
  s_mov_b32 s20, s48
  s_mov_b32 s21, s49
  s_mov_b32 s22, 1280
  s_mov_b32 s23, 0x20000
  buffer_load_ushort v150, v0, s[20:23], 0 offen offset:0
  buffer_load_ushort v153, v0, s[20:23], 0 offen offset:128
  s_mov_b32 s20, s50
  s_mov_b32 s21, s51
  s_mov_b32 s22, 1280
  s_mov_b32 s23, 0x20000
  buffer_load_ushort v151, v0, s[20:23], 0 offen offset:0
  buffer_load_ushort v154, v0, s[20:23], 0 offen offset:128
  s_mov_b32 s20, s52
  s_mov_b32 s21, s53
  s_mov_b32 s22, 1280
  s_mov_b32 s23, 0x20000
  buffer_load_ushort v152, v0, s[20:23], 0 offen offset:0
  buffer_load_ushort v155, v0, s[20:23], 0 offen offset:128
  s_bitcmp1_b32 s46, 0
  s_cselect_b32 s40, s42, s40
  s_cselect_b32 s41, s43, s41
  s_mov_b32 s42, 819200
  s_mov_b32 s43, 0x20000
  s_mul_i32 s44, s47, 102400
  s_lshr_b32 s3, s46, 1
  s_lshl_b32 s3, s3, 6
  s_add_u32 s44, s44, s3
  s_mul_i32 s45, s24, 5120
  s_add_u32 s45, s45, 131072
  s_mul_i32 s47, s47, 481280
  s_add_u32 s46, s46, 54
  s_mul_i32 s46, s46, 5120
  s_add_u32 s46, s46, s47
  v_lshrrev_b32 v180, 2, v1
  v_mul_u32_u24 v180, 1280, v180
  v_bfe_u32 v181, v1, 3, 2
  v_and_b32 v182, 3, v1
  v_xor_b32 v181, v181, v182
  v_lshl_add_u32 v180, v181, 4, v180
  v_add_u32 v181, 19456, v180
  v_add_u32 v182, 38912, v180
  v_add_u32 v183, 58368, v180
  s_mul_i32 s3, s29, 385024
  s_lshl_b32 s30, s36, 13
  s_add_u32 s3, s3, s30
  s_add_u32 s30, s3, 221184
  s_add_u32 s31, s3, 225280
  s_add_u32 s32, s3, 237568
  s_add_u32 s33, s3, 241664
  s_lshl_b32 s3, s24, 8
  s_add_u32 s3, s3, 151552
  v_lshlrev_b32 v178, 2, v178
  v_add_u32 v178, s3, v178
  v_and_b32 v18, 15, v1
  v_bfe_u32 v36, v1, 1, 2
  v_lshrrev_b32 v38, 4, v1
  v_xor_b32 v36, v36, v38
  v_lshlrev_b32 v18, 6, v18
  v_lshl_add_u32 v18, v36, 4, v18
  v_add_u32 v18, s45, v18
  s_add_u32 s20, s38, 15728640
  s_addc_u32 s21, s39, 0
  s_mov_b32 s22, 3850240
  s_waitcnt vmcnt(15)
  v_lshlrev_b32 v64, 16, v130
  v_and_b32 v65, 0xffff0000, v130
  v_lshlrev_b32 v66, 16, v131
  v_and_b32 v67, 0xffff0000, v131
  v_lshlrev_b32 v68, 16, v132
  v_and_b32 v69, 0xffff0000, v132
  v_lshlrev_b32 v70, 16, v133
  v_and_b32 v71, 0xffff0000, v133
  v_lshlrev_b32 v72, 16, v134
  v_and_b32 v73, 0xffff0000, v134
  v_lshlrev_b32 v74, 16, v135
  v_and_b32 v75, 0xffff0000, v135
  v_lshlrev_b32 v76, 16, v136
  v_and_b32 v77, 0xffff0000, v136
  v_lshlrev_b32 v78, 16, v137
  v_and_b32 v79, 0xffff0000, v137
  v_lshlrev_b32 v80, 16, v138
  v_and_b32 v81, 0xffff0000, v138
  v_lshlrev_b32 v82, 16, v139
  v_and_b32 v83, 0xffff0000, v139
  v_pk_add_f32 v[160:161], v[64:65], v[66:67]
  v_pk_add_f32 v[162:163], v[68:69], v[70:71]
  v_pk_add_f32 v[160:161], v[160:161], v[72:73]
  v_pk_add_f32 v[162:163], v[162:163], v[74:75]
  v_pk_add_f32 v[160:161], v[160:161], v[76:77]
  v_pk_add_f32 v[162:163], v[162:163], v[78:79]
  v_pk_add_f32 v[160:161], v[160:161], v[80:81]
  v_pk_add_f32 v[162:163], v[162:163], v[82:83]
  v_pk_add_f32 v[160:161], v[160:161], v[162:163]
  v_add_f32 v160, v160, v161
  s_nop 1
  v_add_f32_dpp v160, v160, v160 row_ror:8 row_mask:0xf bank_mask:0xf
  s_nop 1
  v_add_f32_dpp v160, v160, v160 row_ror:4 row_mask:0xf bank_mask:0xf
  s_nop 1
  v_add_f32_dpp v160, v160, v160 row_ror:2 row_mask:0xf bank_mask:0xf
  s_nop 1
  v_add_f32_dpp v160, v160, v160 row_ror:1 row_mask:0xf bank_mask:0xf
  v_mov_b32 v161, v160
  s_nop 1
  v_permlane16_swap_b32 v160, v161
  v_add_f32 v160, v160, v161
  v_mul_f32 v160, 0x3acccccd, v160
  v_pk_add_f32 v[64:65], v[64:65], v[160:161] op_sel_hi:[1,0] neg_lo:[0,1] neg_hi:[0,1]
  v_pk_add_f32 v[66:67], v[66:67], v[160:161] op_sel_hi:[1,0] neg_lo:[0,1] neg_hi:[0,1]
  v_pk_add_f32 v[68:69], v[68:69], v[160:161] op_sel_hi:[1,0] neg_lo:[0,1] neg_hi:[0,1]
  v_pk_add_f32 v[70:71], v[70:71], v[160:161] op_sel_hi:[1,0] neg_lo:[0,1] neg_hi:[0,1]
  v_pk_add_f32 v[72:73], v[72:73], v[160:161] op_sel_hi:[1,0] neg_lo:[0,1] neg_hi:[0,1]
  v_pk_add_f32 v[74:75], v[74:75], v[160:161] op_sel_hi:[1,0] neg_lo:[0,1] neg_hi:[0,1]
  v_pk_add_f32 v[76:77], v[76:77], v[160:161] op_sel_hi:[1,0] neg_lo:[0,1] neg_hi:[0,1]
  v_pk_add_f32 v[78:79], v[78:79], v[160:161] op_sel_hi:[1,0] neg_lo:[0,1] neg_hi:[0,1]
  v_pk_add_f32 v[80:81], v[80:81], v[160:161] op_sel_hi:[1,0] neg_lo:[0,1] neg_hi:[0,1]
  v_pk_add_f32 v[82:83], v[82:83], v[160:161] op_sel_hi:[1,0] neg_lo:[0,1] neg_hi:[0,1]
  v_pk_mul_f32 v[162:163], v[64:65], v[64:65]
  v_pk_mul_f32 v[164:165], v[66:67], v[66:67]
  v_pk_fma_f32 v[162:163], v[68:69], v[68:69], v[162:163]
  v_pk_fma_f32 v[164:165], v[70:71], v[70:71], v[164:165]
  v_pk_fma_f32 v[162:163], v[72:73], v[72:73], v[162:163]
  v_pk_fma_f32 v[164:165], v[74:75], v[74:75], v[164:165]
  v_pk_fma_f32 v[162:163], v[76:77], v[76:77], v[162:163]
  v_pk_fma_f32 v[164:165], v[78:79], v[78:79], v[164:165]
  v_pk_fma_f32 v[162:163], v[80:81], v[80:81], v[162:163]
  v_pk_fma_f32 v[164:165], v[82:83], v[82:83], v[164:165]
  v_pk_add_f32 v[162:163], v[162:163], v[164:165]
  v_add_f32 v162, v162, v163
  s_nop 1
  v_add_f32_dpp v162, v162, v162 row_ror:8 row_mask:0xf bank_mask:0xf
  s_nop 1
  v_add_f32_dpp v162, v162, v162 row_ror:4 row_mask:0xf bank_mask:0xf
  s_nop 1
  v_add_f32_dpp v162, v162, v162 row_ror:2 row_mask:0xf bank_mask:0xf
  s_nop 1
  v_add_f32_dpp v162, v162, v162 row_ror:1 row_mask:0xf bank_mask:0xf
  v_mov_b32 v163, v162
  s_nop 1
  v_permlane16_swap_b32 v162, v163
  v_add_f32 v162, v162, v163
  v_mul_f32 v162, 0x3acccccd, v162
  v_cvt_pk_bf16_f32 v162, v162, v162
  v_and_b32 v162, 0xffff0000, v162
  v_add_f32 v162, 0x3727c5ac, v162
  v_cvt_pk_bf16_f32 v162, v162, v162
  v_and_b32 v162, 0xffff0000, v162
  v_sqrt_f32 v162, v162
  v_cvt_pk_bf16_f32 v160, v160, v160
  v_and_b32 v160, 0xffff0000, v160
  v_cvt_pk_bf16_f32 v161, v162, v162
  v_and_b32 v161, 0xffff0000, v161
  buffer_load_dwordx2 v[168:169], v190, s[16:19], 0 offen sc1
  s_add_u32 m0, s27, 16384
  s_lshl_b32 s28, s68, 7
  buffer_load_dwordx4 v2, s[4:7], s28 offen offset:0 lds
  buffer_load_dwordx4 v3, s[4:7], s28 offen offset:1024 lds
  buffer_load_dwordx4 v4, s[4:7], s28 offen offset:2048 lds
  s_add_u32 s68, s68, 1
  s_cmp_ge_u32 s68, 10
  s_cselect_b32 s3, 10, 0
  s_sub_u32 s68, s68, s3
  buffer_load_dwordx4 v5, s[4:7], s28 offen offset:3072 lds
  s_waitcnt lgkmcnt(0)
  s_waitcnt vmcnt(12)
  s_barrier
  ds_read_b128 v[48:51], v10 offset:0
  ds_read_b128 a[0:3], v20 offset:0
  ds_read_b128 a[4:7], v20 offset:1024
  ds_read_b128 v[52:55], v10 offset:8192
  s_waitcnt lgkmcnt(2)
  v_mfma_f32_32x32x16_bf16 v[64:79], a[0:3], v[48:51], 0
  ds_read_b128 v[56:59], v11 offset:0
  ds_read_b128 a[8:11], v21 offset:0
  s_add_u32 m0, s27, 81920
  s_lshl_b32 s28, s69, 7
  buffer_load_dwordx4 v6, s[8:11], s28 offen offset:0 lds
  s_waitcnt lgkmcnt(3)
  v_mfma_f32_32x32x16_bf16 v[80:95], a[4:7], v[48:51], 0
  v_mfma_f32_16x16x32_bf16 v[24:27], v[32:35], v[48:51], 0
  ds_read_b128 a[12:15], v21 offset:1024
  buffer_load_dwordx4 v7, s[8:11], s28 offen offset:1024 lds
  s_waitcnt lgkmcnt(3)
  v_mfma_f32_32x32x16_bf16 v[96:111], a[0:3], v[52:55], 0
  ds_read_b128 v[60:63], v11 offset:8192
  ds_read_b128 a[16:19], v22 offset:0
  buffer_load_dwordx4 v8, s[8:11], s28 offen offset:2048 lds
  s_add_u32 s69, s69, 1
  s_cmp_ge_u32 s69, 10
  s_cselect_b32 s3, 10, 0
  s_sub_u32 s69, s69, s3
  v_mfma_f32_32x32x16_bf16 v[112:127], a[4:7], v[52:55], 0
  v_mfma_f32_16x16x32_bf16 v[28:31], v[32:35], v[52:55], 0
  ds_read_b128 a[20:23], v22 offset:1024
  buffer_load_dwordx4 v9, s[8:11], s28 offen offset:3072 lds
  s_waitcnt lgkmcnt(4)
  v_mfma_f32_32x32x16_bf16 v[64:79], a[8:11], v[56:59], v[64:79]
  ds_read_b128 v[48:51], v12 offset:0
  ds_read_b128 a[24:27], v23 offset:0
  s_add_u32 m0, s27, 32768
  s_lshl_b32 s28, s68, 7
  buffer_load_dwordx4 v2, s[4:7], s28 offen offset:0 lds
  s_waitcnt lgkmcnt(5)
  v_mfma_f32_32x32x16_bf16 v[80:95], a[12:15], v[56:59], v[80:95]
  v_mfma_f32_16x16x32_bf16 v[24:27], v[32:35], v[56:59], v[24:27]
  ds_read_b128 a[28:31], v23 offset:1024
  buffer_load_dwordx4 v3, s[4:7], s28 offen offset:1024 lds
  s_waitcnt lgkmcnt(5)
  v_mfma_f32_32x32x16_bf16 v[96:111], a[8:11], v[60:63], v[96:111]
  ds_read_b128 v[52:55], v12 offset:8192
  buffer_load_dwordx4 v4, s[4:7], s28 offen offset:2048 lds
  s_add_u32 s68, s68, 1
  s_cmp_ge_u32 s68, 10
  s_cselect_b32 s3, 10, 0
  s_sub_u32 s68, s68, s3
  v_mfma_f32_32x32x16_bf16 v[112:127], a[12:15], v[60:63], v[112:127]
  v_mfma_f32_16x16x32_bf16 v[28:31], v[32:35], v[60:63], v[28:31]
  buffer_load_dwordx4 v5, s[4:7], s28 offen offset:3072 lds
  s_waitcnt lgkmcnt(3)
  v_mfma_f32_32x32x16_bf16 v[64:79], a[16:19], v[48:51], v[64:79]
  ds_read_b128 v[56:59], v13 offset:0
  s_add_u32 m0, s27, 98304
  s_lshl_b32 s28, s69, 7
  buffer_load_dwordx4 v6, s[8:11], s28 offen offset:0 lds
  v_mfma_f32_32x32x16_bf16 v[80:95], a[20:23], v[48:51], v[80:95]
  v_mfma_f32_16x16x32_bf16 v[24:27], v[32:35], v[48:51], v[24:27]
  ds_read_b128 v[60:63], v13 offset:8192
  buffer_load_dwordx4 v7, s[8:11], s28 offen offset:1024 lds
  s_waitcnt lgkmcnt(2)
  v_mfma_f32_32x32x16_bf16 v[96:111], a[16:19], v[52:55], v[96:111]
  buffer_load_dwordx4 v8, s[8:11], s28 offen offset:2048 lds
  s_add_u32 s69, s69, 1
  s_cmp_ge_u32 s69, 10
  s_cselect_b32 s3, 10, 0
  s_sub_u32 s69, s69, s3
  v_mfma_f32_32x32x16_bf16 v[112:127], a[20:23], v[52:55], v[112:127]
  v_mfma_f32_16x16x32_bf16 v[28:31], v[32:35], v[52:55], v[28:31]
  buffer_load_dwordx4 v9, s[8:11], s28 offen offset:3072 lds
  s_waitcnt lgkmcnt(1)
  v_mfma_f32_32x32x16_bf16 v[64:79], a[24:27], v[56:59], v[64:79]
  s_waitcnt vmcnt(8) lgkmcnt(0)
  s_barrier
  ds_read_b128 v[48:51], v10 offset:16384
  v_mfma_f32_32x32x16_bf16 v[80:95], a[28:31], v[56:59], v[80:95]
  v_mfma_f32_16x16x32_bf16 v[24:27], v[32:35], v[56:59], v[24:27]
  ds_read_b128 a[32:35], v20 offset:16384
  s_add_u32 m0, s27, 49152
  s_lshl_b32 s28, s68, 7
  buffer_load_dwordx4 v2, s[4:7], s28 offen offset:0 lds
  v_mfma_f32_32x32x16_bf16 v[96:111], a[24:27], v[60:63], v[96:111]
  ds_read_b128 v[52:55], v10 offset:24576
  ds_read_b128 a[36:39], v20 offset:17408
  buffer_load_dwordx4 v3, s[4:7], s28 offen offset:1024 lds
  v_mfma_f32_32x32x16_bf16 v[112:127], a[28:31], v[60:63], v[112:127]
  v_mfma_f32_16x16x32_bf16 v[28:31], v[32:35], v[60:63], v[28:31]
  s_waitcnt lgkmcnt(2)
  v_mfma_f32_32x32x16_bf16 v[64:79], a[32:35], v[48:51], v[64:79]
  ds_read_b128 v[56:59], v11 offset:16384
  ds_read_b128 a[40:43], v21 offset:16384
  buffer_load_dwordx4 v4, s[4:7], s28 offen offset:2048 lds
  s_add_u32 s68, s68, 1
  s_cmp_ge_u32 s68, 10
  s_cselect_b32 s3, 10, 0
  s_sub_u32 s68, s68, s3
  s_waitcnt lgkmcnt(2)
  v_mfma_f32_32x32x16_bf16 v[80:95], a[36:39], v[48:51], v[80:95]
  ds_read_b128 a[44:47], v21 offset:17408
  v_mfma_f32_32x32x16_bf16 v[96:111], a[32:35], v[52:55], v[96:111]
  ds_read_b128 v[60:63], v11 offset:24576
  ds_read_b128 a[48:51], v22 offset:16384
  buffer_load_dwordx4 v5, s[4:7], s28 offen offset:3072 lds
  v_mfma_f32_32x32x16_bf16 v[112:127], a[36:39], v[52:55], v[112:127]
  ds_read_b128 a[52:55], v22 offset:17408
  s_mov_b32 s62, 0
L_CHK11:
  v_min_u32 v191, v168, v169
  v_cmp_eq_u32 vcc, 0, v191
  s_cbranch_vccz L_OK11
  s_add_u32 s62, s62, 1
  s_cmp_lt_u32 s62, 0x40000
  s_cbranch_scc0 L_OK11
  s_sleep 2
  buffer_load_dwordx2 v[168:169], v190, s[16:19], 0 offen sc1
  s_waitcnt vmcnt(0)
  s_branch L_CHK11
L_OK11:
  v_readfirstlane_b32 s60, v168
  v_readfirstlane_b32 s61, v169
  s_nop 1
  s_waitcnt lgkmcnt(4)
  v_mfma_f32_32x32x16_bf16 v[64:79], a[40:43], v[56:59], v[64:79]
  ds_read_b128 v[48:51], v12 offset:16384
  ds_read_b128 a[56:59], v23 offset:16384
  s_add_u32 m0, s27, 114688
  s_lshl_b32 s28, s69, 7
  buffer_load_dwordx4 v6, s[8:11], s28 offen offset:0 lds
  s_waitcnt lgkmcnt(5)
  v_mfma_f32_32x32x16_bf16 v[80:95], a[44:47], v[56:59], v[80:95]
  ds_read_b128 a[60:63], v23 offset:17408
  buffer_load_dwordx4 v7, s[8:11], s28 offen offset:1024 lds
  s_waitcnt lgkmcnt(5)
  v_mfma_f32_32x32x16_bf16 v[96:111], a[40:43], v[60:63], v[96:111]
  ds_read_b128 v[52:55], v12 offset:24576
  v_mfma_f32_32x32x16_bf16 v[112:127], a[44:47], v[60:63], v[112:127]
  buffer_load_dwordx4 v8, s[8:11], s28 offen offset:2048 lds
  s_add_u32 s69, s69, 1
  s_cmp_ge_u32 s69, 10
  s_cselect_b32 s3, 10, 0
  s_sub_u32 s69, s69, s3
  s_waitcnt lgkmcnt(3)
  v_mfma_f32_32x32x16_bf16 v[64:79], a[48:51], v[48:51], v[64:79]
  ds_read_b128 v[56:59], v13 offset:16384
  v_bitop3_b32 v162, v160, v161, s60 bitop3:0x96
  v_mov_b32 v163, s61
  buffer_store_dwordx4 v[160:163], v128, s[64:67], 0 offen offset:0 sc1
  v_mfma_f32_32x32x16_bf16 v[80:95], a[52:55], v[48:51], v[80:95]
  ds_read_b128 v[60:63], v13 offset:24576
  buffer_load_dwordx4 v9, s[8:11], s28 offen offset:3072 lds
  v_bitop3_b32 v26, v24, v25, s60 bitop3:0x96
  v_mov_b32 v27, s61
  s_waitcnt lgkmcnt(2)
  v_mfma_f32_32x32x16_bf16 v[96:111], a[48:51], v[52:55], v[96:111]
  s_lshl_b32 s3, s37, 8
  s_add_u32 s3, s3, s57
  s_add_u32 s3, s3, 0
  s_mov_b64 exec, 0xffff
  buffer_store_dwordx4 v[24:27], v16, s[64:67], s3 offen sc1
  s_mov_b64 exec, -1
  v_mfma_f32_32x32x16_bf16 v[112:127], a[52:55], v[52:55], v[112:127]
  v_bitop3_b32 v30, v28, v29, s60 bitop3:0x96
  v_mov_b32 v31, s61
  s_lshl_b32 s3, s37, 8
  s_add_u32 s3, s3, s57
  s_add_u32 s3, s3, 2560
  s_mov_b64 exec, 0xffff
  buffer_store_dwordx4 v[28:31], v16, s[64:67], s3 offen sc1
  s_mov_b64 exec, -1
  s_waitcnt lgkmcnt(1)
  v_mfma_f32_32x32x16_bf16 v[64:79], a[56:59], v[56:59], v[64:79]
  s_waitcnt vmcnt(11) lgkmcnt(0)
  s_barrier
  ds_read_b128 v[48:51], v10 offset:32768
  v_mfma_f32_32x32x16_bf16 v[80:95], a[60:63], v[56:59], v[80:95]
  ds_read_b128 a[64:67], v20 offset:32768
  s_add_u32 m0, s27, 0
  s_lshl_b32 s28, s68, 7
  buffer_load_dwordx4 v2, s[4:7], s28 offen offset:0 lds
  v_mfma_f32_32x32x16_bf16 v[96:111], a[56:59], v[60:63], v[96:111]
  ds_read_b128 v[52:55], v10 offset:40960
  ds_read_b128 a[68:71], v20 offset:33792
  buffer_load_dwordx4 v3, s[4:7], s28 offen offset:1024 lds
  v_mfma_f32_32x32x16_bf16 v[112:127], a[60:63], v[60:63], v[112:127]
  v_lshlrev_b32 v150, 16, v150
  v_lshlrev_b32 v151, 16, v151
  v_lshlrev_b32 v152, 16, v152
  v_mul_f32 v152, 0x3fb8aa3b, v152
  v_exp_f32 v152, v152
  s_waitcnt lgkmcnt(2)
  v_mfma_f32_32x32x16_bf16 v[64:79], a[64:67], v[48:51], v[64:79]
  ds_read_b128 v[56:59], v11 offset:32768
  ds_read_b128 a[72:75], v21 offset:32768
  buffer_load_dwordx4 v4, s[4:7], s28 offen offset:2048 lds
  s_add_u32 s68, s68, 1
  s_cmp_ge_u32 s68, 10
  s_cselect_b32 s3, 10, 0
  s_sub_u32 s68, s68, s3
  s_waitcnt lgkmcnt(2)
  v_mfma_f32_32x32x16_bf16 v[80:95], a[68:71], v[48:51], v[80:95]
  ds_read_b128 a[76:79], v21 offset:33792
  v_mul_f32 v166, v150, v150
  v_cvt_pk_bf16_f32 v152, v152, v152
  v_mfma_f32_32x32x16_bf16 v[96:111], a[64:67], v[52:55], v[96:111]
  ds_read_b128 v[60:63], v11 offset:40960
  ds_read_b128 a[80:83], v22 offset:32768
  buffer_load_dwordx4 v5, s[4:7], s28 offen offset:3072 lds
  v_and_b32 v152, 0xffff0000, v152
  v_mfma_f32_32x32x16_bf16 v[112:127], a[68:71], v[52:55], v[112:127]
  ds_read_b128 a[84:87], v22 offset:33792
  v_mul_f32 v164, v152, v150
  v_mul_f32 v165, v152, v151
  v_mul_f32 v164, 0x3fb8aa3b, v164
  v_mul_f32 v165, 0.15915494, v165
  s_waitcnt lgkmcnt(4)
  v_mfma_f32_32x32x16_bf16 v[64:79], a[72:75], v[56:59], v[64:79]
  ds_read_b128 v[48:51], v12 offset:32768
  ds_read_b128 a[88:91], v23 offset:32768
  s_add_u32 m0, s27, 65536
  s_lshl_b32 s28, s69, 7
  buffer_load_dwordx4 v6, s[8:11], s28 offen offset:0 lds
  s_waitcnt lgkmcnt(5)
  v_mfma_f32_32x32x16_bf16 v[80:95], a[76:79], v[56:59], v[80:95]
  ds_read_b128 a[92:95], v23 offset:33792
  buffer_load_dwordx4 v7, s[8:11], s28 offen offset:1024 lds
  v_exp_f32 v164, v164
  s_waitcnt lgkmcnt(5)
  v_mfma_f32_32x32x16_bf16 v[96:111], a[72:75], v[60:63], v[96:111]
  ds_read_b128 v[52:55], v12 offset:40960
  v_fract_f32 v165, v165
  v_cos_f32 v44, v165
  v_sin_f32 v45, v165
  v_mfma_f32_32x32x16_bf16 v[112:127], a[76:79], v[60:63], v[112:127]
  buffer_load_dwordx4 v8, s[8:11], s28 offen offset:2048 lds
  s_add_u32 s69, s69, 1
  s_cmp_ge_u32 s69, 10
  s_cselect_b32 s3, 10, 0
  s_sub_u32 s69, s69, s3
  s_waitcnt lgkmcnt(3)
  v_mfma_f32_32x32x16_bf16 v[64:79], a[80:83], v[48:51], v[64:79]
  ds_read_b128 v[56:59], v13 offset:32768
  v_fmac_f32 v166, v151, v151
  v_mul_f32 v44, v44, v164
  v_mul_f32 v45, v45, v164
  v_rcp_f32 v166, v166
  v_mfma_f32_32x32x16_bf16 v[80:95], a[84:87], v[48:51], v[80:95]
  ds_read_b128 v[60:63], v13 offset:40960
  buffer_load_dwordx4 v9, s[8:11], s28 offen offset:3072 lds
  v_add_f32 v164, -1.0, v44
  v_mul_f32 v165, v164, v150
  s_waitcnt lgkmcnt(2)
  v_mfma_f32_32x32x16_bf16 v[96:111], a[80:83], v[52:55], v[96:111]
  v_fmac_f32 v165, v45, v151
  v_mul_f32 v152, v45, v150
  v_fma_f32 v152, -v164, v151, v152
  v_add_f32 v166, v166, v166
  v_mul_f32 v46, v165, v166
  v_mfma_f32_32x32x16_bf16 v[112:127], a[84:87], v[52:55], v[112:127]
  v_mul_f32 v47, v152, v166
  v_lshlrev_b32 v153, 16, v153
  v_lshlrev_b32 v154, 16, v154
  v_lshlrev_b32 v155, 16, v155
  v_mul_f32 v155, 0x3fb8aa3b, v155
  s_waitcnt lgkmcnt(1)
  v_mfma_f32_32x32x16_bf16 v[64:79], a[88:91], v[56:59], v[64:79]
  s_waitcnt vmcnt(10) lgkmcnt(0)
  s_barrier
  ds_read_b128 v[48:51], v10 offset:49152
  v_exp_f32 v155, v155
  v_mfma_f32_32x32x16_bf16 v[80:95], a[92:95], v[56:59], v[80:95]
  ds_read_b128 a[96:99], v20 offset:49152
  s_add_u32 m0, s27, 16384
  s_lshl_b32 s28, s68, 7
  buffer_load_dwordx4 v2, s[4:7], s28 offen offset:0 lds
  v_mfma_f32_32x32x16_bf16 v[96:111], a[88:91], v[60:63], v[96:111]
  ds_read_b128 v[52:55], v10 offset:57344
  ds_read_b128 a[100:103], v20 offset:50176
  buffer_load_dwordx4 v3, s[4:7], s28 offen offset:1024 lds
  v_mul_f32 v166, v153, v153
  v_mfma_f32_32x32x16_bf16 v[112:127], a[92:95], v[60:63], v[112:127]
  buffer_load_dwordx4 v4, s[4:7], s28 offen offset:2048 lds
  s_add_u32 s68, s68, 1
  s_cmp_ge_u32 s68, 10
  s_cselect_b32 s3, 10, 0
  s_sub_u32 s68, s68, s3
  s_waitcnt lgkmcnt(2)
  v_mfma_f32_32x32x16_bf16 v[64:79], a[96:99], v[48:51], v[64:79]
  ds_read_b128 v[56:59], v11 offset:49152
  ds_read_b128 a[104:107], v21 offset:49152
  buffer_load_dwordx4 v5, s[4:7], s28 offen offset:3072 lds
  v_cvt_pk_bf16_f32 v155, v155, v155
  s_waitcnt lgkmcnt(2)
  v_mfma_f32_32x32x16_bf16 v[80:95], a[100:103], v[48:51], v[80:95]
  ds_read_b128 a[108:111], v21 offset:50176
  s_add_u32 m0, s27, 81920
  s_lshl_b32 s28, s69, 7
  buffer_load_dwordx4 v6, s[8:11], s28 offen offset:0 lds
  v_mfma_f32_32x32x16_bf16 v[96:111], a[96:99], v[52:55], v[96:111]
  ds_read_b128 v[60:63], v11 offset:57344
  ds_read_b128 a[112:115], v22 offset:49152
  v_and_b32 v155, 0xffff0000, v155
  v_mul_f32 v164, v155, v153
  v_mul_f32 v165, v155, v154
  v_mfma_f32_32x32x16_bf16 v[112:127], a[100:103], v[52:55], v[112:127]
  ds_read_b128 a[116:119], v22 offset:50176
  buffer_load_dwordx4 v7, s[8:11], s28 offen offset:1024 lds
  v_mul_f32 v164, 0x3fb8aa3b, v164
  v_mul_f32 v165, 0.15915494, v165
  s_waitcnt lgkmcnt(4)
  v_mfma_f32_32x32x16_bf16 v[64:79], a[104:107], v[56:59], v[64:79]
  ds_read_b128 v[48:51], v12 offset:49152
  ds_read_b128 a[120:123], v23 offset:49152
  buffer_load_dwordx4 v8, s[8:11], s28 offen offset:2048 lds
  s_add_u32 s69, s69, 1
  s_cmp_ge_u32 s69, 10
  s_cselect_b32 s3, 10, 0
  s_sub_u32 s69, s69, s3
  s_waitcnt lgkmcnt(5)
  v_mfma_f32_32x32x16_bf16 v[80:95], a[108:111], v[56:59], v[80:95]
  ds_read_b128 a[124:127], v23 offset:50176
  buffer_load_dwordx4 v9, s[8:11], s28 offen offset:3072 lds
  v_exp_f32 v164, v164
  s_waitcnt lgkmcnt(5)
  v_mfma_f32_32x32x16_bf16 v[96:111], a[104:107], v[60:63], v[96:111]
  ds_read_b128 v[52:55], v12 offset:57344
  s_mov_b32 m0, s45
  s_mov_b32 s28, s44
  buffer_load_dwordx4 v180, s[40:43], s28 offen offset:0 lds
  v_mfma_f32_32x32x16_bf16 v[112:127], a[108:111], v[60:63], v[112:127]
  buffer_load_dwordx4 v181, s[40:43], s28 offen offset:1024 lds
  v_fract_f32 v165, v165
  v_cos_f32 v184, v165
  s_waitcnt lgkmcnt(3)
  v_mfma_f32_32x32x16_bf16 v[64:79], a[112:115], v[48:51], v[64:79]
  ds_read_b128 v[56:59], v13 offset:49152
  v_sin_f32 v185, v165
  v_fmac_f32 v166, v154, v154
  v_mul_f32 v184, v184, v164
  v_mfma_f32_32x32x16_bf16 v[80:95], a[116:119], v[48:51], v[80:95]
  ds_read_b128 v[60:63], v13 offset:57344
  buffer_load_dwordx4 v182, s[40:43], s28 offen offset:2048 lds
  v_mul_f32 v185, v185, v164
  v_rcp_f32 v166, v166
  s_waitcnt lgkmcnt(2)
  v_mfma_f32_32x32x16_bf16 v[96:111], a[112:115], v[52:55], v[96:111]
  buffer_load_dwordx4 v183, s[40:43], s28 offen offset:3072 lds
  v_add_f32 v164, -1.0, v184
  v_mul_f32 v165, v164, v153
  v_fmac_f32 v165, v185, v154
  v_mfma_f32_32x32x16_bf16 v[112:127], a[116:119], v[52:55], v[112:127]
  s_add_u32 m0, s45, 4096
  s_add_u32 s28, s44, 81920
  buffer_load_dwordx4 v180, s[40:43], s28 offen offset:0 lds
  v_mul_f32 v155, v185, v153
  s_waitcnt lgkmcnt(1)
  v_mfma_f32_32x32x16_bf16 v[64:79], a[120:123], v[56:59], v[64:79]
  s_waitcnt vmcnt(13) lgkmcnt(0)
  s_barrier
  ds_read_b128 v[48:51], v10 offset:0
  v_fma_f32 v155, -v164, v154, v155
  v_add_f32 v166, v166, v166
  v_mfma_f32_32x32x16_bf16 v[80:95], a[124:127], v[56:59], v[80:95]
  ds_read_b128 a[128:131], v20 offset:0
  s_add_u32 m0, s27, 32768
  s_lshl_b32 s28, s68, 7
  buffer_load_dwordx4 v2, s[4:7], s28 offen offset:0 lds
  v_mfma_f32_32x32x16_bf16 v[96:111], a[120:123], v[60:63], v[96:111]
  ds_read_b128 v[52:55], v10 offset:8192
  ds_read_b128 a[132:135], v20 offset:1024
  buffer_load_dwordx4 v3, s[4:7], s28 offen offset:1024 lds
  v_mul_f32 v186, v165, v166
  v_mfma_f32_32x32x16_bf16 v[112:127], a[124:127], v[60:63], v[112:127]
  v_mul_f32 v187, v155, v166
  s_and_b32 s96, s2, 3
  s_lshl_b32 s96, s96, 2
  s_bfe_u32 s98, s2, 0x20003
  s_add_u32 s96, s96, s98
  s_lshr_b32 s97, s2, 5
  s_lshl_b32 s98, s98, 1
  s_add_u32 s98, s98, s97
  s_waitcnt lgkmcnt(2)
  v_mfma_f32_32x32x16_bf16 v[64:79], a[128:131], v[48:51], v[64:79]
  ds_read_b128 v[56:59], v11 offset:0
  ds_read_b128 a[136:139], v21 offset:0
  buffer_load_dwordx4 v4, s[4:7], s28 offen offset:2048 lds
  s_add_u32 s68, s68, 1
  s_cmp_ge_u32 s68, 10
  s_cselect_b32 s3, 10, 0
  s_sub_u32 s68, s68, s3
  s_waitcnt lgkmcnt(2)
  v_mfma_f32_32x32x16_bf16 v[80:95], a[132:135], v[48:51], v[80:95]
  ds_read_b128 a[140:143], v21 offset:1024
  v_mfma_f32_32x32x16_bf16 v[96:111], a[128:131], v[52:55], v[96:111]
  ds_read_b128 v[60:63], v11 offset:8192
  ds_read_b128 a[144:147], v22 offset:0
  buffer_load_dwordx4 v5, s[4:7], s28 offen offset:3072 lds
  s_mul_i32 s3, s97, 481280
  s_add_u32 s3, s3, 15728640
  s_add_u32 s92, s38, s3
  s_addc_u32 s93, s39, 0
  s_mov_b32 s94, 481280
  s_mov_b32 s95, 0x20000
  v_mfma_f32_32x32x16_bf16 v[112:127], a[132:135], v[52:55], v[112:127]
  ds_read_b128 a[148:151], v22 offset:1024
  s_waitcnt lgkmcnt(4)
  v_mfma_f32_32x32x16_bf16 v[64:79], a[136:139], v[56:59], v[64:79]
  ds_read_b128 v[48:51], v12 offset:0
  ds_read_b128 a[152:155], v23 offset:0
  s_add_u32 m0, s27, 98304
  s_lshl_b32 s28, s69, 7
  buffer_load_dwordx4 v6, s[8:11], s28 offen offset:0 lds
  s_waitcnt lgkmcnt(5)
  v_mfma_f32_32x32x16_bf16 v[80:95], a[140:143], v[56:59], v[80:95]
  ds_read_b128 a[156:159], v23 offset:1024
  buffer_load_dwordx4 v7, s[8:11], s28 offen offset:1024 lds
  s_mul_i32 s3, s98, 43
  s_lshr_b32 s3, s3, 7
  s_mul_i32 s3, s3, 3
  s_sub_u32 s3, s98, s3
  v_add_u32 v164, s3, v1
  s_waitcnt lgkmcnt(5)
  v_mfma_f32_32x32x16_bf16 v[96:111], a[136:139], v[60:63], v[96:111]
  ds_read_b128 v[52:55], v12 offset:8192
  v_subrev_u32 v165, 3, v164
  v_mfma_f32_32x32x16_bf16 v[112:127], a[140:143], v[60:63], v[112:127]
  buffer_load_dwordx4 v8, s[8:11], s28 offen offset:2048 lds
  s_add_u32 s69, s69, 1
  s_cmp_ge_u32 s69, 10
  s_cselect_b32 s3, 10, 0
  s_sub_u32 s69, s69, s3
  s_waitcnt lgkmcnt(3)
  v_mfma_f32_32x32x16_bf16 v[64:79], a[144:147], v[48:51], v[64:79]
  ds_read_b128 v[56:59], v13 offset:0
  v_cmp_gt_u32 vcc, 3, v164
  s_nop 1
  v_cndmask_b32 v0, v165, v164, vcc
  v_add_u32 v164, s98, v1
  v_mfma_f32_32x32x16_bf16 v[80:95], a[148:151], v[48:51], v[80:95]
  ds_read_b128 v[60:63], v13 offset:8192
  buffer_load_dwordx4 v9, s[8:11], s28 offen offset:3072 lds
  v_and_b32 v164, 1, v164
  v_cmp_gt_u32 vcc, 3, v1
  s_nop 1
  v_cndmask_b32 v0, v164, v0, vcc
  s_waitcnt lgkmcnt(2)
  v_mfma_f32_32x32x16_bf16 v[96:111], a[144:147], v[52:55], v[96:111]
  s_mul_i32 s3, s98, 13
  s_lshr_b32 s3, s3, 6
  s_mul_i32 s3, s3, 5
  s_sub_u32 s3, s98, s3
  s_sub_u32 s3, s3, 5
  v_add_u32 v164, s3, v1
  v_mfma_f32_32x32x16_bf16 v[112:127], a[148:151], v[52:55], v[112:127]
  v_subrev_u32 v165, 5, v164
  v_cmp_gt_u32 vcc, 5, v164
  s_nop 1
  v_cndmask_b32 v164, v165, v164, vcc
  s_waitcnt lgkmcnt(1)
  v_mfma_f32_32x32x16_bf16 v[64:79], a[152:155], v[56:59], v[64:79]
  s_waitcnt vmcnt(13) lgkmcnt(0)
  s_barrier
  ds_read_b128 v[48:51], v10 offset:16384
  v_subrev_u32 v166, 5, v1
  v_cmp_gt_u32 vcc, 5, v166
  s_nop 1
  v_cndmask_b32 v0, v0, v164, vcc
  v_mfma_f32_32x32x16_bf16 v[80:95], a[156:159], v[56:59], v[80:95]
  ds_read_b128 a[160:163], v20 offset:16384
  s_add_u32 m0, s27, 49152
  s_lshl_b32 s28, s68, 7
  buffer_load_dwordx4 v2, s[4:7], s28 offen offset:0 lds
  v_mfma_f32_32x32x16_bf16 v[96:111], a[152:155], v[60:63], v[96:111]
  ds_read_b128 v[52:55], v10 offset:24576
  ds_read_b128 a[164:167], v20 offset:17408
  buffer_load_dwordx4 v3, s[4:7], s28 offen offset:1024 lds
  v_mfma_f32_32x32x16_bf16 v[112:127], a[156:159], v[60:63], v[112:127]
  v_lshlrev_b32 v0, 2, v0
  v_add_u32 v0, s24, v0
  v_and_b32 v164, 1, v0
  v_mad_u32_u24 v164, v0, 5, v164
  v_add_u32 v165, 2, v164
  s_waitcnt lgkmcnt(2)
  v_mfma_f32_32x32x16_bf16 v[64:79], a[160:163], v[48:51], v[64:79]
  ds_read_b128 v[56:59], v11 offset:16384
  ds_read_b128 a[168:171], v21 offset:16384
  buffer_load_dwordx4 v4, s[4:7], s28 offen offset:2048 lds
  s_add_u32 s68, s68, 1
  s_cmp_ge_u32 s68, 10
  s_cselect_b32 s3, 10, 0
  s_sub_u32 s68, s68, s3
  s_waitcnt lgkmcnt(2)
  v_mfma_f32_32x32x16_bf16 v[80:95], a[164:167], v[48:51], v[80:95]
  ds_read_b128 a[172:175], v21 offset:17408
  v_cmp_gt_u32 vcc, 3, v1
  s_nop 1
  v_cndmask_b32 v164, v165, v164, vcc
  v_mfma_f32_32x32x16_bf16 v[96:111], a[160:163], v[52:55], v[96:111]
  ds_read_b128 v[60:63], v11 offset:24576
  ds_read_b128 a[176:179], v22 offset:16384
  buffer_load_dwordx4 v5, s[4:7], s28 offen offset:3072 lds
  v_lshlrev_b32 v165, 1, v0
  v_mfma_f32_32x32x16_bf16 v[112:127], a[164:167], v[52:55], v[112:127]
  ds_read_b128 a[180:183], v22 offset:17408
  v_add_u32 v165, 54, v165
  v_cmp_gt_u32 vcc, 5, v166
  s_nop 1
  v_cndmask_b32 v164, v164, v165, vcc
  s_waitcnt lgkmcnt(4)
  v_mfma_f32_32x32x16_bf16 v[64:79], a[168:171], v[56:59], v[64:79]
  ds_read_b128 v[48:51], v12 offset:16384
  ds_read_b128 a[184:187], v23 offset:16384
  s_add_u32 m0, s27, 114688
  s_lshl_b32 s28, s69, 7
  buffer_load_dwordx4 v6, s[8:11], s28 offen offset:0 lds
  s_waitcnt lgkmcnt(5)
  v_mfma_f32_32x32x16_bf16 v[80:95], a[172:175], v[56:59], v[80:95]
  ds_read_b128 a[188:191], v23 offset:17408
  buffer_load_dwordx4 v7, s[8:11], s28 offen offset:1024 lds
  v_add_u32 v165, 40, v164
  v_mul_u32_u24 v166, 10, v0
  s_waitcnt lgkmcnt(5)
  v_mfma_f32_32x32x16_bf16 v[96:111], a[168:171], v[60:63], v[96:111]
  ds_read_b128 v[52:55], v12 offset:24576
  v_subrev_u32 v166, 26, v166
  v_cmp_gt_u32 vcc, 3, v0
  s_nop 1
  v_cndmask_b32 v165, v166, v165, vcc
  v_mfma_f32_32x32x16_bf16 v[112:127], a[172:175], v[60:63], v[112:127]
  buffer_load_dwordx4 v8, s[8:11], s28 offen offset:2048 lds
  s_add_u32 s69, s69, 1
  s_cmp_ge_u32 s69, 10
  s_cselect_b32 s3, 10, 0
  s_sub_u32 s69, s69, s3
  s_waitcnt lgkmcnt(3)
  v_mfma_f32_32x32x16_bf16 v[64:79], a[176:179], v[48:51], v[64:79]
  ds_read_b128 v[56:59], v13 offset:16384
  v_cmp_gt_u32 vcc, 10, v1
  s_nop 1
  v_cndmask_b32 v164, v165, v164, vcc
  s_bfe_u32 s3, s2, 0x10002
  v_add_u32 v164, s3, v164
  v_mfma_f32_32x32x16_bf16 v[80:95], a[180:183], v[48:51], v[80:95]
  ds_read_b128 v[60:63], v13 offset:24576
  buffer_load_dwordx4 v9, s[8:11], s28 offen offset:3072 lds
  v_mov_b32 v165, 0x10000
  v_cmp_eq_u32 vcc, 11, v0
  v_cmp_gt_u32 s[54:55], 3, v1
  s_and_b64 vcc, vcc, s[54:55]
  s_nop 0
  v_cndmask_b32 v0, v164, v165, vcc
  s_waitcnt lgkmcnt(2)
  v_mfma_f32_32x32x16_bf16 v[96:111], a[176:179], v[52:55], v[96:111]
  v_lshlrev_b32 v0, 10, v0
  v_mfma_f32_32x32x16_bf16 v[112:127], a[180:183], v[52:55], v[112:127]
  s_lshl_b32 s3, s36, 13
  s_add_u32 s56, s3, 2686976
  s_add_u32 s16, s38, s56
  s_addc_u32 s17, s39, 0
  s_mov_b32 s18, 8192
  s_waitcnt lgkmcnt(1)
  v_mfma_f32_32x32x16_bf16 v[64:79], a[184:187], v[56:59], v[64:79]
  s_waitcnt vmcnt(8) lgkmcnt(0)
  s_barrier
  ds_read_b128 v[48:51], v10 offset:32768
  ds_read_b128 v[128:131], v18 offset:0
  v_mfma_f32_32x32x16_bf16 v[80:95], a[188:191], v[56:59], v[80:95]
  ds_read_b128 a[192:195], v20 offset:32768
  s_add_u32 m0, s27, 0
  s_lshl_b32 s28, s68, 7
  buffer_load_dwordx4 v2, s[4:7], s28 offen offset:0 lds
  v_mfma_f32_32x32x16_bf16 v[96:111], a[184:187], v[60:63], v[96:111]
  ds_read_b128 v[52:55], v10 offset:40960
  ds_read_b128 a[196:199], v20 offset:33792
  buffer_load_dwordx4 v3, s[4:7], s28 offen offset:1024 lds
  ds_read_b128 v[132:135], v18 offset:1024
  v_mfma_f32_32x32x16_bf16 v[112:127], a[188:191], v[60:63], v[112:127]
  ds_read_b128 v[136:139], v18 offset:2048
  ds_read_b128 v[140:143], v18 offset:3072
  ds_read_b128 v[144:147], v18 offset:4096
  s_waitcnt lgkmcnt(7)
  buffer_store_dwordx4 v[128:131], v14, s[20:23], s46 offen offset:0 sc1
  s_waitcnt lgkmcnt(6)
  v_mfma_f32_32x32x16_bf16 v[64:79], a[192:195], v[48:51], v[64:79]
  ds_read_b128 v[56:59], v11 offset:32768
  ds_read_b128 a[200:203], v21 offset:32768
  buffer_load_dwordx4 v4, s[4:7], s28 offen offset:2048 lds
  s_add_u32 s68, s68, 1
  s_cmp_ge_u32 s68, 10
  s_cselect_b32 s3, 10, 0
  s_sub_u32 s68, s68, s3
  s_waitcnt lgkmcnt(6)
  v_mfma_f32_32x32x16_bf16 v[80:95], a[196:199], v[48:51], v[80:95]
  ds_read_b128 a[204:207], v21 offset:33792
  s_waitcnt lgkmcnt(6)
  buffer_store_dwordx4 v[132:135], v14, s[20:23], s46 offen offset:1024 sc1
  v_mfma_f32_32x32x16_bf16 v[96:111], a[192:195], v[52:55], v[96:111]
  ds_read_b128 v[60:63], v11 offset:40960
  ds_read_b128 a[208:211], v22 offset:32768
  buffer_load_dwordx4 v5, s[4:7], s28 offen offset:3072 lds
  s_waitcnt lgkmcnt(7)
  buffer_store_dwordx4 v[136:139], v14, s[20:23], s46 offen offset:2048 sc1
  v_mfma_f32_32x32x16_bf16 v[112:127], a[196:199], v[52:55], v[112:127]
  ds_read_b128 a[212:215], v22 offset:33792
  s_waitcnt lgkmcnt(4)
  v_mfma_f32_32x32x16_bf16 v[64:79], a[200:203], v[56:59], v[64:79]
  ds_read_b128 v[48:51], v12 offset:32768
  ds_read_b128 a[216:219], v23 offset:32768
  s_add_u32 m0, s27, 65536
  s_lshl_b32 s28, s69, 7
  buffer_load_dwordx4 v6, s[8:11], s28 offen offset:0 lds
  s_waitcnt lgkmcnt(5)
  v_mfma_f32_32x32x16_bf16 v[80:95], a[204:207], v[56:59], v[80:95]
  ds_read_b128 a[220:223], v23 offset:33792
  buffer_load_dwordx4 v7, s[8:11], s28 offen offset:1024 lds
  buffer_store_dwordx4 v[140:143], v14, s[20:23], s46 offen offset:3072 sc1
  s_waitcnt lgkmcnt(5)
  v_mfma_f32_32x32x16_bf16 v[96:111], a[200:203], v[60:63], v[96:111]
  ds_read_b128 v[52:55], v12 offset:40960
  v_mfma_f32_32x32x16_bf16 v[112:127], a[204:207], v[60:63], v[112:127]
  buffer_load_dwordx4 v8, s[8:11], s28 offen offset:2048 lds
  s_add_u32 s69, s69, 1
  s_cmp_ge_u32 s69, 10
  s_cselect_b32 s3, 10, 0
  s_sub_u32 s69, s69, s3
  s_waitcnt lgkmcnt(3)
  v_mfma_f32_32x32x16_bf16 v[64:79], a[208:211], v[48:51], v[64:79]
  ds_read_b128 v[56:59], v13 offset:32768
  v_mfma_f32_32x32x16_bf16 v[80:95], a[212:215], v[48:51], v[80:95]
  ds_read_b128 v[60:63], v13 offset:40960
  buffer_load_dwordx4 v9, s[8:11], s28 offen offset:3072 lds
  s_waitcnt lgkmcnt(2)
  v_mfma_f32_32x32x16_bf16 v[96:111], a[208:211], v[52:55], v[96:111]
  s_add_u32 s46, s46, 4096
  buffer_store_dwordx4 v[144:147], v14, s[20:23], s46 offen offset:0 sc1
  s_add_u32 s54, s57, 0
  s_mul_i32 s3, s34, 2560
  s_add_u32 s54, s54, s3
  buffer_load_dwordx4 v[156:159], v16, s[64:67], s54 offen offset:0 sc1
  v_mfma_f32_32x32x16_bf16 v[112:127], a[212:215], v[52:55], v[112:127]
  s_add_u32 s54, s57, 0
  s_mul_i32 s3, s34, 2560
  s_add_u32 s54, s54, s3
  buffer_load_dwordx4 v[160:163], v16, s[64:67], s54 offen offset:1024 sc1
  s_waitcnt lgkmcnt(1)
  v_mfma_f32_32x32x16_bf16 v[64:79], a[216:219], v[56:59], v[64:79]
  s_waitcnt vmcnt(15) lgkmcnt(0)
  s_barrier
  ds_read_b128 v[48:51], v10 offset:49152
  v_mfma_f32_32x32x16_bf16 v[80:95], a[220:223], v[56:59], v[80:95]
  ds_read_b128 a[224:227], v20 offset:49152
  s_add_u32 m0, s27, 16384
  s_lshl_b32 s28, s68, 7
  buffer_load_dwordx4 v2, s[4:7], s28 offen offset:0 lds
  v_mfma_f32_32x32x16_bf16 v[96:111], a[216:219], v[60:63], v[96:111]
  ds_read_b128 v[52:55], v10 offset:57344
  ds_read_b128 a[228:231], v20 offset:50176
  buffer_load_dwordx4 v3, s[4:7], s28 offen offset:1024 lds
  s_add_u32 s54, s57, 0
  s_mul_i32 s3, s34, 2560
  s_add_u32 s54, s54, s3
  buffer_load_dwordx4 v[164:167], v17, s[64:67], s54 offen offset:0 sc1
  v_mfma_f32_32x32x16_bf16 v[112:127], a[220:223], v[60:63], v[112:127]
  s_waitcnt lgkmcnt(2)
  v_mfma_f32_32x32x16_bf16 v[64:79], a[224:227], v[48:51], v[64:79]
  ds_read_b128 v[56:59], v11 offset:49152
  ds_read_b128 a[232:235], v21 offset:49152
  buffer_load_dwordx4 v4, s[4:7], s28 offen offset:2048 lds
  s_add_u32 s68, s68, 1
  s_cmp_ge_u32 s68, 10
  s_cselect_b32 s3, 10, 0
  s_sub_u32 s68, s68, s3
  s_waitcnt lgkmcnt(2)
  v_mfma_f32_32x32x16_bf16 v[80:95], a[228:231], v[48:51], v[80:95]
  ds_read_b128 a[236:239], v21 offset:50176
  v_mfma_f32_32x32x16_bf16 v[96:111], a[224:227], v[52:55], v[96:111]
  ds_read_b128 v[60:63], v11 offset:57344
  ds_read_b128 a[240:243], v22 offset:49152
  buffer_load_dwordx4 v5, s[4:7], s28 offen offset:3072 lds
  v_mfma_f32_32x32x16_bf16 v[112:127], a[228:231], v[52:55], v[112:127]
  ds_read_b128 a[244:247], v22 offset:50176
  s_waitcnt lgkmcnt(4)
  v_mfma_f32_32x32x16_bf16 v[64:79], a[232:235], v[56:59], v[64:79]
  ds_read_b128 v[48:51], v12 offset:49152
  ds_read_b128 a[248:251], v23 offset:49152
  s_add_u32 m0, s27, 81920
  s_lshl_b32 s28, s69, 7
  buffer_load_dwordx4 v6, s[8:11], s28 offen offset:0 lds
  s_waitcnt lgkmcnt(5)
  v_mfma_f32_32x32x16_bf16 v[80:95], a[236:239], v[56:59], v[80:95]
  ds_read_b128 a[252:255], v23 offset:50176
  buffer_load_dwordx4 v7, s[8:11], s28 offen offset:1024 lds
  s_mov_b32 s54, 65536
  buffer_load_dwordx4 v[170:173], v189, s[64:67], s54 offen sc1
  buffer_load_dwordx4 v[174:177], v189, s[64:67], s54 offen offset:128 sc1
  s_waitcnt lgkmcnt(5)
  v_mfma_f32_32x32x16_bf16 v[96:111], a[232:235], v[60:63], v[96:111]
  ds_read_b128 v[52:55], v12 offset:57344
  v_mfma_f32_32x32x16_bf16 v[112:127], a[236:239], v[60:63], v[112:127]
  buffer_load_dwordx4 v8, s[8:11], s28 offen offset:2048 lds
  s_add_u32 s69, s69, 1
  s_cmp_ge_u32 s69, 10
  s_cselect_b32 s3, 10, 0
  s_sub_u32 s69, s69, s3
  s_waitcnt lgkmcnt(3)
  v_mfma_f32_32x32x16_bf16 v[64:79], a[240:243], v[48:51], v[64:79]
  ds_read_b128 v[56:59], v13 offset:49152
  v_mfma_f32_32x32x16_bf16 v[80:95], a[244:247], v[48:51], v[80:95]
  ds_read_b128 v[60:63], v13 offset:57344
  buffer_load_dwordx4 v9, s[8:11], s28 offen offset:3072 lds
  s_waitcnt lgkmcnt(2)
  v_mfma_f32_32x32x16_bf16 v[96:111], a[240:243], v[52:55], v[96:111]
  v_mfma_f32_32x32x16_bf16 v[112:127], a[244:247], v[52:55], v[112:127]
  s_waitcnt lgkmcnt(1)
  v_mfma_f32_32x32x16_bf16 v[64:79], a[248:251], v[56:59], v[64:79]
  s_waitcnt vmcnt(14) lgkmcnt(0)
  s_barrier
  ds_read_b128 v[48:51], v10 offset:0
  v_mfma_f32_32x32x16_bf16 v[80:95], a[252:255], v[56:59], v[80:95]
  ds_read_b128 v[192:195], v20 offset:0
  s_add_u32 m0, s27, 98304
  s_lshl_b32 s28, s69, 7
  s_add_u32 s28, s28, 81920
  buffer_load_dwordx4 v6, s[8:11], s28 offen offset:0 lds
  v_mfma_f32_32x32x16_bf16 v[96:111], a[248:251], v[60:63], v[96:111]
  ds_read_b128 v[52:55], v10 offset:8192
  ds_read_b128 v[196:199], v20 offset:1024
  buffer_load_dwordx4 v7, s[8:11], s28 offen offset:1024 lds
  v_mfma_f32_32x32x16_bf16 v[112:127], a[252:255], v[60:63], v[112:127]
  s_waitcnt lgkmcnt(2)
  v_mfma_f32_32x32x16_bf16 v[64:79], v[192:195], v[48:51], v[64:79]
  ds_read_b128 v[56:59], v11 offset:0
  ds_read_b128 v[200:203], v21 offset:0
  buffer_load_dwordx4 v8, s[8:11], s28 offen offset:2048 lds
  s_add_u32 s69, s69, 1
  s_cmp_ge_u32 s69, 10
  s_cselect_b32 s3, 10, 0
  s_sub_u32 s69, s69, s3
  s_waitcnt lgkmcnt(2)
  v_mfma_f32_32x32x16_bf16 v[80:95], v[196:199], v[48:51], v[80:95]
  ds_read_b128 v[204:207], v21 offset:1024
  v_mfma_f32_32x32x16_bf16 v[96:111], v[192:195], v[52:55], v[96:111]
  ds_read_b128 v[60:63], v11 offset:8192
  ds_read_b128 v[208:211], v22 offset:0
  buffer_load_dwordx4 v9, s[8:11], s28 offen offset:3072 lds
  v_mfma_f32_32x32x16_bf16 v[112:127], v[196:199], v[52:55], v[112:127]
  ds_read_b128 v[212:215], v22 offset:1024
  s_waitcnt lgkmcnt(4)
  v_mfma_f32_32x32x16_bf16 v[64:79], v[200:203], v[56:59], v[64:79]
  ds_read_b128 v[48:51], v12 offset:0
  ds_read_b128 v[216:219], v23 offset:0
  s_add_u32 m0, s27, 114688
  s_lshl_b32 s28, s69, 7
  s_add_u32 s28, s28, 81920
  buffer_load_dwordx4 v6, s[8:11], s28 offen offset:0 lds
  s_waitcnt lgkmcnt(5)
  v_mfma_f32_32x32x16_bf16 v[80:95], v[204:207], v[56:59], v[80:95]
  ds_read_b128 v[220:223], v23 offset:1024
  buffer_load_dwordx4 v7, s[8:11], s28 offen offset:1024 lds
  s_waitcnt lgkmcnt(5)
  v_mfma_f32_32x32x16_bf16 v[96:111], v[200:203], v[60:63], v[96:111]
  ds_read_b128 v[52:55], v12 offset:8192
  v_mfma_f32_32x32x16_bf16 v[112:127], v[204:207], v[60:63], v[112:127]
  buffer_load_dwordx4 v8, s[8:11], s28 offen offset:2048 lds
  s_add_u32 s69, s69, 1
  s_cmp_ge_u32 s69, 10
  s_cselect_b32 s3, 10, 0
  s_sub_u32 s69, s69, s3
  s_waitcnt lgkmcnt(3)
  v_mfma_f32_32x32x16_bf16 v[64:79], v[208:211], v[48:51], v[64:79]
  ds_read_b128 v[56:59], v13 offset:0
  v_mfma_f32_32x32x16_bf16 v[80:95], v[212:215], v[48:51], v[80:95]
  ds_read_b128 v[60:63], v13 offset:8192
  buffer_load_dwordx4 v9, s[8:11], s28 offen offset:3072 lds
  s_waitcnt lgkmcnt(2)
  v_mfma_f32_32x32x16_bf16 v[96:111], v[208:211], v[52:55], v[96:111]
  v_mfma_f32_32x32x16_bf16 v[112:127], v[212:215], v[52:55], v[112:127]
  s_waitcnt lgkmcnt(1)
  v_mfma_f32_32x32x16_bf16 v[64:79], v[216:219], v[56:59], v[64:79]
  s_waitcnt vmcnt(8) lgkmcnt(0)
  s_barrier
  ds_read_b128 v[48:51], v10 offset:16384
  s_mul_i32 s3, s25, 5
  s_add_u32 s3, s3, s26
  s_lshl_b32 s3, s3, 2
  s_add_u32 s54, s3, 4052
  s_cmp_eq_u32 s24, 0
  s_cselect_b32 s54, s54, 1073741824
  v_mov_b32 v128, s60
  v_mul_u32_u24 v129, 0, v1
  s_mov_b64 exec, 1
  buffer_store_dword v128, v129, s[64:67], s54 offen sc1
  s_mov_b64 exec, -1
  v_mfma_f32_32x32x16_bf16 v[80:95], v[220:223], v[56:59], v[80:95]
  ds_read_b128 v[224:227], v20 offset:16384
  s_add_u32 m0, s27, 65536
  s_lshl_b32 s28, s69, 7
  s_add_u32 s28, s28, 81920
  buffer_load_dwordx4 v6, s[8:11], s28 offen offset:0 lds
  v_mfma_f32_32x32x16_bf16 v[96:111], v[216:219], v[60:63], v[96:111]
  ds_read_b128 v[52:55], v10 offset:24576
  ds_read_b128 v[228:231], v20 offset:17408
  v_mfma_f32_32x32x16_bf16 v[112:127], v[220:223], v[60:63], v[112:127]
  s_waitcnt lgkmcnt(2)
  v_mfma_f32_32x32x16_bf16 v[64:79], v[224:227], v[48:51], v[64:79]
  ds_read_b128 v[56:59], v11 offset:16384
  ds_read_b128 v[232:235], v21 offset:16384
  s_sub_u32 s3, 15, s25
  s_lshl_b32 s3, s3, 9
  v_lshlrev_b32 v4, 4, v179
  v_add_u32 v4, s3, v4
  s_waitcnt lgkmcnt(2)
  v_mfma_f32_32x32x16_bf16 v[80:95], v[228:231], v[48:51], v[80:95]
  ds_read_b128 v[236:239], v21 offset:17408
  buffer_load_dwordx4 v7, s[8:11], s28 offen offset:1024 lds
  s_lshl_b32 s3, s24, 8
  s_add_u32 s3, s3, 151552
  v_lshrrev_b32 v5, 5, v1
  v_lshlrev_b32 v5, 7, v5
  v_add_u32 v5, s3, v5
  v_mfma_f32_32x32x16_bf16 v[96:111], v[224:227], v[52:55], v[96:111]
  ds_read_b128 v[60:63], v11 offset:24576
  ds_read_b128 v[240:243], v22 offset:16384
  v_mfma_f32_32x32x16_bf16 v[112:127], v[228:231], v[52:55], v[112:127]
  ds_read_b128 v[244:247], v22 offset:17408
  s_mov_b32 s62, 0
L_CHK12:
  v_bitop3_b32 v158, v156, v157, v158 bitop3:0x96
  v_bitop3_b32 v162, v160, v161, v162 bitop3:0x96
  v_bitop3_b32 v166, v164, v165, v166 bitop3:0x96
  v_cmp_ne_u64 s[54:55], s[60:61], v[158:159]
  v_cmp_ne_u64 vcc, s[60:61], v[162:163]
  s_or_b64 s[54:55], s[54:55], vcc
  v_cmp_ne_u64 vcc, s[60:61], v[166:167]
  s_or_b64 vcc, s[54:55], vcc
  s_cbranch_vccz L_OK12
  s_add_u32 s62, s62, 1
  s_cmp_lt_u32 s62, 0x40000
  s_cbranch_scc0 L_OK12
  s_sleep 2
  s_add_u32 s54, s57, 0
  s_mul_i32 s3, s34, 2560
  s_add_u32 s54, s54, s3
  buffer_load_dwordx4 v[156:159], v16, s[64:67], s54 offen offset:0 sc1
  s_add_u32 s54, s57, 0
  s_mul_i32 s3, s34, 2560
  s_add_u32 s54, s54, s3
  buffer_load_dwordx4 v[160:163], v16, s[64:67], s54 offen offset:1024 sc1
  s_add_u32 s54, s57, 0
  s_mul_i32 s3, s34, 2560
  s_add_u32 s54, s54, s3
  buffer_load_dwordx4 v[164:167], v17, s[64:67], s54 offen offset:0 sc1
  s_waitcnt vmcnt(0)
  s_branch L_CHK12
L_OK12:
  s_waitcnt lgkmcnt(4)
  v_mfma_f32_32x32x16_bf16 v[64:79], v[232:235], v[56:59], v[64:79]
  ds_read_b128 v[48:51], v12 offset:16384
  ds_read_b128 v[248:251], v23 offset:16384
  v_add_f32 v156, v156, v160
  v_add_f32 v157, v157, v161
  s_waitcnt lgkmcnt(5)
  v_mfma_f32_32x32x16_bf16 v[80:95], v[236:239], v[56:59], v[80:95]
  ds_read_b128 v[252:255], v23 offset:17408
  buffer_load_dwordx4 v8, s[8:11], s28 offen offset:2048 lds
  s_add_u32 s69, s69, 1
  s_cmp_ge_u32 s69, 10
  s_cselect_b32 s3, 10, 0
  s_sub_u32 s69, s69, s3
  s_waitcnt lgkmcnt(5)
  v_mfma_f32_32x32x16_bf16 v[96:111], v[232:235], v[60:63], v[96:111]
  ds_read_b128 v[52:55], v12 offset:24576
  v_fmac_f32 v156, v164, v15
  v_fmac_f32 v157, v165, v15
  v_mov_b32 v41, 0
  v_mov_b32 v43, 0
  v_mfma_f32_32x32x16_bf16 v[112:127], v[236:239], v[60:63], v[112:127]
  v_permlane16_swap_b32 v156, v157
  v_add_f32 v156, v156, v157
  v_mov_b32 v157, v156
  v_lshrrev_b32 v158, 2, v16
  s_nop 0
  s_waitcnt lgkmcnt(3)
  v_mfma_f32_32x32x16_bf16 v[64:79], v[240:243], v[48:51], v[64:79]
  ds_read_b128 v[56:59], v13 offset:16384
  v_permlane32_swap_b32 v156, v157
  v_add_f32 v156, v156, v157
  v_cvt_pk_bf16_f32 v157, v156, v156
  v_and_b32 v157, 0xffff0000, v157
  v_mfma_f32_32x32x16_bf16 v[80:95], v[244:247], v[48:51], v[80:95]
  ds_read_b128 v[60:63], v13 offset:24576
  buffer_load_dwordx4 v9, s[8:11], s28 offen offset:3072 lds
  v_sub_f32 v156, v156, v157
  v_cvt_pk_bf16_f32 v156, v157, v156
  s_waitcnt lgkmcnt(2)
  v_mfma_f32_32x32x16_bf16 v[96:111], v[240:243], v[52:55], v[96:111]
  v_cndmask_b32 v156, v156, 0, s[58:59]
  s_lshl_b32 s3, s35, 9
  s_add_u32 s3, s3, 152576
  v_add_u32 v158, s3, v158
  s_lshl_b32 s3, s34, 8
  v_add_u32 v159, s3, v158
  v_mfma_f32_32x32x16_bf16 v[112:127], v[244:247], v[52:55], v[112:127]
  ds_write_b32 v159, v156
  s_mov_b32 s62, 0
L_CHK13:
  v_bitop3_b32 v172, v170, v171, v172 bitop3:0x96
  v_bitop3_b32 v176, v174, v175, v176 bitop3:0x96
  v_cmp_ne_u64 s[54:55], s[60:61], v[172:173]
  v_cmp_ne_u64 vcc, s[60:61], v[176:177]
  s_or_b64 vcc, s[54:55], vcc
  s_cbranch_vccz L_OK13
  s_add_u32 s62, s62, 1
  s_cmp_lt_u32 s62, 0x40000
  s_cbranch_scc0 L_OK13
  s_sleep 2
  s_mov_b32 s54, 65536
  buffer_load_dwordx4 v[170:173], v189, s[64:67], s54 offen sc1
  buffer_load_dwordx4 v[174:177], v189, s[64:67], s54 offen offset:128 sc1
  s_waitcnt vmcnt(0)
  s_branch L_CHK13
L_OK13:
  s_waitcnt lgkmcnt(2)
  v_mfma_f32_32x32x16_bf16 v[64:79], v[248:251], v[56:59], v[64:79]
  s_waitcnt vmcnt(9) lgkmcnt(0)
  s_barrier
  ds_read_b128 v[48:51], v10 offset:32768
  v_mfma_f32_32x32x16_bf16 v[80:95], v[252:255], v[56:59], v[80:95]
  s_add_u32 m0, s27, 81920
  s_lshl_b32 s28, s69, 7
  s_add_u32 s28, s28, 81920
  buffer_load_dwordx4 v6, s[8:11], s28 offen offset:0 lds
  v_mfma_f32_32x32x16_bf16 v[96:111], v[248:251], v[60:63], v[96:111]
  ds_read_b128 v[52:55], v10 offset:40960
  v_cvt_pk_bf16_f32 v36, -v170, -v170
  v_mov_b32 v37, 0
  v_rcp_f32 v172, v171
  v_mfma_f32_32x32x16_bf16 v[112:127], v[252:255], v[60:63], v[112:127]
  v_cvt_pk_bf16_f32 v38, -v174, -v174
  v_mov_b32 v39, 0
  v_rcp_f32 v176, v175
  s_nop 0
  ds_write_b32 v178, v172 offset:0
  ds_write_b32 v178, v176 offset:64
  ds_read_b32 v40, v158
  ds_read_b32 v42, v158 offset:256
  v_mov_b32 v20, v184
  v_mov_b32 v21, v185
  v_mov_b32 v22, v186
  v_mov_b32 v23, v187
  s_waitcnt lgkmcnt(0)
  s_nop 1
  v_mfma_f32_32x32x8_bf16 v[64:79], v[36:37], v[40:41], v[64:79]
  v_mfma_f32_32x32x8_bf16 v[80:95], v[38:39], v[40:41], v[80:95]
  v_mfma_f32_32x32x8_bf16 v[96:111], v[36:37], v[42:43], v[96:111]
  v_mfma_f32_32x32x8_bf16 v[112:127], v[38:39], v[42:43], v[112:127]
  v_mfma_f32_32x32x16_bf16 v[128:143], a[0:3], v[48:51], 0
  ds_read_b128 v[56:59], v11 offset:32768
  s_add_u32 s56, s56, 0x4000
  s_add_u32 s20, s38, s56
  s_addc_u32 s21, s39, 0
  s_mov_b32 s22, 8192
  s_cmp_eq_u32 s34, 1
  s_cselect_b64 s[52:53], -1, 0
  v_mfma_f32_32x32x16_bf16 v[144:159], a[4:7], v[48:51], 0
  v_mfma_f32_16x16x32_bf16 v[24:27], v[32:35], v[48:51], 0
  buffer_load_dwordx4 v7, s[8:11], s28 offen offset:1024 lds
  v_mfma_f32_32x32x16_bf16 v[160:175], a[0:3], v[52:55], 0
  ds_read_b128 v[60:63], v11 offset:40960
  v_mfma_f32_32x32x16_bf16 v[176:191], a[4:7], v[52:55], 0
  v_mfma_f32_16x16x32_bf16 v[28:31], v[32:35], v[52:55], 0
  s_waitcnt lgkmcnt(1)
  v_mfma_f32_32x32x16_bf16 v[128:143], a[8:11], v[56:59], v[128:143]
  ds_read_b128 v[48:51], v12 offset:32768
  v_mfma_f32_32x32x16_bf16 v[144:159], a[12:15], v[56:59], v[144:159]
  v_mfma_f32_16x16x32_bf16 v[24:27], v[32:35], v[56:59], v[24:27]
  buffer_load_dwordx4 v8, s[8:11], s28 offen offset:2048 lds
  s_add_u32 s69, s69, 1
  s_cmp_ge_u32 s69, 10
  s_cselect_b32 s3, 10, 0
  s_sub_u32 s69, s69, s3
  s_waitcnt lgkmcnt(1)
  v_mfma_f32_32x32x16_bf16 v[160:175], a[8:11], v[60:63], v[160:175]
  ds_read_b128 v[52:55], v12 offset:40960
  v_mfma_f32_32x32x16_bf16 v[176:191], a[12:15], v[60:63], v[176:191]
  v_mfma_f32_16x16x32_bf16 v[28:31], v[32:35], v[60:63], v[28:31]
  s_waitcnt lgkmcnt(1)
  v_mfma_f32_32x32x16_bf16 v[128:143], a[16:19], v[48:51], v[128:143]
  ds_read_b128 v[56:59], v13 offset:32768
  v_mfma_f32_32x32x16_bf16 v[144:159], a[20:23], v[48:51], v[144:159]
  v_mfma_f32_16x16x32_bf16 v[24:27], v[32:35], v[48:51], v[24:27]
  ds_read_b128 v[60:63], v13 offset:40960
  buffer_load_dwordx4 v9, s[8:11], s28 offen offset:3072 lds
  s_waitcnt lgkmcnt(2)
  v_mfma_f32_32x32x16_bf16 v[160:175], a[16:19], v[52:55], v[160:175]
  v_mfma_f32_32x32x16_bf16 v[176:191], a[20:23], v[52:55], v[176:191]
  v_mfma_f32_16x16x32_bf16 v[28:31], v[32:35], v[52:55], v[28:31]
  s_waitcnt lgkmcnt(1)
  v_mfma_f32_32x32x16_bf16 v[128:143], a[24:27], v[56:59], v[128:143]
  s_waitcnt vmcnt(9) lgkmcnt(0)
  s_barrier
  ds_read_b128 v[48:51], v10 offset:49152
  v_mfma_f32_32x32x16_bf16 v[144:159], a[28:31], v[56:59], v[144:159]
  v_mfma_f32_16x16x32_bf16 v[24:27], v[32:35], v[56:59], v[24:27]
  s_add_u32 m0, s27, 98304
  s_lshl_b32 s28, s69, 7
  s_add_u32 s28, s28, 81920
  buffer_load_dwordx4 v6, s[8:11], s28 offen offset:0 lds
  v_mfma_f32_32x32x16_bf16 v[160:175], a[24:27], v[60:63], v[160:175]
  ds_read_b128 v[52:55], v10 offset:57344
  v_mfma_f32_32x32x16_bf16 v[176:191], a[28:31], v[60:63], v[176:191]
  v_mfma_f32_16x16x32_bf16 v[28:31], v[32:35], v[60:63], v[28:31]
  s_waitcnt lgkmcnt(1)
  v_mfma_f32_32x32x16_bf16 v[128:143], a[32:35], v[48:51], v[128:143]
  ds_read_b128 v[56:59], v11 offset:49152
  v_mfma_f32_32x32x16_bf16 v[144:159], a[36:39], v[48:51], v[144:159]
  buffer_load_dwordx4 v7, s[8:11], s28 offen offset:1024 lds
  s_waitcnt lgkmcnt(1)
  v_mfma_f32_32x32x16_bf16 v[160:175], a[32:35], v[52:55], v[160:175]
  ds_read_b128 v[60:63], v11 offset:57344
  v_mfma_f32_32x32x16_bf16 v[176:191], a[36:39], v[52:55], v[176:191]
  v_bitop3_b32 v26, v24, v25, s60 bitop3:0x96
  v_mov_b32 v27, s61
  s_lshl_b32 s3, s37, 8
  s_add_u32 s3, s3, s57
  s_add_u32 s3, s3, 10240
  s_mov_b64 exec, 0xffff
  buffer_store_dwordx4 v[24:27], v16, s[64:67], s3 offen sc1
  s_mov_b64 exec, -1
  s_waitcnt lgkmcnt(1)
  v_mfma_f32_32x32x16_bf16 v[128:143], a[40:43], v[56:59], v[128:143]
  ds_read_b128 v[48:51], v12 offset:49152
  v_bitop3_b32 v30, v28, v29, s60 bitop3:0x96
  v_mov_b32 v31, s61
  v_mfma_f32_32x32x16_bf16 v[144:159], a[44:47], v[56:59], v[144:159]
  buffer_load_dwordx4 v8, s[8:11], s28 offen offset:2048 lds
  s_add_u32 s69, s69, 1
  s_cmp_ge_u32 s69, 10
  s_cselect_b32 s3, 10, 0
  s_sub_u32 s69, s69, s3
  s_lshl_b32 s3, s37, 8
  s_add_u32 s3, s3, s57
  s_add_u32 s3, s3, 12800
  s_mov_b64 exec, 0xffff
  buffer_store_dwordx4 v[28:31], v16, s[64:67], s3 offen sc1
  s_mov_b64 exec, -1
  s_waitcnt lgkmcnt(1)
  v_mfma_f32_32x32x16_bf16 v[160:175], a[40:43], v[60:63], v[160:175]
  ds_read_b128 v[52:55], v12 offset:57344
  v_mfma_f32_32x32x16_bf16 v[176:191], a[44:47], v[60:63], v[176:191]
  ds_read_b128 v[28:31], v5 offset:0
  ds_read_b128 v[32:35], v5 offset:16
  s_waitcnt lgkmcnt(1)
  v_mul_f32 v64, v64, v28
  v_mul_f32 v65, v65, v29
  v_mfma_f32_32x32x16_bf16 v[128:143], a[48:51], v[48:51], v[128:143]
  ds_read_b128 v[56:59], v13 offset:49152
  v_mul_f32 v66, v66, v30
  v_mul_f32 v67, v67, v31
  v_mul_f32 v96, v96, v28
  v_mul_f32 v97, v97, v29
  v_mul_f32 v98, v98, v30
  v_mfma_f32_32x32x16_bf16 v[144:159], a[52:55], v[48:51], v[144:159]
  ds_read_b128 v[60:63], v13 offset:57344
  buffer_load_dwordx4 v9, s[8:11], s28 offen offset:3072 lds
  v_mul_f32 v99, v99, v31
  v_mov_b32 v18, v64
  v_mov_b32 v19, v96
  v_mfma_f32_32x32x16_bf16 v[160:175], a[48:51], v[52:55], v[160:175]
  v_mov_b32 v24, v65
  v_mov_b32 v25, v97
  v_fma_f32 v26, -v45, v19, v66
  v_fma_f32 v27, v45, v18, v98
  v_fma_f32 v18, v44, v18, v26
  v_fma_f32 v19, v44, v19, v27
  v_mfma_f32_32x32x16_bf16 v[176:191], a[52:55], v[52:55], v[176:191]
  v_fma_f32 v26, -v45, v25, v67
  v_fma_f32 v27, v45, v24, v99
  v_fma_f32 v24, v44, v24, v26
  v_fma_f32 v25, v44, v25, v27
  ds_read_b128 v[28:31], v5 offset:32
  s_waitcnt lgkmcnt(3)
  s_waitcnt lgkmcnt(2)
  v_mfma_f32_32x32x16_bf16 v[128:143], a[56:59], v[56:59], v[128:143]
  s_waitcnt vmcnt(10) lgkmcnt(0)
  s_barrier
  ds_read_b128 v[48:51], v10 offset:0
  v_mul_f32 v68, v68, v32
  v_mul_f32 v69, v69, v33
  v_mul_f32 v70, v70, v34
  v_mfma_f32_32x32x16_bf16 v[144:159], a[60:63], v[56:59], v[144:159]
  s_add_u32 m0, s27, 114688
  s_lshl_b32 s28, s69, 7
  s_add_u32 s28, s28, 81920
  buffer_load_dwordx4 v6, s[8:11], s28 offen offset:0 lds
  v_mul_f32 v71, v71, v35
  v_mfma_f32_32x32x16_bf16 v[160:175], a[56:59], v[60:63], v[160:175]
  ds_read_b128 v[52:55], v10 offset:8192
  v_mul_f32 v100, v100, v32
  v_mul_f32 v101, v101, v33
  v_mul_f32 v102, v102, v34
  v_mul_f32 v103, v103, v35
  v_fma_f32 v26, -v45, v19, v68
  v_mfma_f32_32x32x16_bf16 v[176:191], a[60:63], v[60:63], v[176:191]
  v_fma_f32 v27, v45, v18, v100
  v_fma_f32 v18, v44, v18, v26
  v_fma_f32 v19, v44, v19, v27
  v_fma_f32 v26, -v45, v25, v69
  v_fma_f32 v27, v45, v24, v101
  v_fma_f32 v24, v44, v24, v26
  s_waitcnt lgkmcnt(1)
  v_mfma_f32_32x32x16_bf16 v[128:143], a[64:67], v[48:51], v[128:143]
  ds_read_b128 v[56:59], v11 offset:0
  v_fma_f32 v25, v44, v25, v27
  v_fma_f32 v26, -v45, v19, v70
  v_fma_f32 v27, v45, v18, v102
  v_fma_f32 v18, v44, v18, v26
  v_fma_f32 v19, v44, v19, v27
  v_mfma_f32_32x32x16_bf16 v[144:159], a[68:71], v[48:51], v[144:159]
  buffer_load_dwordx4 v7, s[8:11], s28 offen offset:1024 lds
  v_fma_f32 v26, -v45, v25, v71
  v_fma_f32 v27, v45, v24, v103
  v_fma_f32 v24, v44, v24, v26
  v_fma_f32 v25, v44, v25, v27
  s_waitcnt lgkmcnt(1)
  v_mfma_f32_32x32x16_bf16 v[160:175], a[64:67], v[52:55], v[160:175]
  ds_read_b128 v[60:63], v11 offset:8192
  ds_read_b128 v[32:35], v5 offset:48
  v_mul_f32 v72, v72, v28
  v_mul_f32 v73, v73, v29
  v_mul_f32 v74, v74, v30
  v_mfma_f32_32x32x16_bf16 v[176:191], a[68:71], v[52:55], v[176:191]
  v_mul_f32 v75, v75, v31
  v_mul_f32 v104, v104, v28
  v_mul_f32 v105, v105, v29
  v_mul_f32 v106, v106, v30
  v_mul_f32 v107, v107, v31
  v_fma_f32 v26, -v45, v19, v72
  s_waitcnt lgkmcnt(2)
  v_mfma_f32_32x32x16_bf16 v[128:143], a[72:75], v[56:59], v[128:143]
  ds_read_b128 v[48:51], v12 offset:0
  v_fma_f32 v27, v45, v18, v104
  v_fma_f32 v18, v44, v18, v26
  v_fma_f32 v19, v44, v19, v27
  v_fma_f32 v26, -v45, v25, v73
  v_fma_f32 v27, v45, v24, v105
  v_mfma_f32_32x32x16_bf16 v[144:159], a[76:79], v[56:59], v[144:159]
  buffer_load_dwordx4 v8, s[8:11], s28 offen offset:2048 lds
  s_add_u32 s69, s69, 1
  s_cmp_ge_u32 s69, 10
  s_cselect_b32 s3, 10, 0
  s_sub_u32 s69, s69, s3
  v_fma_f32 v24, v44, v24, v26
  s_waitcnt lgkmcnt(2)
  v_mfma_f32_32x32x16_bf16 v[160:175], a[72:75], v[60:63], v[160:175]
  ds_read_b128 v[52:55], v12 offset:8192
  v_fma_f32 v25, v44, v25, v27
  v_fma_f32 v26, -v45, v19, v74
  v_fma_f32 v27, v45, v18, v106
  v_fma_f32 v18, v44, v18, v26
  v_fma_f32 v19, v44, v19, v27
  v_mfma_f32_32x32x16_bf16 v[176:191], a[76:79], v[60:63], v[176:191]
  v_fma_f32 v26, -v45, v25, v75
  v_fma_f32 v27, v45, v24, v107
  v_fma_f32 v24, v44, v24, v26
  v_fma_f32 v25, v44, v25, v27
  ds_read_b128 v[28:31], v5 offset:64
  s_waitcnt lgkmcnt(3)
  s_waitcnt lgkmcnt(2)
  v_mfma_f32_32x32x16_bf16 v[128:143], a[80:83], v[48:51], v[128:143]
  ds_read_b128 v[56:59], v13 offset:0
  v_mul_f32 v76, v76, v32
  v_mul_f32 v77, v77, v33
  v_mul_f32 v78, v78, v34
  v_mul_f32 v79, v79, v35
  v_mul_f32 v108, v108, v32
  v_mfma_f32_32x32x16_bf16 v[144:159], a[84:87], v[48:51], v[144:159]
  ds_read_b128 v[60:63], v13 offset:8192
  buffer_load_dwordx4 v9, s[8:11], s28 offen offset:3072 lds
  v_mul_f32 v109, v109, v33
  v_mul_f32 v110, v110, v34
  v_mul_f32 v111, v111, v35
  s_waitcnt lgkmcnt(3)
  v_mfma_f32_32x32x16_bf16 v[160:175], a[80:83], v[52:55], v[160:175]
  v_fma_f32 v26, -v45, v19, v76
  v_fma_f32 v27, v45, v18, v108
  v_fma_f32 v18, v44, v18, v26
  v_fma_f32 v19, v44, v19, v27
  v_fma_f32 v26, -v45, v25, v77
  v_fma_f32 v27, v45, v24, v109
  v_mfma_f32_32x32x16_bf16 v[176:191], a[84:87], v[52:55], v[176:191]
  v_fma_f32 v24, v44, v24, v26
  v_fma_f32 v25, v44, v25, v27
  v_fma_f32 v26, -v45, v19, v78
  v_fma_f32 v27, v45, v18, v110
  v_fma_f32 v18, v44, v18, v26
  v_fma_f32 v19, v44, v19, v27
  s_waitcnt lgkmcnt(1)
  v_mfma_f32_32x32x16_bf16 v[128:143], a[88:91], v[56:59], v[128:143]
  s_waitcnt vmcnt(10) lgkmcnt(0)
  s_barrier
  ds_read_b128 v[48:51], v10 offset:16384
  v_fma_f32 v26, -v45, v25, v79
  v_fma_f32 v27, v45, v24, v111
  v_fma_f32 v24, v44, v24, v26
  v_mfma_f32_32x32x16_bf16 v[144:159], a[92:95], v[56:59], v[144:159]
  s_add_u32 m0, s27, 65536
  s_lshl_b32 s28, s69, 7
  s_add_u32 s28, s28, 81920
  buffer_load_dwordx4 v6, s[8:11], s28 offen offset:0 lds
  v_fma_f32 v25, v44, v25, v27
  v_mfma_f32_32x32x16_bf16 v[160:175], a[88:91], v[60:63], v[160:175]
  ds_read_b128 v[52:55], v10 offset:24576
  ds_read_b128 v[32:35], v5 offset:80
  v_mul_f32 v80, v80, v28
  v_mul_f32 v81, v81, v29
  v_mul_f32 v82, v82, v30
  v_mfma_f32_32x32x16_bf16 v[176:191], a[92:95], v[60:63], v[176:191]
  v_mul_f32 v83, v83, v31
  v_mul_f32 v112, v112, v28
  v_mul_f32 v113, v113, v29
  v_mul_f32 v114, v114, v30
  v_mul_f32 v115, v115, v31
  v_fma_f32 v26, -v45, v19, v80
  s_waitcnt lgkmcnt(2)
  v_mfma_f32_32x32x16_bf16 v[128:143], a[96:99], v[48:51], v[128:143]
  ds_read_b128 v[56:59], v11 offset:16384
  v_fma_f32 v27, v45, v18, v112
  v_fma_f32 v18, v44, v18, v26
  v_fma_f32 v19, v44, v19, v27
  v_fma_f32 v26, -v45, v25, v81
  v_fma_f32 v27, v45, v24, v113
  v_mfma_f32_32x32x16_bf16 v[144:159], a[100:103], v[48:51], v[144:159]
  buffer_load_dwordx4 v7, s[8:11], s28 offen offset:1024 lds
  v_fma_f32 v24, v44, v24, v26
  v_fma_f32 v25, v44, v25, v27
  v_fma_f32 v26, -v45, v19, v82
  v_fma_f32 v27, v45, v18, v114
  s_waitcnt lgkmcnt(2)
  v_mfma_f32_32x32x16_bf16 v[160:175], a[96:99], v[52:55], v[160:175]
  ds_read_b128 v[60:63], v11 offset:24576
  v_fma_f32 v18, v44, v18, v26
  v_fma_f32 v19, v44, v19, v27
  v_fma_f32 v26, -v45, v25, v83
  v_fma_f32 v27, v45, v24, v115
  v_fma_f32 v24, v44, v24, v26
  v_mfma_f32_32x32x16_bf16 v[176:191], a[100:103], v[52:55], v[176:191]
  v_fma_f32 v25, v44, v25, v27
  ds_read_b128 v[28:31], v5 offset:96
  s_waitcnt lgkmcnt(3)
  v_mul_f32 v84, v84, v32
  v_mul_f32 v85, v85, v33
  v_mul_f32 v86, v86, v34
  s_waitcnt lgkmcnt(2)
  v_mfma_f32_32x32x16_bf16 v[128:143], a[104:107], v[56:59], v[128:143]
  ds_read_b128 v[48:51], v12 offset:16384
  v_mul_f32 v87, v87, v35
  v_mul_f32 v116, v116, v32
  v_mul_f32 v117, v117, v33
  v_mul_f32 v118, v118, v34
  v_mul_f32 v119, v119, v35
  v_mfma_f32_32x32x16_bf16 v[144:159], a[108:111], v[56:59], v[144:159]
  buffer_load_dwordx4 v8, s[8:11], s28 offen offset:2048 lds
  s_add_u32 s69, s69, 1
  s_cmp_ge_u32 s69, 10
  s_cselect_b32 s3, 10, 0
  s_sub_u32 s69, s69, s3
  v_fma_f32 v26, -v45, v19, v84
  s_waitcnt lgkmcnt(2)
  v_mfma_f32_32x32x16_bf16 v[160:175], a[104:107], v[60:63], v[160:175]
  ds_read_b128 v[52:55], v12 offset:24576
  v_fma_f32 v27, v45, v18, v116
  v_fma_f32 v18, v44, v18, v26
  v_fma_f32 v19, v44, v19, v27
  v_fma_f32 v26, -v45, v25, v85
  v_fma_f32 v27, v45, v24, v117
  v_mfma_f32_32x32x16_bf16 v[176:191], a[108:111], v[60:63], v[176:191]
  v_fma_f32 v24, v44, v24, v26
  v_fma_f32 v25, v44, v25, v27
  v_fma_f32 v26, -v45, v19, v86
  v_fma_f32 v27, v45, v18, v118
  v_fma_f32 v18, v44, v18, v26
  v_fma_f32 v19, v44, v19, v27
  s_waitcnt lgkmcnt(1)
  v_mfma_f32_32x32x16_bf16 v[128:143], a[112:115], v[48:51], v[128:143]
  ds_read_b128 v[56:59], v13 offset:16384
  v_fma_f32 v26, -v45, v25, v87
  v_fma_f32 v27, v45, v24, v119
  v_fma_f32 v24, v44, v24, v26
  v_fma_f32 v25, v44, v25, v27
  ds_read_b128 v[32:35], v5 offset:112
  v_mfma_f32_32x32x16_bf16 v[144:159], a[116:119], v[48:51], v[144:159]
  ds_read_b128 v[60:63], v13 offset:24576
  buffer_load_dwordx4 v9, s[8:11], s28 offen offset:3072 lds
  v_mul_f32 v88, v88, v28
  v_mul_f32 v89, v89, v29
  s_waitcnt lgkmcnt(3)
  v_mfma_f32_32x32x16_bf16 v[160:175], a[112:115], v[52:55], v[160:175]
  v_mul_f32 v90, v90, v30
  v_mul_f32 v91, v91, v31
  v_mul_f32 v120, v120, v28
  v_mul_f32 v121, v121, v29
  v_mul_f32 v122, v122, v30
  v_mul_f32 v123, v123, v31
  v_mfma_f32_32x32x16_bf16 v[176:191], a[116:119], v[52:55], v[176:191]
  v_fma_f32 v26, -v45, v19, v88
  v_fma_f32 v27, v45, v18, v120
  v_fma_f32 v18, v44, v18, v26
  v_fma_f32 v19, v44, v19, v27
  v_fma_f32 v26, -v45, v25, v89
  v_fma_f32 v27, v45, v24, v121
  s_waitcnt lgkmcnt(2)
  v_mfma_f32_32x32x16_bf16 v[128:143], a[120:123], v[56:59], v[128:143]
  s_waitcnt vmcnt(8) lgkmcnt(0)
  s_barrier
  ds_read_b128 v[48:51], v10 offset:32768
  v_fma_f32 v24, v44, v24, v26
  v_fma_f32 v25, v44, v25, v27
  v_fma_f32 v26, -v45, v19, v90
  v_mfma_f32_32x32x16_bf16 v[144:159], a[124:127], v[56:59], v[144:159]
  s_add_u32 m0, s27, 81920
  s_lshl_b32 s28, s69, 7
  s_add_u32 s28, s28, 81920
  buffer_load_dwordx4 v6, s[8:11], s28 offen offset:0 lds
  v_fma_f32 v27, v45, v18, v122
  v_mfma_f32_32x32x16_bf16 v[160:175], a[120:123], v[60:63], v[160:175]
  ds_read_b128 v[52:55], v10 offset:40960
  v_fma_f32 v18, v44, v18, v26
  v_fma_f32 v19, v44, v19, v27
  v_fma_f32 v26, -v45, v25, v91
  v_fma_f32 v27, v45, v24, v123
  v_fma_f32 v24, v44, v24, v26
  v_mfma_f32_32x32x16_bf16 v[176:191], a[124:127], v[60:63], v[176:191]
  v_fma_f32 v25, v44, v25, v27
  v_mul_f32 v92, v92, v32
  v_mul_f32 v93, v93, v33
  v_mul_f32 v94, v94, v34
  v_mul_f32 v95, v95, v35
  s_waitcnt lgkmcnt(1)
  v_mfma_f32_32x32x16_bf16 v[128:143], a[128:131], v[48:51], v[128:143]
  ds_read_b128 v[56:59], v11 offset:32768
  v_mul_f32 v124, v124, v32
  v_mul_f32 v125, v125, v33
  v_mul_f32 v126, v126, v34
  v_mul_f32 v127, v127, v35
  v_fma_f32 v26, -v45, v19, v92
  v_mfma_f32_32x32x16_bf16 v[144:159], a[132:135], v[48:51], v[144:159]
  buffer_load_dwordx4 v7, s[8:11], s28 offen offset:1024 lds
  v_fma_f32 v27, v45, v18, v124
  v_fma_f32 v18, v44, v18, v26
  v_fma_f32 v19, v44, v19, v27
  v_fma_f32 v26, -v45, v25, v93
  s_waitcnt lgkmcnt(1)
  v_mfma_f32_32x32x16_bf16 v[160:175], a[128:131], v[52:55], v[160:175]
  ds_read_b128 v[60:63], v11 offset:40960
  v_fma_f32 v27, v45, v24, v125
  v_fma_f32 v24, v44, v24, v26
  v_fma_f32 v25, v44, v25, v27
  v_fma_f32 v26, -v45, v19, v94
  v_fma_f32 v27, v45, v18, v126
  v_mfma_f32_32x32x16_bf16 v[176:191], a[132:135], v[52:55], v[176:191]
  v_fma_f32 v18, v44, v18, v26
  v_fma_f32 v19, v44, v19, v27
  v_fma_f32 v26, -v45, v25, v95
  v_fma_f32 v27, v45, v24, v127
  v_fma_f32 v24, v44, v24, v26
  v_fma_f32 v25, v44, v25, v27
  s_waitcnt lgkmcnt(1)
  v_mfma_f32_32x32x16_bf16 v[128:143], a[136:139], v[56:59], v[128:143]
  ds_read_b128 v[48:51], v12 offset:32768
  s_cmp_eq_u32 s24, 0
  s_cselect_b32 s54, 0, 1
  s_lshl_b32 s54, s54, 30
  s_add_u32 s54, s54, 4096
  buffer_load_dwordx4 v[40:43], v16, s[64:67], s54 offen sc1
  v_mul_f32 v26, v45, v45
  v_mfma_f32_32x32x16_bf16 v[144:159], a[140:143], v[56:59], v[144:159]
  buffer_load_dwordx4 v8, s[8:11], s28 offen offset:2048 lds
  s_add_u32 s69, s69, 1
  s_cmp_ge_u32 s69, 10
  s_cselect_b32 s3, 10, 0
  s_sub_u32 s69, s69, s3
  v_mul_f32 v29, v44, v45
  s_waitcnt lgkmcnt(1)
  v_mfma_f32_32x32x16_bf16 v[160:175], a[136:139], v[60:63], v[160:175]
  ds_read_b128 v[52:55], v12 offset:40960
  v_fma_f32 v28, v44, v44, -v26
  v_add_f32 v29, v29, v29
  v_mul_f32 v26, v29, v29
  v_mul_f32 v29, v28, v29
  v_fma_f32 v28, v28, v28, -v26
  v_mfma_f32_32x32x16_bf16 v[176:191], a[140:143], v[60:63], v[176:191]
  v_add_f32 v29, v29, v29
  v_mul_f32 v26, v29, v29
  v_mul_f32 v29, v28, v29
  v_fma_f32 v28, v28, v28, -v26
  v_add_f32 v29, v29, v29
  v_mul_f32 v26, v29, v29
  s_waitcnt lgkmcnt(1)
  v_mfma_f32_32x32x16_bf16 v[128:143], a[144:147], v[48:51], v[128:143]
  ds_read_b128 v[56:59], v13 offset:32768
  v_mul_f32 v29, v28, v29
  v_fma_f32 v28, v28, v28, -v26
  v_add_f32 v29, v29, v29
  v_fma_f32 v26, -v29, v19, v24
  v_fma_f32 v27, v29, v18, v25
  v_mfma_f32_32x32x16_bf16 v[144:159], a[148:151], v[48:51], v[144:159]
  ds_read_b128 v[60:63], v13 offset:40960
  buffer_load_dwordx4 v9, s[8:11], s28 offen offset:3072 lds
  v_fma_f32 v24, v28, v18, v26
  v_fma_f32 v25, v28, v19, v27
  v_mul_f32 v26, v29, v29
  s_waitcnt lgkmcnt(2)
  v_mfma_f32_32x32x16_bf16 v[160:175], a[144:147], v[52:55], v[160:175]
  v_mul_f32 v29, v28, v29
  v_fma_f32 v28, v28, v28, -v26
  v_add_f32 v29, v29, v29
  v_mov_b32 v2, v24
  v_mov_b32 v3, v25
  s_nop 1
  v_mfma_f32_32x32x16_bf16 v[176:191], a[148:151], v[52:55], v[176:191]
  v_permlane32_swap_b32 v2, v24
  v_permlane32_swap_b32 v3, v25
  v_fma_f32 v26, -v29, v3, v24
  v_fma_f32 v27, v29, v2, v25
  v_fma_f32 v32, v28, v2, v26
  v_fma_f32 v33, v28, v3, v27
  s_waitcnt lgkmcnt(1)
  v_mfma_f32_32x32x16_bf16 v[128:143], a[152:155], v[56:59], v[128:143]
  s_waitcnt vmcnt(9) lgkmcnt(0)
  s_barrier
  ds_read_b128 v[48:51], v10 offset:49152
  v_mul_f32 v26, v29, v29
  v_mul_f32 v29, v28, v29
  v_fma_f32 v28, v28, v28, -v26
  v_mfma_f32_32x32x16_bf16 v[144:159], a[156:159], v[56:59], v[144:159]
  s_add_u32 m0, s27, 98304
  s_lshl_b32 s28, s69, 7
  s_add_u32 s28, s28, 81920
  buffer_load_dwordx4 v6, s[8:11], s28 offen offset:0 lds
  v_add_f32 v29, v29, v29
  v_mfma_f32_32x32x16_bf16 v[160:175], a[152:155], v[60:63], v[160:175]
  ds_read_b128 v[52:55], v10 offset:57344
  s_lshl_b32 s3, s35, 10
  s_add_u32 s3, s3, 153600
  v_lshrrev_b32 v24, 1, v16
  v_add_u32 v24, s3, v24
  s_lshl_b32 s3, s34, 9
  v_add_u32 v25, s3, v24
  v_mfma_f32_32x32x16_bf16 v[176:191], a[156:159], v[60:63], v[176:191]
  ds_write_b64 v25, v[32:33]
  s_waitcnt lgkmcnt(2)
  v_mfma_f32_32x32x16_bf16 v[128:143], a[160:163], v[48:51], v[128:143]
  ds_read_b128 v[56:59], v11 offset:49152
  v_mfma_f32_32x32x16_bf16 v[144:159], a[164:167], v[48:51], v[144:159]
  buffer_load_dwordx4 v7, s[8:11], s28 offen offset:1024 lds
  s_waitcnt lgkmcnt(2)
  v_mfma_f32_32x32x16_bf16 v[160:175], a[160:163], v[52:55], v[160:175]
  ds_read_b128 v[60:63], v11 offset:57344
  v_mfma_f32_32x32x16_bf16 v[176:191], a[164:167], v[52:55], v[176:191]
  s_waitcnt lgkmcnt(1)
  v_mfma_f32_32x32x16_bf16 v[128:143], a[168:171], v[56:59], v[128:143]
  ds_read_b128 v[48:51], v12 offset:49152
  v_mfma_f32_32x32x16_bf16 v[144:159], a[172:175], v[56:59], v[144:159]
  buffer_load_dwordx4 v8, s[8:11], s28 offen offset:2048 lds
  s_add_u32 s69, s69, 1
  s_cmp_ge_u32 s69, 10
  s_cselect_b32 s3, 10, 0
  s_sub_u32 s69, s69, s3
  s_waitcnt lgkmcnt(1)
  v_mfma_f32_32x32x16_bf16 v[160:175], a[168:171], v[60:63], v[160:175]
  ds_read_b128 v[52:55], v12 offset:57344
  v_mfma_f32_32x32x16_bf16 v[176:191], a[172:175], v[60:63], v[176:191]
  s_waitcnt lgkmcnt(1)
  v_mfma_f32_32x32x16_bf16 v[128:143], a[176:179], v[48:51], v[128:143]
  ds_read_b128 v[56:59], v13 offset:49152
  v_mfma_f32_32x32x16_bf16 v[144:159], a[180:183], v[48:51], v[144:159]
  ds_read_b128 v[60:63], v13 offset:57344
  buffer_load_dwordx4 v9, s[8:11], s28 offen offset:3072 lds
  s_waitcnt lgkmcnt(2)
  v_mfma_f32_32x32x16_bf16 v[160:175], a[176:179], v[52:55], v[160:175]
  s_cmp_lg_u32 s24, 0
  s_cbranch_scc1 L_W14
  s_waitcnt vmcnt(6)
  s_mov_b32 s62, 0
L_CHK15:
  v_xor_b32 v40, s60, v40
  v_xor_b32 v41, s60, v41
  v_xor_b32 v42, s60, v42
  v_xor_b32 v43, s60, v43
  v_or3_b32 v40, v40, v41, v42
  v_or_b32 v40, v40, v43
  v_cmp_ne_u32 vcc, 0, v40
  s_cbranch_vccz L_OK15
  s_add_u32 s62, s62, 1
  s_cmp_lt_u32 s62, 0x40000
  s_cbranch_scc0 L_OK15
  s_sleep 8
  s_cmp_eq_u32 s24, 0
  s_cselect_b32 s54, 0, 1
  s_lshl_b32 s54, s54, 30
  s_add_u32 s54, s54, 4096
  buffer_load_dwordx4 v[40:43], v16, s[64:67], s54 offen sc1
  s_waitcnt vmcnt(0)
  s_branch L_CHK15
L_OK15:
L_W14:
  v_mfma_f32_32x32x16_bf16 v[176:191], a[180:183], v[52:55], v[176:191]
  s_waitcnt lgkmcnt(1)
  v_mfma_f32_32x32x16_bf16 v[128:143], a[184:187], v[56:59], v[128:143]
  s_waitcnt vmcnt(9) lgkmcnt(0)
  s_barrier
  ds_read_b128 v[48:51], v10 offset:0
  ds_read_b64 v[30:31], v24
  ds_read_b64 v[32:33], v24 offset:512
  s_nop 7
  v_mfma_f32_32x32x16_bf16 v[144:159], a[188:191], v[56:59], v[144:159]
  s_add_u32 m0, s27, 114688
  s_lshl_b32 s28, s69, 7
  s_add_u32 s28, s28, 81920
  buffer_load_dwordx4 v6, s[8:11], s28 offen offset:0 lds
  v_readlane_b32 s99, v0, 0
  s_nop 3
  s_mul_i32 s99, s99, 5
  v_mfma_f32_32x32x16_bf16 v[160:175], a[184:187], v[60:63], v[160:175]
  ds_read_b128 v[52:55], v10 offset:8192
  v_mfma_f32_32x32x16_bf16 v[176:191], a[188:191], v[60:63], v[176:191]
  s_waitcnt lgkmcnt(1)
  v_fma_f32 v26, -v29, v31, v32
  v_fma_f32 v27, v29, v30, v33
  v_fma_f32 v32, v28, v30, v26
  v_mfma_f32_32x32x16_bf16 v[128:143], a[192:195], v[48:51], v[128:143]
  ds_read_b128 v[56:59], v11 offset:0
  buffer_load_dwordx4 a[0:3], v16, s[92:95], s99 offen offset:0 sc1
  v_readlane_b32 s100, v0, 1
  v_fma_f32 v33, v28, v31, v27
  v_bitop3_b32 v34, v32, v33, s60 bitop3:0x96
  v_mfma_f32_32x32x16_bf16 v[144:159], a[196:199], v[48:51], v[144:159]
  buffer_load_dwordx4 v7, s[8:11], s28 offen offset:1024 lds
  v_mov_b32 v35, 0
  buffer_store_dwordx4 v[32:35], v4, s[16:19], 0 offen sc1
  v_subrev_u32 v25, 122880, v25
  ds_write_b64 v25, v[30:31]
  s_waitcnt lgkmcnt(2)
  v_mfma_f32_32x32x16_bf16 v[160:175], a[192:195], v[52:55], v[160:175]
  ds_read_b128 v[60:63], v11 offset:8192
  s_add_u32 s54, s57, 10240
  s_mul_i32 s3, s34, 2560
  s_add_u32 s54, s54, s3
  buffer_load_dwordx4 v[24:27], v16, s[64:67], s54 offen offset:0 sc1
  v_mfma_f32_32x32x16_bf16 v[176:191], a[196:199], v[52:55], v[176:191]
  buffer_load_dwordx4 a[4:7], v16, s[92:95], s99 offen offset:1024 sc1
  s_add_u32 s54, s57, 10240
  s_mul_i32 s3, s34, 2560
  s_add_u32 s54, s54, s3
  buffer_load_dwordx4 v[28:31], v16, s[64:67], s54 offen offset:1024 sc1
  s_waitcnt lgkmcnt(2)
  v_mfma_f32_32x32x16_bf16 v[128:143], a[200:203], v[56:59], v[128:143]
  ds_read_b128 v[48:51], v12 offset:0
  s_add_u32 s54, s57, 10240
  s_mul_i32 s3, s34, 2560
  s_add_u32 s54, s54, s3
  buffer_load_dwordx4 v[32:35], v17, s[64:67], s54 offen offset:0 sc1
  v_mfma_f32_32x32x16_bf16 v[144:159], a[204:207], v[56:59], v[144:159]
  buffer_load_dwordx4 v8, s[8:11], s28 offen offset:2048 lds
  s_add_u32 s69, s69, 1
  s_cmp_ge_u32 s69, 10
  s_cselect_b32 s3, 10, 0
  s_sub_u32 s69, s69, s3
  s_waitcnt lgkmcnt(1)
  v_mfma_f32_32x32x16_bf16 v[160:175], a[200:203], v[60:63], v[160:175]
  ds_read_b128 v[52:55], v12 offset:8192
  buffer_load_dwordx4 a[8:11], v16, s[92:95], s99 offen offset:2048 sc1
  s_mul_i32 s100, s100, 5
  v_mfma_f32_32x32x16_bf16 v[176:191], a[204:207], v[60:63], v[176:191]
  s_waitcnt lgkmcnt(1)
  v_mfma_f32_32x32x16_bf16 v[128:143], a[208:211], v[48:51], v[128:143]
  ds_read_b128 v[56:59], v13 offset:0
  v_mfma_f32_32x32x16_bf16 v[144:159], a[212:215], v[48:51], v[144:159]
  ds_read_b128 v[60:63], v13 offset:8192
  buffer_load_dwordx4 v9, s[8:11], s28 offen offset:3072 lds
  buffer_load_dwordx4 a[12:15], v16, s[92:95], s99 offen offset:3072 sc1
  s_waitcnt lgkmcnt(2)
  v_mfma_f32_32x32x16_bf16 v[160:175], a[208:211], v[52:55], v[160:175]
  v_mfma_f32_32x32x16_bf16 v[176:191], a[212:215], v[52:55], v[176:191]
  s_waitcnt lgkmcnt(1)
  v_mfma_f32_32x32x16_bf16 v[128:143], a[216:219], v[56:59], v[128:143]
  s_waitcnt vmcnt(16) lgkmcnt(0)
  s_barrier
  ds_read_b128 v[48:51], v10 offset:16384
  s_add_u32 s99, s99, 4096
  buffer_load_dwordx4 a[16:19], v16, s[92:95], s99 offen offset:0 sc1
  v_mfma_f32_32x32x16_bf16 v[144:159], a[220:223], v[56:59], v[144:159]
  v_mfma_f32_32x32x16_bf16 v[160:175], a[216:219], v[60:63], v[160:175]
  ds_read_b128 v[52:55], v10 offset:24576
  v_mfma_f32_32x32x16_bf16 v[176:191], a[220:223], v[60:63], v[176:191]
  buffer_load_dwordx4 a[20:23], v16, s[92:95], s100 offen offset:0 sc1
  v_readlane_b32 s99, v0, 2
  s_waitcnt lgkmcnt(1)
  v_mfma_f32_32x32x16_bf16 v[128:143], a[224:227], v[48:51], v[128:143]
  ds_read_b128 v[56:59], v11 offset:16384
  v_mfma_f32_32x32x16_bf16 v[144:159], a[228:231], v[48:51], v[144:159]
  s_waitcnt lgkmcnt(1)
  v_mfma_f32_32x32x16_bf16 v[160:175], a[224:227], v[52:55], v[160:175]
  ds_read_b128 v[60:63], v11 offset:24576
  buffer_load_dwordx4 a[24:27], v16, s[92:95], s100 offen offset:1024 sc1
  v_mfma_f32_32x32x16_bf16 v[176:191], a[228:231], v[52:55], v[176:191]
  s_waitcnt lgkmcnt(1)
  v_mfma_f32_32x32x16_bf16 v[128:143], a[232:235], v[56:59], v[128:143]
  ds_read_b128 v[48:51], v12 offset:16384
  v_mfma_f32_32x32x16_bf16 v[144:159], a[236:239], v[56:59], v[144:159]
  buffer_load_dwordx4 a[28:31], v16, s[92:95], s100 offen offset:2048 sc1
  s_mul_i32 s99, s99, 5
  s_waitcnt lgkmcnt(1)
  v_mfma_f32_32x32x16_bf16 v[160:175], a[232:235], v[60:63], v[160:175]
  ds_read_b128 v[52:55], v12 offset:24576
  v_mfma_f32_32x32x16_bf16 v[176:191], a[236:239], v[60:63], v[176:191]
  s_waitcnt lgkmcnt(1)
  v_mfma_f32_32x32x16_bf16 v[128:143], a[240:243], v[48:51], v[128:143]
  ds_read_b128 v[56:59], v13 offset:16384
  buffer_load_dwordx4 a[32:35], v16, s[92:95], s100 offen offset:3072 sc1
  v_mfma_f32_32x32x16_bf16 v[144:159], a[244:247], v[48:51], v[144:159]
  ds_read_b128 v[60:63], v13 offset:24576
  s_waitcnt lgkmcnt(2)
  v_mfma_f32_32x32x16_bf16 v[160:175], a[240:243], v[52:55], v[160:175]
  v_mfma_f32_32x32x16_bf16 v[176:191], a[244:247], v[52:55], v[176:191]
  s_add_u32 s100, s100, 4096
  buffer_load_dwordx4 a[36:39], v16, s[92:95], s100 offen offset:0 sc1
  s_waitcnt lgkmcnt(1)
  v_mfma_f32_32x32x16_bf16 v[128:143], a[248:251], v[56:59], v[128:143]
  s_waitcnt vmcnt(18) lgkmcnt(0)
  s_barrier
  ds_read_b128 v[48:51], v10 offset:32768
  s_waitcnt vmcnt(10)
  s_mov_b32 s62, 0
L_CHK16:
  v_bitop3_b32 v26, v24, v25, v26 bitop3:0x96
  v_bitop3_b32 v30, v28, v29, v30 bitop3:0x96
  v_bitop3_b32 v34, v32, v33, v34 bitop3:0x96
  v_cmp_ne_u64 s[54:55], s[60:61], v[26:27]
  v_cmp_ne_u64 vcc, s[60:61], v[30:31]
  s_or_b64 s[54:55], s[54:55], vcc
  v_cmp_ne_u64 vcc, s[60:61], v[34:35]
  s_or_b64 vcc, s[54:55], vcc
  s_cbranch_vccz L_OK16
  s_add_u32 s62, s62, 1
  s_cmp_lt_u32 s62, 0x40000
  s_cbranch_scc0 L_OK16
  s_sleep 2
  s_add_u32 s54, s57, 10240
  s_mul_i32 s3, s34, 2560
  s_add_u32 s54, s54, s3
  buffer_load_dwordx4 v[24:27], v16, s[64:67], s54 offen offset:0 sc1
  s_add_u32 s54, s57, 10240
  s_mul_i32 s3, s34, 2560
  s_add_u32 s54, s54, s3
  buffer_load_dwordx4 v[28:31], v16, s[64:67], s54 offen offset:1024 sc1
  s_add_u32 s54, s57, 10240
  s_mul_i32 s3, s34, 2560
  s_add_u32 s54, s54, s3
  buffer_load_dwordx4 v[32:35], v17, s[64:67], s54 offen offset:0 sc1
  s_waitcnt vmcnt(0)
  s_branch L_CHK16
L_OK16:
  v_mfma_f32_32x32x16_bf16 v[144:159], a[252:255], v[56:59], v[144:159]
  v_add_f32 v24, v24, v28
  v_add_f32 v25, v25, v29
  v_fmac_f32 v24, v32, v15
  v_mfma_f32_32x32x16_bf16 v[160:175], a[248:251], v[60:63], v[160:175]
  ds_read_b128 v[52:55], v10 offset:40960
  buffer_load_dwordx4 a[40:43], v16, s[92:95], s99 offen offset:0 sc1
  v_readlane_b32 s100, v0, 3
  v_fmac_f32 v25, v33, v15
  v_mov_b32 v41, 0
  v_mfma_f32_32x32x16_bf16 v[176:191], a[252:255], v[60:63], v[176:191]
  v_mov_b32 v43, 0
  v_permlane16_swap_b32 v24, v25
  v_add_f32 v24, v24, v25
  v_mov_b32 v25, v24
  v_lshrrev_b32 v26, 2, v16
  s_nop 0
  s_waitcnt lgkmcnt(1)
  v_mfma_f32_32x32x16_bf16 v[128:143], v[192:195], v[48:51], v[128:143]
  ds_read_b128 v[56:59], v11 offset:32768
  v_permlane32_swap_b32 v24, v25
  v_add_f32 v24, v24, v25
  v_cvt_pk_bf16_f32 v25, v24, v24
  v_and_b32 v25, 0xffff0000, v25
  v_sub_f32 v24, v24, v25
  v_mfma_f32_32x32x16_bf16 v[144:159], v[196:199], v[48:51], v[144:159]
  buffer_load_dwordx4 a[44:47], v16, s[92:95], s99 offen offset:1024 sc1
  v_cvt_pk_bf16_f32 v24, v25, v24
  v_cndmask_b32 v24, v24, 0, s[58:59]
  s_lshl_b32 s3, s35, 9
  s_add_u32 s3, s3, 152576
  v_add_u32 v26, s3, v26
  s_lshl_b32 s3, s34, 8
  v_add_u32 v27, s3, v26
  s_waitcnt lgkmcnt(1)
  v_mfma_f32_32x32x16_bf16 v[160:175], v[192:195], v[52:55], v[160:175]
  ds_read_b128 v[60:63], v11 offset:40960
  ds_write_b32 v27, v24
  v_mfma_f32_32x32x16_bf16 v[176:191], v[196:199], v[52:55], v[176:191]
  s_waitcnt lgkmcnt(2)
  v_mfma_f32_32x32x16_bf16 v[128:143], v[200:203], v[56:59], v[128:143]
  ds_read_b128 v[48:51], v12 offset:32768
  buffer_load_dwordx4 a[48:51], v16, s[92:95], s99 offen offset:2048 sc1
  s_mul_i32 s100, s100, 5
  v_mfma_f32_32x32x16_bf16 v[144:159], v[204:207], v[56:59], v[144:159]
  s_waitcnt lgkmcnt(2)
  v_mfma_f32_32x32x16_bf16 v[160:175], v[200:203], v[60:63], v[160:175]
  ds_read_b128 v[52:55], v12 offset:40960
  v_mfma_f32_32x32x16_bf16 v[176:191], v[204:207], v[60:63], v[176:191]
  buffer_load_dwordx4 a[52:55], v16, s[92:95], s99 offen offset:3072 sc1
  s_waitcnt lgkmcnt(1)
  v_mfma_f32_32x32x16_bf16 v[128:143], v[208:211], v[48:51], v[128:143]
  ds_read_b128 v[56:59], v13 offset:32768
  v_mfma_f32_32x32x16_bf16 v[144:159], v[212:215], v[48:51], v[144:159]
  ds_read_b128 v[60:63], v13 offset:40960
  s_waitcnt lgkmcnt(2)
  v_mfma_f32_32x32x16_bf16 v[160:175], v[208:211], v[52:55], v[160:175]
  s_add_u32 s99, s99, 4096
  buffer_load_dwordx4 a[56:59], v16, s[92:95], s99 offen offset:0 sc1
  v_mfma_f32_32x32x16_bf16 v[176:191], v[212:215], v[52:55], v[176:191]
  s_waitcnt lgkmcnt(1)
  v_mfma_f32_32x32x16_bf16 v[128:143], v[216:219], v[56:59], v[128:143]
  s_waitcnt vmcnt(12) lgkmcnt(0)
  s_barrier
  ds_read_b128 v[48:51], v10 offset:49152
  ds_read_b32 v40, v26
  ds_read_b32 v42, v26 offset:256
  v_lshrrev_b32 v6, 5, v1
  v_mfma_f32_32x32x16_bf16 v[144:159], v[220:223], v[56:59], v[144:159]
  buffer_load_dwordx4 a[60:63], v16, s[92:95], s100 offen offset:0 sc1
  v_readlane_b32 s99, v0, 4
  v_lshlrev_b32 v6, 12, v6
  v_add_u32 v6, v6, v4
  v_add_u32 v6, 512, v6
  v_mfma_f32_32x32x16_bf16 v[160:175], v[216:219], v[60:63], v[160:175]
  ds_read_b128 v[52:55], v10 offset:57344
  buffer_load_dwordx4 a[160:163], v6, s[16:19], 0 offen offset:0 sc1
  buffer_load_dwordx4 a[164:167], v6, s[16:19], 0 offen offset:512 sc1
  buffer_load_dwordx4 a[168:171], v6, s[16:19], 0 offen offset:1024 sc1
  v_mfma_f32_32x32x16_bf16 v[176:191], v[220:223], v[60:63], v[176:191]
  buffer_load_dwordx4 a[172:175], v6, s[16:19], 0 offen offset:1536 sc1
  s_waitcnt lgkmcnt(3)
  v_mfma_f32_32x32x16_bf16 v[128:143], v[224:227], v[48:51], v[128:143]
  ds_read_b128 v[56:59], v11 offset:49152
  buffer_load_dwordx4 a[64:67], v16, s[92:95], s100 offen offset:1024 sc1
  v_mfma_f32_32x32x16_bf16 v[144:159], v[228:231], v[48:51], v[144:159]
  s_waitcnt lgkmcnt(1)
  v_mfma_f32_32x32x16_bf16 v[160:175], v[224:227], v[52:55], v[160:175]
  ds_read_b128 v[60:63], v11 offset:57344
  buffer_load_dwordx4 a[176:179], v6, s[16:19], 0 offen offset:2048 sc1
  v_mfma_f32_32x32x16_bf16 v[176:191], v[228:231], v[52:55], v[176:191]
  buffer_load_dwordx4 a[68:71], v16, s[92:95], s100 offen offset:2048 sc1
  s_mul_i32 s99, s99, 5
  s_waitcnt lgkmcnt(1)
  v_mfma_f32_32x32x16_bf16 v[128:143], v[232:235], v[56:59], v[128:143]
  ds_read_b128 v[48:51], v12 offset:49152
  v_mfma_f32_32x32x16_bf16 v[144:159], v[236:239], v[56:59], v[144:159]
  buffer_load_dwordx4 a[180:183], v6, s[16:19], 0 offen offset:2560 sc1
  s_waitcnt lgkmcnt(1)
  v_mfma_f32_32x32x16_bf16 v[160:175], v[232:235], v[60:63], v[160:175]
  ds_read_b128 v[52:55], v12 offset:57344
  buffer_load_dwordx4 a[72:75], v16, s[92:95], s100 offen offset:3072 sc1
  v_mfma_f32_32x32x16_bf16 v[176:191], v[236:239], v[60:63], v[176:191]
  s_waitcnt lgkmcnt(1)
  v_mfma_f32_32x32x16_bf16 v[128:143], v[240:243], v[48:51], v[128:143]
  ds_read_b128 v[56:59], v13 offset:49152
  buffer_load_dwordx4 a[184:187], v6, s[16:19], 0 offen offset:3072 sc1
  v_mfma_f32_32x32x16_bf16 v[144:159], v[244:247], v[48:51], v[144:159]
  ds_read_b128 v[60:63], v13 offset:57344
  s_add_u32 s100, s100, 4096
  buffer_load_dwordx4 a[76:79], v16, s[92:95], s100 offen offset:0 sc1
  s_waitcnt lgkmcnt(2)
  v_mfma_f32_32x32x16_bf16 v[160:175], v[240:243], v[52:55], v[160:175]
  v_mfma_f32_32x32x16_bf16 v[176:191], v[244:247], v[52:55], v[176:191]
  buffer_load_dwordx4 a[188:191], v6, s[16:19], 0 offen offset:3584 sc1
  s_waitcnt lgkmcnt(1)
  v_mfma_f32_32x32x16_bf16 v[128:143], v[248:251], v[56:59], v[128:143]
  buffer_load_dwordx4 a[80:83], v16, s[92:95], s99 offen offset:0 sc1
  v_readlane_b32 s100, v0, 10
  v_mfma_f32_32x32x16_bf16 v[144:159], v[252:255], v[56:59], v[144:159]
  s_waitcnt lgkmcnt(0)
  v_mfma_f32_32x32x16_bf16 v[160:175], v[248:251], v[60:63], v[160:175]
  v_mfma_f32_32x32x16_bf16 v[176:191], v[252:255], v[60:63], v[176:191]
  s_nop 1
  v_mfma_f32_32x32x8_bf16 v[128:143], v[36:37], v[40:41], v[128:143]
  v_mfma_f32_32x32x8_bf16 v[144:159], v[38:39], v[40:41], v[144:159]
  v_mfma_f32_32x32x8_bf16 v[160:175], v[36:37], v[42:43], v[160:175]
  v_mfma_f32_32x32x8_bf16 v[176:191], v[38:39], v[42:43], v[176:191]
  v_lshrrev_b32 v8, 5, v1
  v_lshlrev_b32 v6, 12, v8
  v_add_u32 v6, v6, v4
  v_add_u32 v6, 512, v6
  v_lshlrev_b32 v8, 3, v8
  v_sub_u32 v8, s25, v8
  v_med3_i32 v8, v8, 0, 8
  v_mul_lo_u32 v8, v8, s60
  v_mov_b32 v13, v0
  s_nop 3
  ds_read_b128 v[48:51], v5 offset:0
  ds_read_b128 v[52:55], v5 offset:16
  ds_read_b128 v[56:59], v5 offset:32
  ds_read_b128 v[60:63], v5 offset:48
  v_pk_mul_f32 v[32:33], v[20:21], v[20:21] op_sel_hi:[0,1]
  v_pk_fma_f32 v[36:37], v[20:21], v[20:21], v[32:33] op_sel:[1,1,0] op_sel_hi:[1,0,1] neg_lo:[0,1,0]
  v_pk_mul_f32 v[32:33], v[36:37], v[36:37] op_sel_hi:[0,1]
  v_pk_fma_f32 v[36:37], v[36:37], v[36:37], v[32:33] op_sel:[1,1,0] op_sel_hi:[1,0,1] neg_lo:[0,1,0]
  v_pk_mul_f32 v[32:33], v[36:37], v[36:37] op_sel_hi:[0,1]
  v_pk_fma_f32 v[36:37], v[36:37], v[36:37], v[32:33] op_sel:[1,1,0] op_sel_hi:[1,0,1] neg_lo:[0,1,0]
  v_pk_mul_f32 v[32:33], v[36:37], v[36:37] op_sel_hi:[0,1]
  v_pk_fma_f32 v[36:37], v[36:37], v[36:37], v[32:33] op_sel:[1,1,0] op_sel_hi:[1,0,1] neg_lo:[0,1,0]
  v_pk_mul_f32 v[32:33], v[36:37], v[36:37] op_sel_hi:[0,1]
  v_pk_fma_f32 v[38:39], v[36:37], v[36:37], v[32:33] op_sel:[1,1,0] op_sel_hi:[1,0,1] neg_lo:[0,1,0]
  v_pk_mul_f32 v[32:33], v[38:39], v[38:39] op_sel_hi:[0,1]
  v_pk_fma_f32 v[40:41], v[38:39], v[38:39], v[32:33] op_sel:[1,1,0] op_sel_hi:[1,0,1] neg_lo:[0,1,0]
  s_lshl_b32 s3, s35, 10
  s_add_u32 s3, s3, 153600
  v_lshrrev_b32 v42, 1, v16
  v_add_u32 v42, s3, v42
  s_lshl_b32 s3, s34, 9
  v_add_u32 v43, s3, v42
  s_waitcnt lgkmcnt(3)
  v_pk_mul_f32 v[128:129], v[128:129], v[48:49]
  v_pk_mul_f32 v[160:161], v[160:161], v[48:49]
  v_pk_mul_f32 v[130:131], v[130:131], v[50:51]
  v_pk_mul_f32 v[162:163], v[162:163], v[50:51]
  ds_read_b128 v[48:51], v5 offset:64
  v_pk_fma_f32 v[32:33], v[160:161], v[20:21], v[130:131] op_sel:[0,1,0] op_sel_hi:[1,1,1] neg_lo:[0,1,0] neg_hi:[0,1,0]
  v_pk_fma_f32 v[34:35], v[128:129], v[20:21], v[162:163] op_sel:[0,1,0] op_sel_hi:[1,1,1]
  v_pk_fma_f32 v[28:29], v[128:129], v[20:21], v[32:33] op_sel_hi:[1,0,1]
  v_pk_fma_f32 v[30:31], v[160:161], v[20:21], v[34:35] op_sel_hi:[1,0,1]
  s_waitcnt lgkmcnt(3)
  v_pk_mul_f32 v[132:133], v[132:133], v[52:53]
  v_pk_mul_f32 v[164:165], v[164:165], v[52:53]
  v_pk_fma_f32 v[32:33], v[30:31], v[20:21], v[132:133] op_sel:[0,1,0] op_sel_hi:[1,1,1] neg_lo:[0,1,0] neg_hi:[0,1,0]
  v_pk_fma_f32 v[34:35], v[28:29], v[20:21], v[164:165] op_sel:[0,1,0] op_sel_hi:[1,1,1]
  v_pk_fma_f32 v[28:29], v[28:29], v[20:21], v[32:33] op_sel_hi:[1,0,1]
  v_pk_fma_f32 v[30:31], v[30:31], v[20:21], v[34:35] op_sel_hi:[1,0,1]
  v_pk_mul_f32 v[134:135], v[134:135], v[54:55]
  v_pk_mul_f32 v[166:167], v[166:167], v[54:55]
  ds_read_b128 v[52:55], v5 offset:80
  v_pk_fma_f32 v[32:33], v[30:31], v[20:21], v[134:135] op_sel:[0,1,0] op_sel_hi:[1,1,1] neg_lo:[0,1,0] neg_hi:[0,1,0]
  v_pk_fma_f32 v[34:35], v[28:29], v[20:21], v[166:167] op_sel:[0,1,0] op_sel_hi:[1,1,1]
  v_pk_fma_f32 v[28:29], v[28:29], v[20:21], v[32:33] op_sel_hi:[1,0,1]
  v_pk_fma_f32 v[30:31], v[30:31], v[20:21], v[34:35] op_sel_hi:[1,0,1]
  s_waitcnt lgkmcnt(3)
  v_pk_mul_f32 v[136:137], v[136:137], v[56:57]
  v_pk_mul_f32 v[168:169], v[168:169], v[56:57]
  v_pk_fma_f32 v[32:33], v[30:31], v[20:21], v[136:137] op_sel:[0,1,0] op_sel_hi:[1,1,1] neg_lo:[0,1,0] neg_hi:[0,1,0]
  v_pk_fma_f32 v[34:35], v[28:29], v[20:21], v[168:169] op_sel:[0,1,0] op_sel_hi:[1,1,1]
  v_pk_fma_f32 v[28:29], v[28:29], v[20:21], v[32:33] op_sel_hi:[1,0,1]
  v_pk_fma_f32 v[30:31], v[30:31], v[20:21], v[34:35] op_sel_hi:[1,0,1]
  v_pk_mul_f32 v[138:139], v[138:139], v[58:59]
  v_pk_mul_f32 v[170:171], v[170:171], v[58:59]
  ds_read_b128 v[56:59], v5 offset:96
  v_pk_fma_f32 v[32:33], v[30:31], v[20:21], v[138:139] op_sel:[0,1,0] op_sel_hi:[1,1,1] neg_lo:[0,1,0] neg_hi:[0,1,0]
  v_pk_fma_f32 v[34:35], v[28:29], v[20:21], v[170:171] op_sel:[0,1,0] op_sel_hi:[1,1,1]
  v_pk_fma_f32 v[28:29], v[28:29], v[20:21], v[32:33] op_sel_hi:[1,0,1]
  v_pk_fma_f32 v[30:31], v[30:31], v[20:21], v[34:35] op_sel_hi:[1,0,1]
  s_waitcnt lgkmcnt(3)
  v_pk_mul_f32 v[140:141], v[140:141], v[60:61]
  v_pk_mul_f32 v[172:173], v[172:173], v[60:61]
  v_pk_fma_f32 v[32:33], v[30:31], v[20:21], v[140:141] op_sel:[0,1,0] op_sel_hi:[1,1,1] neg_lo:[0,1,0] neg_hi:[0,1,0]
  v_pk_fma_f32 v[34:35], v[28:29], v[20:21], v[172:173] op_sel:[0,1,0] op_sel_hi:[1,1,1]
  v_pk_fma_f32 v[28:29], v[28:29], v[20:21], v[32:33] op_sel_hi:[1,0,1]
  v_pk_fma_f32 v[30:31], v[30:31], v[20:21], v[34:35] op_sel_hi:[1,0,1]
  v_pk_mul_f32 v[142:143], v[142:143], v[62:63]
  v_pk_mul_f32 v[174:175], v[174:175], v[62:63]
  ds_read_b128 v[60:63], v5 offset:112
  v_pk_fma_f32 v[32:33], v[30:31], v[20:21], v[142:143] op_sel:[0,1,0] op_sel_hi:[1,1,1] neg_lo:[0,1,0] neg_hi:[0,1,0]
  v_pk_fma_f32 v[34:35], v[28:29], v[20:21], v[174:175] op_sel:[0,1,0] op_sel_hi:[1,1,1]
  v_pk_fma_f32 v[28:29], v[28:29], v[20:21], v[32:33] op_sel_hi:[1,0,1]
  v_pk_fma_f32 v[30:31], v[30:31], v[20:21], v[34:35] op_sel_hi:[1,0,1]
  s_waitcnt lgkmcnt(3)
  v_pk_mul_f32 v[144:145], v[144:145], v[48:49]
  v_pk_mul_f32 v[176:177], v[176:177], v[48:49]
  v_pk_fma_f32 v[32:33], v[30:31], v[20:21], v[144:145] op_sel:[0,1,0] op_sel_hi:[1,1,1] neg_lo:[0,1,0] neg_hi:[0,1,0]
  v_pk_fma_f32 v[34:35], v[28:29], v[20:21], v[176:177] op_sel:[0,1,0] op_sel_hi:[1,1,1]
  v_pk_fma_f32 v[28:29], v[28:29], v[20:21], v[32:33] op_sel_hi:[1,0,1]
  v_pk_fma_f32 v[30:31], v[30:31], v[20:21], v[34:35] op_sel_hi:[1,0,1]
  v_pk_mul_f32 v[146:147], v[146:147], v[50:51]
  v_pk_mul_f32 v[178:179], v[178:179], v[50:51]
  v_pk_fma_f32 v[32:33], v[30:31], v[20:21], v[146:147] op_sel:[0,1,0] op_sel_hi:[1,1,1] neg_lo:[0,1,0] neg_hi:[0,1,0]
  v_pk_fma_f32 v[34:35], v[28:29], v[20:21], v[178:179] op_sel:[0,1,0] op_sel_hi:[1,1,1]
  v_pk_fma_f32 v[28:29], v[28:29], v[20:21], v[32:33] op_sel_hi:[1,0,1]
  v_pk_fma_f32 v[30:31], v[30:31], v[20:21], v[34:35] op_sel_hi:[1,0,1]
  s_waitcnt lgkmcnt(2)
  v_pk_mul_f32 v[148:149], v[148:149], v[52:53]
  v_pk_mul_f32 v[180:181], v[180:181], v[52:53]
  v_pk_fma_f32 v[32:33], v[30:31], v[20:21], v[148:149] op_sel:[0,1,0] op_sel_hi:[1,1,1] neg_lo:[0,1,0] neg_hi:[0,1,0]
  v_pk_fma_f32 v[34:35], v[28:29], v[20:21], v[180:181] op_sel:[0,1,0] op_sel_hi:[1,1,1]
  v_pk_fma_f32 v[28:29], v[28:29], v[20:21], v[32:33] op_sel_hi:[1,0,1]
  v_pk_fma_f32 v[30:31], v[30:31], v[20:21], v[34:35] op_sel_hi:[1,0,1]
  v_pk_mul_f32 v[150:151], v[150:151], v[54:55]
  v_pk_mul_f32 v[182:183], v[182:183], v[54:55]
  v_pk_fma_f32 v[32:33], v[30:31], v[20:21], v[150:151] op_sel:[0,1,0] op_sel_hi:[1,1,1] neg_lo:[0,1,0] neg_hi:[0,1,0]
  v_pk_fma_f32 v[34:35], v[28:29], v[20:21], v[182:183] op_sel:[0,1,0] op_sel_hi:[1,1,1]
  v_pk_fma_f32 v[28:29], v[28:29], v[20:21], v[32:33] op_sel_hi:[1,0,1]
  v_pk_fma_f32 v[30:31], v[30:31], v[20:21], v[34:35] op_sel_hi:[1,0,1]
  s_waitcnt lgkmcnt(1)
  v_pk_mul_f32 v[152:153], v[152:153], v[56:57]
  v_pk_mul_f32 v[184:185], v[184:185], v[56:57]
  v_pk_fma_f32 v[32:33], v[30:31], v[20:21], v[152:153] op_sel:[0,1,0] op_sel_hi:[1,1,1] neg_lo:[0,1,0] neg_hi:[0,1,0]
  v_pk_fma_f32 v[34:35], v[28:29], v[20:21], v[184:185] op_sel:[0,1,0] op_sel_hi:[1,1,1]
  v_pk_fma_f32 v[28:29], v[28:29], v[20:21], v[32:33] op_sel_hi:[1,0,1]
  v_pk_fma_f32 v[30:31], v[30:31], v[20:21], v[34:35] op_sel_hi:[1,0,1]
  v_pk_mul_f32 v[154:155], v[154:155], v[58:59]
  v_pk_mul_f32 v[186:187], v[186:187], v[58:59]
  v_pk_fma_f32 v[32:33], v[30:31], v[20:21], v[154:155] op_sel:[0,1,0] op_sel_hi:[1,1,1] neg_lo:[0,1,0] neg_hi:[0,1,0]
  v_pk_fma_f32 v[34:35], v[28:29], v[20:21], v[186:187] op_sel:[0,1,0] op_sel_hi:[1,1,1]
  v_pk_fma_f32 v[28:29], v[28:29], v[20:21], v[32:33] op_sel_hi:[1,0,1]
  v_pk_fma_f32 v[30:31], v[30:31], v[20:21], v[34:35] op_sel_hi:[1,0,1]
  s_waitcnt lgkmcnt(0)
  v_pk_mul_f32 v[156:157], v[156:157], v[60:61]
  v_pk_mul_f32 v[188:189], v[188:189], v[60:61]
  v_pk_fma_f32 v[32:33], v[30:31], v[20:21], v[156:157] op_sel:[0,1,0] op_sel_hi:[1,1,1] neg_lo:[0,1,0] neg_hi:[0,1,0]
  v_pk_fma_f32 v[34:35], v[28:29], v[20:21], v[188:189] op_sel:[0,1,0] op_sel_hi:[1,1,1]
  v_pk_fma_f32 v[28:29], v[28:29], v[20:21], v[32:33] op_sel_hi:[1,0,1]
  v_pk_fma_f32 v[30:31], v[30:31], v[20:21], v[34:35] op_sel_hi:[1,0,1]
  v_pk_mul_f32 v[158:159], v[158:159], v[62:63]
  v_pk_mul_f32 v[190:191], v[190:191], v[62:63]
  v_pk_fma_f32 v[32:33], v[30:31], v[20:21], v[158:159] op_sel:[0,1,0] op_sel_hi:[1,1,1] neg_lo:[0,1,0] neg_hi:[0,1,0]
  v_pk_fma_f32 v[34:35], v[28:29], v[20:21], v[190:191] op_sel:[0,1,0] op_sel_hi:[1,1,1]
  v_pk_fma_f32 v[28:29], v[28:29], v[20:21], v[32:33] op_sel_hi:[1,0,1]
  v_pk_fma_f32 v[30:31], v[30:31], v[20:21], v[34:35] op_sel_hi:[1,0,1]
  v_mov_b32 v228, v28
  v_mov_b32 v229, v30
  v_mov_b32 v28, v29
  v_mov_b32 v29, v31
  v_pk_fma_f32 v[32:33], v[228:229], v[36:37], v[28:29] op_sel:[1,1,0] op_sel_hi:[0,1,1] neg_lo:[0,1,0]
  v_pk_fma_f32 v[28:29], v[228:229], v[36:37], v[32:33] op_sel_hi:[1,0,1]
  v_mov_b32 v230, v28
  v_mov_b32 v231, v29
  s_nop 1
  v_permlane32_swap_b32 v230, v28
  v_permlane32_swap_b32 v231, v29
  v_pk_fma_f32 v[32:33], v[230:231], v[38:39], v[28:29] op_sel:[1,1,0] op_sel_hi:[0,1,1] neg_lo:[0,1,0]
  v_pk_fma_f32 v[24:25], v[230:231], v[38:39], v[32:33] op_sel_hi:[1,0,1]
  ds_write_b64 v43, v[24:25]
  v_subrev_u32 v236, 122880, v43
  ds_read_b64 v[236:237], v236
  s_waitcnt lgkmcnt(0)
  s_barrier
  ds_read_b64 v[232:233], v42
  ds_read_b64 v[24:25], v42 offset:512
  s_waitcnt lgkmcnt(0)
  v_pk_fma_f32 v[32:33], v[232:233], v[40:41], v[24:25] op_sel:[1,1,0] op_sel_hi:[0,1,1] neg_lo:[0,1,0]
  v_pk_fma_f32 v[24:25], v[232:233], v[40:41], v[32:33] op_sel_hi:[1,0,1]
  v_bitop3_b32 v26, v24, v25, s60 bitop3:0x96
  v_mov_b32 v27, 0
  buffer_store_dwordx4 v[24:27], v4, s[20:23], 0 offen sc1
  s_waitcnt vmcnt(2)
  v_accvgpr_read_b32 v192, a160
  v_accvgpr_read_b32 v193, a161
  v_accvgpr_read_b32 v194, a162
  v_accvgpr_read_b32 v196, a164
  v_accvgpr_read_b32 v197, a165
  v_accvgpr_read_b32 v198, a166
  v_accvgpr_read_b32 v200, a168
  v_accvgpr_read_b32 v201, a169
  v_accvgpr_read_b32 v202, a170
  v_accvgpr_read_b32 v204, a172
  v_accvgpr_read_b32 v205, a173
  v_accvgpr_read_b32 v206, a174
  v_accvgpr_read_b32 v208, a176
  v_accvgpr_read_b32 v209, a177
  v_accvgpr_read_b32 v210, a178
  v_accvgpr_read_b32 v212, a180
  v_accvgpr_read_b32 v213, a181
  v_accvgpr_read_b32 v214, a182
  v_accvgpr_read_b32 v216, a184
  v_accvgpr_read_b32 v217, a185
  v_accvgpr_read_b32 v218, a186
  v_accvgpr_read_b32 v220, a188
  v_accvgpr_read_b32 v221, a189
  v_accvgpr_read_b32 v222, a190
  s_lshl_b32 s55, s24, 13
  s_add_u32 s55, s55, 32768
  v_and_b32 v58, 7, v1
  v_bfe_u32 v59, v1, 3, 1
  v_lshrrev_b32 v60, 5, v1
  v_xor_b32 v59, v59, v60
  v_lshlrev_b32 v59, 2, v59
  v_xor_b32 v58, v58, v59
  v_lshlrev_b32 v58, 4, v58
  v_and_b32 v59, 31, v1
  v_lshl_add_u32 v58, v59, 7, v58
  v_add_u32 v10, s55, v58
  v_xor_b32 v11, 16, v10
  v_xor_b32 v12, 32, v10
  v_xor_b32 v15, 48, v10
  v_lshrrev_b32 v252, 4, v1
  v_bfe_u32 v253, v1, 2, 2
  v_lshl_add_u32 v254, v252, 3, v253
  v_and_b32 v252, 1, v252
  v_lshlrev_b32 v252, 2, v252
  v_xor_b32 v252, v252, v253
  v_bfe_u32 v253, v1, 1, 1
  v_xor_b32 v252, v252, v253
  v_lshlrev_b32 v252, 4, v252
  v_lshl_add_u32 v252, v254, 7, v252
  v_and_b32 v253, 1, v1
  v_lshl_add_u32 v252, v253, 3, v252
  v_add_u32 v252, s55, v252
  v_xor_b32 v253, 32, v252
  v_xor_b32 v254, 64, v252
  v_xor_b32 v255, 96, v252
  v_pk_mul_f32 v[36:37], v[44:45], v[44:45] op_sel_hi:[0,1]
  v_pk_fma_f32 v[240:241], v[44:45], v[44:45], v[36:37] op_sel:[1,1,0] op_sel_hi:[1,0,1] neg_lo:[0,1,0]
  v_pk_mul_f32 v[36:37], v[240:241], v[240:241] op_sel_hi:[0,1]
  v_pk_fma_f32 v[240:241], v[240:241], v[240:241], v[36:37] op_sel:[1,1,0] op_sel_hi:[1,0,1] neg_lo:[0,1,0]
  v_pk_mul_f32 v[36:37], v[240:241], v[240:241] op_sel_hi:[0,1]
  v_pk_fma_f32 v[240:241], v[240:241], v[240:241], v[36:37] op_sel:[1,1,0] op_sel_hi:[1,0,1] neg_lo:[0,1,0]
  v_pk_mul_f32 v[36:37], v[240:241], v[240:241] op_sel_hi:[0,1]
  v_pk_fma_f32 v[240:241], v[240:241], v[240:241], v[36:37] op_sel:[1,1,0] op_sel_hi:[1,0,1] neg_lo:[0,1,0]
  v_pk_mul_f32 v[36:37], v[240:241], v[240:241] op_sel_hi:[0,1]
  v_pk_fma_f32 v[242:243], v[240:241], v[240:241], v[36:37] op_sel:[1,1,0] op_sel_hi:[1,0,1] neg_lo:[0,1,0]
  buffer_load_dwordx4 a[84:87], v16, s[92:95], s99 offen offset:1024 sc1
  v_pk_mul_f32 v[36:37], v[242:243], v[242:243] op_sel_hi:[0,1]
  v_pk_fma_f32 v[244:245], v[242:243], v[242:243], v[36:37] op_sel:[1,1,0] op_sel_hi:[1,0,1] neg_lo:[0,1,0]
  v_pk_mul_f32 v[36:37], v[244:245], v[244:245] op_sel_hi:[0,1]
  v_pk_fma_f32 v[246:247], v[244:245], v[244:245], v[36:37] op_sel:[1,1,0] op_sel_hi:[1,0,1] neg_lo:[0,1,0]
  v_pk_mul_f32 v[36:37], v[246:247], v[246:247] op_sel_hi:[0,1]
  v_pk_fma_f32 v[248:249], v[246:247], v[246:247], v[36:37] op_sel:[1,1,0] op_sel_hi:[1,0,1] neg_lo:[0,1,0]
  v_pk_mul_f32 v[36:37], v[248:249], v[248:249] op_sel_hi:[0,1]
  v_pk_fma_f32 v[248:249], v[248:249], v[248:249], v[36:37] op_sel:[1,1,0] op_sel_hi:[1,0,1] neg_lo:[0,1,0]
  v_pk_mul_f32 v[36:37], v[248:249], v[248:249] op_sel_hi:[0,1]
  v_pk_fma_f32 v[248:249], v[248:249], v[248:249], v[36:37] op_sel:[1,1,0] op_sel_hi:[1,0,1] neg_lo:[0,1,0]
  buffer_load_dwordx4 a[88:91], v16, s[92:95], s99 offen offset:2048 sc1
  s_mul_i32 s100, s100, 5
  s_mov_b32 s62, 0
L_CHK17:
  v_bitop3_b32 v194, v192, v193, v194 bitop3:0x96
  v_bitop3_b32 v198, v196, v197, v198 bitop3:0x96
  v_bitop3_b32 v202, v200, v201, v202 bitop3:0x96
  v_bitop3_b32 v206, v204, v205, v206 bitop3:0x96
  v_bitop3_b32 v210, v208, v209, v210 bitop3:0x96
  v_bitop3_b32 v214, v212, v213, v214 bitop3:0x96
  v_bitop3_b32 v218, v216, v217, v218 bitop3:0x96
  v_bitop3_b32 v222, v220, v221, v222 bitop3:0x96
  v_add_u32 v9, v194, v198
  v_add3_u32 v9, v9, v202, v206
  v_add3_u32 v9, v9, v210, v214
  v_add3_u32 v9, v9, v218, v222
  v_cmp_ne_u32 vcc, v9, v8
  s_cbranch_vccz L_OK17
  s_add_u32 s62, s62, 1
  s_cmp_lt_u32 s62, 0x40000
  s_cbranch_scc0 L_OK17
  s_sleep 2
  buffer_load_dwordx4 v[192:195], v6, s[16:19], 0 offen offset:0 sc1
  buffer_load_dwordx4 v[196:199], v6, s[16:19], 0 offen offset:512 sc1
  buffer_load_dwordx4 v[200:203], v6, s[16:19], 0 offen offset:1024 sc1
  buffer_load_dwordx4 v[204:207], v6, s[16:19], 0 offen offset:1536 sc1
  buffer_load_dwordx4 v[208:211], v6, s[16:19], 0 offen offset:2048 sc1
  buffer_load_dwordx4 v[212:215], v6, s[16:19], 0 offen offset:2560 sc1
  buffer_load_dwordx4 v[216:219], v6, s[16:19], 0 offen offset:3072 sc1
  buffer_load_dwordx4 v[220:223], v6, s[16:19], 0 offen offset:3584 sc1
  s_waitcnt vmcnt(0)
  s_branch L_CHK17
L_OK17:
  v_pk_fma_f32 v[40:41], v[220:221], v[246:247], v[216:217] op_sel:[1,1,0] op_sel_hi:[0,1,1] neg_lo:[0,1,0]
  v_pk_fma_f32 v[36:37], v[220:221], v[246:247], v[40:41] op_sel_hi:[1,0,1]
  v_pk_fma_f32 v[40:41], v[36:37], v[246:247], v[212:213] op_sel:[1,1,0] op_sel_hi:[0,1,1] neg_lo:[0,1,0]
  v_pk_fma_f32 v[36:37], v[36:37], v[246:247], v[40:41] op_sel_hi:[1,0,1]
  v_pk_fma_f32 v[40:41], v[36:37], v[246:247], v[208:209] op_sel:[1,1,0] op_sel_hi:[0,1,1] neg_lo:[0,1,0]
  v_pk_fma_f32 v[36:37], v[36:37], v[246:247], v[40:41] op_sel_hi:[1,0,1]
  v_pk_fma_f32 v[40:41], v[36:37], v[246:247], v[204:205] op_sel:[1,1,0] op_sel_hi:[0,1,1] neg_lo:[0,1,0]
  v_pk_fma_f32 v[36:37], v[36:37], v[246:247], v[40:41] op_sel_hi:[1,0,1]
  v_pk_fma_f32 v[40:41], v[36:37], v[246:247], v[200:201] op_sel:[1,1,0] op_sel_hi:[0,1,1] neg_lo:[0,1,0]
  v_pk_fma_f32 v[36:37], v[36:37], v[246:247], v[40:41] op_sel_hi:[1,0,1]
  v_pk_fma_f32 v[40:41], v[36:37], v[246:247], v[196:197] op_sel:[1,1,0] op_sel_hi:[0,1,1] neg_lo:[0,1,0]
  v_pk_fma_f32 v[36:37], v[36:37], v[246:247], v[40:41] op_sel_hi:[1,0,1]
  v_pk_fma_f32 v[40:41], v[36:37], v[246:247], v[192:193] op_sel:[1,1,0] op_sel_hi:[0,1,1] neg_lo:[0,1,0]
  v_pk_fma_f32 v[36:37], v[36:37], v[246:247], v[40:41] op_sel_hi:[1,0,1]
  v_mov_b32 v38, v36
  v_mov_b32 v39, v37
  s_nop 1
  v_permlane32_swap_b32 v38, v36
  buffer_load_dwordx4 a[92:95], v16, s[92:95], s99 offen offset:3072 sc1
  v_permlane32_swap_b32 v39, v37
  v_pk_fma_f32 v[40:41], v[36:37], v[248:249], v[38:39] op_sel:[1,1,0] op_sel_hi:[0,1,1] neg_lo:[0,1,0]
  v_pk_fma_f32 v[36:37], v[36:37], v[248:249], v[40:41] op_sel_hi:[1,0,1]
  v_pk_fma_f32 v[40:41], v[36:37], v[244:245], v[236:237] op_sel:[1,1,0] op_sel_hi:[0,1,1] neg_lo:[0,1,0]
  v_pk_fma_f32 v[38:39], v[36:37], v[244:245], v[40:41] op_sel_hi:[1,0,1]
  v_cndmask_b32 v36, v36, v38, s[52:53]
  v_cndmask_b32 v37, v37, v39, s[52:53]
  v_pk_fma_f32 v[40:41], v[36:37], v[242:243], v[2:3] op_sel:[1,1,0] op_sel_hi:[0,1,1] neg_lo:[0,1,0]
  v_pk_fma_f32 v[38:39], v[36:37], v[242:243], v[40:41] op_sel_hi:[1,0,1]
  v_cndmask_b32 v36, v36, v38, s[58:59]
  v_cndmask_b32 v37, v37, v39, s[58:59]
  v_pk_fma_f32 v[40:41], v[36:37], v[240:241], v[18:19] op_sel:[1,1,0] op_sel_hi:[0,1,1] neg_lo:[0,1,0]
  v_pk_fma_f32 v[38:39], v[36:37], v[240:241], v[40:41] op_sel_hi:[1,0,1]
  v_mov_b32 v24, v36
  v_mov_b32 v25, v38
  v_mov_b32 v26, v37
  v_mov_b32 v27, v39
  v_pk_fma_f32 v[40:41], v[26:27], v[44:45], v[64:65] op_sel:[0,1,0] op_sel_hi:[1,1,1] neg_lo:[0,1,0] neg_hi:[0,1,0]
  s_add_u32 s99, s99, 4096
  buffer_load_dwordx4 a[96:99], v16, s[92:95], s99 offen offset:0 sc1
  v_pk_fma_f32 v[42:43], v[24:25], v[44:45], v[96:97] op_sel:[0,1,0] op_sel_hi:[1,1,1]
  v_pk_fma_f32 v[24:25], v[24:25], v[44:45], v[40:41] op_sel_hi:[1,0,1]
  v_pk_fma_f32 v[26:27], v[26:27], v[44:45], v[42:43] op_sel_hi:[1,0,1]
  v_pk_mul_f32 v[64:65], v[24:25], v[46:47] op_sel_hi:[1,0]
  v_pk_mul_f32 v[96:97], v[24:25], v[46:47] op_sel:[0,1] neg_lo:[0,1] neg_hi:[0,1]
  v_pk_fma_f32 v[64:65], v[26:27], v[46:47], v[64:65] op_sel:[0,1,0] neg_lo:[0,1,0] neg_hi:[0,1,0]
  v_pk_fma_f32 v[96:97], v[26:27], v[46:47], v[96:97] op_sel_hi:[1,0,1] neg_lo:[0,1,0] neg_hi:[0,1,0]
  v_pk_fma_f32 v[40:41], v[26:27], v[44:45], v[66:67] op_sel:[0,1,0] op_sel_hi:[1,1,1] neg_lo:[0,1,0] neg_hi:[0,1,0]
  v_pk_fma_f32 v[42:43], v[24:25], v[44:45], v[98:99] op_sel:[0,1,0] op_sel_hi:[1,1,1]
  v_pk_fma_f32 v[24:25], v[24:25], v[44:45], v[40:41] op_sel_hi:[1,0,1]
  v_pk_fma_f32 v[26:27], v[26:27], v[44:45], v[42:43] op_sel_hi:[1,0,1]
  v_pk_mul_f32 v[66:67], v[24:25], v[46:47] op_sel_hi:[1,0]
  v_pk_mul_f32 v[98:99], v[24:25], v[46:47] op_sel:[0,1] neg_lo:[0,1] neg_hi:[0,1]
  v_pk_fma_f32 v[66:67], v[26:27], v[46:47], v[66:67] op_sel:[0,1,0] neg_lo:[0,1,0] neg_hi:[0,1,0]
  v_pk_fma_f32 v[98:99], v[26:27], v[46:47], v[98:99] op_sel_hi:[1,0,1] neg_lo:[0,1,0] neg_hi:[0,1,0]
  v_pk_fma_f32 v[40:41], v[26:27], v[44:45], v[68:69] op_sel:[0,1,0] op_sel_hi:[1,1,1] neg_lo:[0,1,0] neg_hi:[0,1,0]
  v_pk_fma_f32 v[42:43], v[24:25], v[44:45], v[100:101] op_sel:[0,1,0] op_sel_hi:[1,1,1]
  v_pk_fma_f32 v[24:25], v[24:25], v[44:45], v[40:41] op_sel_hi:[1,0,1]
  buffer_load_dwordx4 a[200:203], v16, s[92:95], s100 offen offset:0 sc1
  v_readlane_b32 s99, v13, 11
  v_pk_fma_f32 v[26:27], v[26:27], v[44:45], v[42:43] op_sel_hi:[1,0,1]
  v_pk_mul_f32 v[68:69], v[24:25], v[46:47] op_sel_hi:[1,0]
  v_pk_mul_f32 v[100:101], v[24:25], v[46:47] op_sel:[0,1] neg_lo:[0,1] neg_hi:[0,1]
  v_pk_fma_f32 v[68:69], v[26:27], v[46:47], v[68:69] op_sel:[0,1,0] neg_lo:[0,1,0] neg_hi:[0,1,0]
  v_pk_fma_f32 v[100:101], v[26:27], v[46:47], v[100:101] op_sel_hi:[1,0,1] neg_lo:[0,1,0] neg_hi:[0,1,0]
  v_pk_fma_f32 v[40:41], v[26:27], v[44:45], v[70:71] op_sel:[0,1,0] op_sel_hi:[1,1,1] neg_lo:[0,1,0] neg_hi:[0,1,0]
  v_pk_fma_f32 v[42:43], v[24:25], v[44:45], v[102:103] op_sel:[0,1,0] op_sel_hi:[1,1,1]
  v_pk_fma_f32 v[24:25], v[24:25], v[44:45], v[40:41] op_sel_hi:[1,0,1]
  v_pk_fma_f32 v[26:27], v[26:27], v[44:45], v[42:43] op_sel_hi:[1,0,1]
  v_pk_mul_f32 v[70:71], v[24:25], v[46:47] op_sel_hi:[1,0]
  v_pk_mul_f32 v[102:103], v[24:25], v[46:47] op_sel:[0,1] neg_lo:[0,1] neg_hi:[0,1]
  v_pk_fma_f32 v[70:71], v[26:27], v[46:47], v[70:71] op_sel:[0,1,0] neg_lo:[0,1,0] neg_hi:[0,1,0]
  v_pk_fma_f32 v[102:103], v[26:27], v[46:47], v[102:103] op_sel_hi:[1,0,1] neg_lo:[0,1,0] neg_hi:[0,1,0]
  v_pk_fma_f32 v[40:41], v[26:27], v[44:45], v[72:73] op_sel:[0,1,0] op_sel_hi:[1,1,1] neg_lo:[0,1,0] neg_hi:[0,1,0]
  v_pk_fma_f32 v[42:43], v[24:25], v[44:45], v[104:105] op_sel:[0,1,0] op_sel_hi:[1,1,1]
  v_pk_fma_f32 v[24:25], v[24:25], v[44:45], v[40:41] op_sel_hi:[1,0,1]
  v_pk_fma_f32 v[26:27], v[26:27], v[44:45], v[42:43] op_sel_hi:[1,0,1]
  v_pk_mul_f32 v[72:73], v[24:25], v[46:47] op_sel_hi:[1,0]
  buffer_load_dwordx4 a[204:207], v16, s[92:95], s100 offen offset:1024 sc1
  v_pk_mul_f32 v[104:105], v[24:25], v[46:47] op_sel:[0,1] neg_lo:[0,1] neg_hi:[0,1]
  v_pk_fma_f32 v[72:73], v[26:27], v[46:47], v[72:73] op_sel:[0,1,0] neg_lo:[0,1,0] neg_hi:[0,1,0]
  v_pk_fma_f32 v[104:105], v[26:27], v[46:47], v[104:105] op_sel_hi:[1,0,1] neg_lo:[0,1,0] neg_hi:[0,1,0]
  v_pk_fma_f32 v[40:41], v[26:27], v[44:45], v[74:75] op_sel:[0,1,0] op_sel_hi:[1,1,1] neg_lo:[0,1,0] neg_hi:[0,1,0]
  v_pk_fma_f32 v[42:43], v[24:25], v[44:45], v[106:107] op_sel:[0,1,0] op_sel_hi:[1,1,1]
  v_pk_fma_f32 v[24:25], v[24:25], v[44:45], v[40:41] op_sel_hi:[1,0,1]
  v_pk_fma_f32 v[26:27], v[26:27], v[44:45], v[42:43] op_sel_hi:[1,0,1]
  v_pk_mul_f32 v[74:75], v[24:25], v[46:47] op_sel_hi:[1,0]
  v_pk_mul_f32 v[106:107], v[24:25], v[46:47] op_sel:[0,1] neg_lo:[0,1] neg_hi:[0,1]
  v_pk_fma_f32 v[74:75], v[26:27], v[46:47], v[74:75] op_sel:[0,1,0] neg_lo:[0,1,0] neg_hi:[0,1,0]
  v_pk_fma_f32 v[106:107], v[26:27], v[46:47], v[106:107] op_sel_hi:[1,0,1] neg_lo:[0,1,0] neg_hi:[0,1,0]
  v_pk_fma_f32 v[40:41], v[26:27], v[44:45], v[76:77] op_sel:[0,1,0] op_sel_hi:[1,1,1] neg_lo:[0,1,0] neg_hi:[0,1,0]
  v_pk_fma_f32 v[42:43], v[24:25], v[44:45], v[108:109] op_sel:[0,1,0] op_sel_hi:[1,1,1]
  v_pk_fma_f32 v[24:25], v[24:25], v[44:45], v[40:41] op_sel_hi:[1,0,1]
  v_pk_fma_f32 v[26:27], v[26:27], v[44:45], v[42:43] op_sel_hi:[1,0,1]
  v_pk_mul_f32 v[76:77], v[24:25], v[46:47] op_sel_hi:[1,0]
  v_pk_mul_f32 v[108:109], v[24:25], v[46:47] op_sel:[0,1] neg_lo:[0,1] neg_hi:[0,1]
  v_pk_fma_f32 v[76:77], v[26:27], v[46:47], v[76:77] op_sel:[0,1,0] neg_lo:[0,1,0] neg_hi:[0,1,0]
  buffer_load_dwordx4 a[208:211], v16, s[92:95], s100 offen offset:2048 sc1
  s_mul_i32 s99, s99, 5
  v_pk_fma_f32 v[108:109], v[26:27], v[46:47], v[108:109] op_sel_hi:[1,0,1] neg_lo:[0,1,0] neg_hi:[0,1,0]
  v_pk_fma_f32 v[40:41], v[26:27], v[44:45], v[78:79] op_sel:[0,1,0] op_sel_hi:[1,1,1] neg_lo:[0,1,0] neg_hi:[0,1,0]
  v_pk_fma_f32 v[42:43], v[24:25], v[44:45], v[110:111] op_sel:[0,1,0] op_sel_hi:[1,1,1]
  v_pk_fma_f32 v[24:25], v[24:25], v[44:45], v[40:41] op_sel_hi:[1,0,1]
  v_pk_fma_f32 v[26:27], v[26:27], v[44:45], v[42:43] op_sel_hi:[1,0,1]
  v_pk_mul_f32 v[78:79], v[24:25], v[46:47] op_sel_hi:[1,0]
  v_pk_mul_f32 v[110:111], v[24:25], v[46:47] op_sel:[0,1] neg_lo:[0,1] neg_hi:[0,1]
  v_pk_fma_f32 v[78:79], v[26:27], v[46:47], v[78:79] op_sel:[0,1,0] neg_lo:[0,1,0] neg_hi:[0,1,0]
  v_pk_fma_f32 v[110:111], v[26:27], v[46:47], v[110:111] op_sel_hi:[1,0,1] neg_lo:[0,1,0] neg_hi:[0,1,0]
  v_cvt_pk_bf16_f32 v48, v64, v66
  v_cvt_pk_bf16_f32 v49, v68, v70
  v_cvt_pk_bf16_f32 v50, v72, v74
  v_cvt_pk_bf16_f32 v51, v76, v78
  ds_write_b128 v10, v[48:51] offset:0
  v_cvt_pk_bf16_f32 v52, v65, v67
  v_cvt_pk_bf16_f32 v53, v69, v71
  v_cvt_pk_bf16_f32 v54, v73, v75
  v_cvt_pk_bf16_f32 v55, v77, v79
  buffer_load_dwordx4 a[212:215], v16, s[92:95], s100 offen offset:3072 sc1
  ds_write_b128 v12, v[52:55] offset:0
  v_cvt_pk_bf16_f32 v56, v96, v98
  buffer_load_dwordx4 v[192:195], v6, s[20:23], 0 offen offset:0 sc1
  buffer_load_dwordx4 v[196:199], v6, s[20:23], 0 offen offset:512 sc1
  buffer_load_dwordx4 v[200:203], v6, s[20:23], 0 offen offset:1024 sc1
  buffer_load_dwordx4 v[204:207], v6, s[20:23], 0 offen offset:1536 sc1
  buffer_load_dwordx4 v[208:211], v6, s[20:23], 0 offen offset:2048 sc1
  buffer_load_dwordx4 v[212:215], v6, s[20:23], 0 offen offset:2560 sc1
  buffer_load_dwordx4 v[216:219], v6, s[20:23], 0 offen offset:3072 sc1
  buffer_load_dwordx4 v[220:223], v6, s[20:23], 0 offen offset:3584 sc1
  v_cvt_pk_bf16_f32 v57, v100, v102
  v_cvt_pk_bf16_f32 v58, v104, v106
  v_cvt_pk_bf16_f32 v59, v108, v110
  ds_write_b128 v10, v[56:59] offset:4096
  v_cvt_pk_bf16_f32 v60, v97, v99
  v_cvt_pk_bf16_f32 v61, v101, v103
  v_cvt_pk_bf16_f32 v62, v105, v107
  v_cvt_pk_bf16_f32 v63, v109, v111
  ds_write_b128 v12, v[60:63] offset:4096
  v_pk_fma_f32 v[40:41], v[26:27], v[44:45], v[80:81] op_sel:[0,1,0] op_sel_hi:[1,1,1] neg_lo:[0,1,0] neg_hi:[0,1,0]
  v_pk_fma_f32 v[42:43], v[24:25], v[44:45], v[112:113] op_sel:[0,1,0] op_sel_hi:[1,1,1]
  v_pk_fma_f32 v[24:25], v[24:25], v[44:45], v[40:41] op_sel_hi:[1,0,1]
  v_pk_fma_f32 v[26:27], v[26:27], v[44:45], v[42:43] op_sel_hi:[1,0,1]
  v_pk_mul_f32 v[80:81], v[24:25], v[46:47] op_sel_hi:[1,0]
  v_pk_mul_f32 v[112:113], v[24:25], v[46:47] op_sel:[0,1] neg_lo:[0,1] neg_hi:[0,1]
  v_pk_fma_f32 v[80:81], v[26:27], v[46:47], v[80:81] op_sel:[0,1,0] neg_lo:[0,1,0] neg_hi:[0,1,0]
  v_pk_fma_f32 v[112:113], v[26:27], v[46:47], v[112:113] op_sel_hi:[1,0,1] neg_lo:[0,1,0] neg_hi:[0,1,0]
  v_pk_fma_f32 v[40:41], v[26:27], v[44:45], v[82:83] op_sel:[0,1,0] op_sel_hi:[1,1,1] neg_lo:[0,1,0] neg_hi:[0,1,0]
  s_add_u32 s100, s100, 4096
  buffer_load_dwordx4 a[216:219], v16, s[92:95], s100 offen offset:0 sc1
  v_pk_fma_f32 v[42:43], v[24:25], v[44:45], v[114:115] op_sel:[0,1,0] op_sel_hi:[1,1,1]
  v_pk_fma_f32 v[24:25], v[24:25], v[44:45], v[40:41] op_sel_hi:[1,0,1]
  v_pk_fma_f32 v[26:27], v[26:27], v[44:45], v[42:43] op_sel_hi:[1,0,1]
  v_pk_mul_f32 v[82:83], v[24:25], v[46:47] op_sel_hi:[1,0]
  v_pk_mul_f32 v[114:115], v[24:25], v[46:47] op_sel:[0,1] neg_lo:[0,1] neg_hi:[0,1]
  v_pk_fma_f32 v[82:83], v[26:27], v[46:47], v[82:83] op_sel:[0,1,0] neg_lo:[0,1,0] neg_hi:[0,1,0]
  v_pk_fma_f32 v[114:115], v[26:27], v[46:47], v[114:115] op_sel_hi:[1,0,1] neg_lo:[0,1,0] neg_hi:[0,1,0]
  v_pk_fma_f32 v[40:41], v[26:27], v[44:45], v[84:85] op_sel:[0,1,0] op_sel_hi:[1,1,1] neg_lo:[0,1,0] neg_hi:[0,1,0]
  v_pk_fma_f32 v[42:43], v[24:25], v[44:45], v[116:117] op_sel:[0,1,0] op_sel_hi:[1,1,1]
  v_pk_fma_f32 v[24:25], v[24:25], v[44:45], v[40:41] op_sel_hi:[1,0,1]
  v_pk_fma_f32 v[26:27], v[26:27], v[44:45], v[42:43] op_sel_hi:[1,0,1]
  v_pk_mul_f32 v[84:85], v[24:25], v[46:47] op_sel_hi:[1,0]
  v_pk_mul_f32 v[116:117], v[24:25], v[46:47] op_sel:[0,1] neg_lo:[0,1] neg_hi:[0,1]
  v_pk_fma_f32 v[84:85], v[26:27], v[46:47], v[84:85] op_sel:[0,1,0] neg_lo:[0,1,0] neg_hi:[0,1,0]
  v_pk_fma_f32 v[116:117], v[26:27], v[46:47], v[116:117] op_sel_hi:[1,0,1] neg_lo:[0,1,0] neg_hi:[0,1,0]
  v_pk_fma_f32 v[40:41], v[26:27], v[44:45], v[86:87] op_sel:[0,1,0] op_sel_hi:[1,1,1] neg_lo:[0,1,0] neg_hi:[0,1,0]
  v_pk_fma_f32 v[42:43], v[24:25], v[44:45], v[118:119] op_sel:[0,1,0] op_sel_hi:[1,1,1]
  v_pk_fma_f32 v[24:25], v[24:25], v[44:45], v[40:41] op_sel_hi:[1,0,1]
  buffer_load_dwordx4 a[220:223], v16, s[92:95], s99 offen offset:0 sc1
  v_readlane_b32 s100, v13, 5
  v_pk_fma_f32 v[26:27], v[26:27], v[44:45], v[42:43] op_sel_hi:[1,0,1]
  v_pk_mul_f32 v[86:87], v[24:25], v[46:47] op_sel_hi:[1,0]
  v_pk_mul_f32 v[118:119], v[24:25], v[46:47] op_sel:[0,1] neg_lo:[0,1] neg_hi:[0,1]
  v_pk_fma_f32 v[86:87], v[26:27], v[46:47], v[86:87] op_sel:[0,1,0] neg_lo:[0,1,0] neg_hi:[0,1,0]
  v_pk_fma_f32 v[118:119], v[26:27], v[46:47], v[118:119] op_sel_hi:[1,0,1] neg_lo:[0,1,0] neg_hi:[0,1,0]
  v_pk_fma_f32 v[40:41], v[26:27], v[44:45], v[88:89] op_sel:[0,1,0] op_sel_hi:[1,1,1] neg_lo:[0,1,0] neg_hi:[0,1,0]
  v_pk_fma_f32 v[42:43], v[24:25], v[44:45], v[120:121] op_sel:[0,1,0] op_sel_hi:[1,1,1]
  v_pk_fma_f32 v[24:25], v[24:25], v[44:45], v[40:41] op_sel_hi:[1,0,1]
  v_pk_fma_f32 v[26:27], v[26:27], v[44:45], v[42:43] op_sel_hi:[1,0,1]
  v_pk_mul_f32 v[88:89], v[24:25], v[46:47] op_sel_hi:[1,0]
  v_pk_mul_f32 v[120:121], v[24:25], v[46:47] op_sel:[0,1] neg_lo:[0,1] neg_hi:[0,1]
  v_pk_fma_f32 v[88:89], v[26:27], v[46:47], v[88:89] op_sel:[0,1,0] neg_lo:[0,1,0] neg_hi:[0,1,0]
  v_pk_fma_f32 v[120:121], v[26:27], v[46:47], v[120:121] op_sel_hi:[1,0,1] neg_lo:[0,1,0] neg_hi:[0,1,0]
  v_pk_fma_f32 v[40:41], v[26:27], v[44:45], v[90:91] op_sel:[0,1,0] op_sel_hi:[1,1,1] neg_lo:[0,1,0] neg_hi:[0,1,0]
  v_pk_fma_f32 v[42:43], v[24:25], v[44:45], v[122:123] op_sel:[0,1,0] op_sel_hi:[1,1,1]
  v_pk_fma_f32 v[24:25], v[24:25], v[44:45], v[40:41] op_sel_hi:[1,0,1]
  v_pk_fma_f32 v[26:27], v[26:27], v[44:45], v[42:43] op_sel_hi:[1,0,1]
  v_pk_mul_f32 v[90:91], v[24:25], v[46:47] op_sel_hi:[1,0]
  buffer_load_dwordx4 a[224:227], v16, s[92:95], s99 offen offset:1024 sc1
  v_pk_mul_f32 v[122:123], v[24:25], v[46:47] op_sel:[0,1] neg_lo:[0,1] neg_hi:[0,1]
  v_pk_fma_f32 v[90:91], v[26:27], v[46:47], v[90:91] op_sel:[0,1,0] neg_lo:[0,1,0] neg_hi:[0,1,0]
  v_pk_fma_f32 v[122:123], v[26:27], v[46:47], v[122:123] op_sel_hi:[1,0,1] neg_lo:[0,1,0] neg_hi:[0,1,0]
  v_pk_fma_f32 v[40:41], v[26:27], v[44:45], v[92:93] op_sel:[0,1,0] op_sel_hi:[1,1,1] neg_lo:[0,1,0] neg_hi:[0,1,0]
  v_pk_fma_f32 v[42:43], v[24:25], v[44:45], v[124:125] op_sel:[0,1,0] op_sel_hi:[1,1,1]
  v_pk_fma_f32 v[24:25], v[24:25], v[44:45], v[40:41] op_sel_hi:[1,0,1]
  v_pk_fma_f32 v[26:27], v[26:27], v[44:45], v[42:43] op_sel_hi:[1,0,1]
  v_pk_mul_f32 v[92:93], v[24:25], v[46:47] op_sel_hi:[1,0]
  v_pk_mul_f32 v[124:125], v[24:25], v[46:47] op_sel:[0,1] neg_lo:[0,1] neg_hi:[0,1]
  v_pk_fma_f32 v[92:93], v[26:27], v[46:47], v[92:93] op_sel:[0,1,0] neg_lo:[0,1,0] neg_hi:[0,1,0]
  v_pk_fma_f32 v[124:125], v[26:27], v[46:47], v[124:125] op_sel_hi:[1,0,1] neg_lo:[0,1,0] neg_hi:[0,1,0]
  v_pk_fma_f32 v[40:41], v[26:27], v[44:45], v[94:95] op_sel:[0,1,0] op_sel_hi:[1,1,1] neg_lo:[0,1,0] neg_hi:[0,1,0]
  v_pk_fma_f32 v[42:43], v[24:25], v[44:45], v[126:127] op_sel:[0,1,0] op_sel_hi:[1,1,1]
  v_pk_fma_f32 v[24:25], v[24:25], v[44:45], v[40:41] op_sel_hi:[1,0,1]
  v_pk_fma_f32 v[26:27], v[26:27], v[44:45], v[42:43] op_sel_hi:[1,0,1]
  v_pk_mul_f32 v[94:95], v[24:25], v[46:47] op_sel_hi:[1,0]
  v_pk_mul_f32 v[126:127], v[24:25], v[46:47] op_sel:[0,1] neg_lo:[0,1] neg_hi:[0,1]
  v_pk_fma_f32 v[94:95], v[26:27], v[46:47], v[94:95] op_sel:[0,1,0] neg_lo:[0,1,0] neg_hi:[0,1,0]
  buffer_load_dwordx4 a[228:231], v16, s[92:95], s99 offen offset:2048 sc1
  s_mul_i32 s100, s100, 5
  v_pk_fma_f32 v[126:127], v[26:27], v[46:47], v[126:127] op_sel_hi:[1,0,1] neg_lo:[0,1,0] neg_hi:[0,1,0]
  v_cvt_pk_bf16_f32 v48, v80, v82
  v_cvt_pk_bf16_f32 v49, v84, v86
  v_cvt_pk_bf16_f32 v50, v88, v90
  v_cvt_pk_bf16_f32 v51, v92, v94
  ds_write_b128 v11, v[48:51] offset:0
  v_cvt_pk_bf16_f32 v52, v81, v83
  v_cvt_pk_bf16_f32 v53, v85, v87
  v_cvt_pk_bf16_f32 v54, v89, v91
  v_cvt_pk_bf16_f32 v55, v93, v95
  ds_write_b128 v15, v[52:55] offset:0
  v_cvt_pk_bf16_f32 v56, v112, v114
  v_cvt_pk_bf16_f32 v57, v116, v118
  v_cvt_pk_bf16_f32 v58, v120, v122
  v_cvt_pk_bf16_f32 v59, v124, v126
  ds_write_b128 v11, v[56:59] offset:4096
  v_cvt_pk_bf16_f32 v60, v113, v115
  v_cvt_pk_bf16_f32 v61, v117, v119
  buffer_load_dwordx4 a[232:235], v16, s[92:95], s99 offen offset:3072 sc1
  v_cvt_pk_bf16_f32 v62, v121, v123
  v_cvt_pk_bf16_f32 v63, v125, v127
  ds_write_b128 v15, v[60:63] offset:4096
  s_waitcnt lgkmcnt(0)
  ds_read_b64_tr_b16 v[96:97], v252 offset:0
  ds_read_b64_tr_b16 v[98:99], v254 offset:512
  ds_read_b64_tr_b16 v[100:101], v253 offset:0
  ds_read_b64_tr_b16 v[102:103], v255 offset:512
  ds_read_b64_tr_b16 v[104:105], v254 offset:0
  ds_read_b64_tr_b16 v[106:107], v252 offset:512
  ds_read_b64_tr_b16 v[108:109], v255 offset:0
  ds_read_b64_tr_b16 v[110:111], v253 offset:512
  ds_read_b64_tr_b16 v[112:113], v252 offset:4096
  ds_read_b64_tr_b16 v[114:115], v254 offset:4608
  ds_read_b64_tr_b16 v[116:117], v253 offset:4096
  ds_read_b64_tr_b16 v[118:119], v255 offset:4608
  ds_read_b64_tr_b16 v[120:121], v254 offset:4096
  ds_read_b64_tr_b16 v[122:123], v252 offset:4608
  ds_read_b64_tr_b16 v[124:125], v255 offset:4096
  ds_read_b64_tr_b16 v[126:127], v253 offset:4608
  v_pk_mul_f32 v[36:37], v[20:21], v[20:21] op_sel_hi:[0,1]
  v_pk_fma_f32 v[240:241], v[20:21], v[20:21], v[36:37] op_sel:[1,1,0] op_sel_hi:[1,0,1] neg_lo:[0,1,0]
  v_pk_mul_f32 v[36:37], v[240:241], v[240:241] op_sel_hi:[0,1]
  v_pk_fma_f32 v[240:241], v[240:241], v[240:241], v[36:37] op_sel:[1,1,0] op_sel_hi:[1,0,1] neg_lo:[0,1,0]
  v_pk_mul_f32 v[36:37], v[240:241], v[240:241] op_sel_hi:[0,1]
  v_pk_fma_f32 v[240:241], v[240:241], v[240:241], v[36:37] op_sel:[1,1,0] op_sel_hi:[1,0,1] neg_lo:[0,1,0]
  v_pk_mul_f32 v[36:37], v[240:241], v[240:241] op_sel_hi:[0,1]
  v_pk_fma_f32 v[240:241], v[240:241], v[240:241], v[36:37] op_sel:[1,1,0] op_sel_hi:[1,0,1] neg_lo:[0,1,0]
  v_pk_mul_f32 v[36:37], v[240:241], v[240:241] op_sel_hi:[0,1]
  v_pk_fma_f32 v[242:243], v[240:241], v[240:241], v[36:37] op_sel:[1,1,0] op_sel_hi:[1,0,1] neg_lo:[0,1,0]
  s_add_u32 s99, s99, 4096
  buffer_load_dwordx4 a[236:239], v16, s[92:95], s99 offen offset:0 sc1
  v_pk_mul_f32 v[36:37], v[242:243], v[242:243] op_sel_hi:[0,1]
  v_pk_fma_f32 v[244:245], v[242:243], v[242:243], v[36:37] op_sel:[1,1,0] op_sel_hi:[1,0,1] neg_lo:[0,1,0]
  v_pk_mul_f32 v[36:37], v[244:245], v[244:245] op_sel_hi:[0,1]
  v_pk_fma_f32 v[246:247], v[244:245], v[244:245], v[36:37] op_sel:[1,1,0] op_sel_hi:[1,0,1] neg_lo:[0,1,0]
  v_pk_mul_f32 v[36:37], v[246:247], v[246:247] op_sel_hi:[0,1]
  v_pk_fma_f32 v[248:249], v[246:247], v[246:247], v[36:37] op_sel:[1,1,0] op_sel_hi:[1,0,1] neg_lo:[0,1,0]
  v_pk_mul_f32 v[36:37], v[248:249], v[248:249] op_sel_hi:[0,1]
  v_pk_fma_f32 v[248:249], v[248:249], v[248:249], v[36:37] op_sel:[1,1,0] op_sel_hi:[1,0,1] neg_lo:[0,1,0]
  v_pk_mul_f32 v[36:37], v[248:249], v[248:249] op_sel_hi:[0,1]
  v_pk_fma_f32 v[248:249], v[248:249], v[248:249], v[36:37] op_sel:[1,1,0] op_sel_hi:[1,0,1] neg_lo:[0,1,0]
  buffer_load_dwordx4 a[100:103], v16, s[92:95], s100 offen offset:0 sc1
  v_readlane_b32 s99, v13, 6
  buffer_load_dwordx4 a[104:107], v16, s[92:95], s100 offen offset:1024 sc1
  buffer_load_dwordx4 a[108:111], v16, s[92:95], s100 offen offset:2048 sc1
  s_mul_i32 s99, s99, 5
  buffer_load_dwordx4 a[112:115], v16, s[92:95], s100 offen offset:3072 sc1
  s_add_u32 s100, s100, 4096
  buffer_load_dwordx4 a[116:119], v16, s[92:95], s100 offen offset:0 sc1
  buffer_load_dwordx4 a[120:123], v16, s[92:95], s99 offen offset:0 sc1
  v_readlane_b32 s100, v13, 7
  buffer_load_dwordx4 a[124:127], v16, s[92:95], s99 offen offset:1024 sc1
  buffer_load_dwordx4 a[128:131], v16, s[92:95], s99 offen offset:2048 sc1
  s_mul_i32 s100, s100, 5
  buffer_load_dwordx4 a[132:135], v16, s[92:95], s99 offen offset:3072 sc1
  s_add_u32 s99, s99, 4096
  buffer_load_dwordx4 a[136:139], v16, s[92:95], s99 offen offset:0 sc1
  buffer_load_dwordx4 a[140:143], v16, s[92:95], s100 offen offset:0 sc1
  buffer_load_dwordx4 a[144:147], v16, s[92:95], s100 offen offset:1024 sc1
  buffer_load_dwordx4 a[148:151], v16, s[92:95], s100 offen offset:2048 sc1
  buffer_load_dwordx4 a[152:155], v16, s[92:95], s100 offen offset:3072 sc1
  s_add_u32 s100, s100, 4096
  buffer_load_dwordx4 a[156:159], v16, s[92:95], s100 offen offset:0 sc1
  s_mov_b64 s[46:47], s[52:53]
  s_load_dwordx2 s[6:7], s[0:1], 0
  s_load_dwordx2 s[4:5], s[0:1], 64
  s_load_dwordx2 s[34:35], s[0:1], 104
  s_bfe_u32 s53, s2, 0x10002
  s_lshl_b32 s3, s96, 3
  s_add_u32 s57, s3, s97
  s_lshl_b32 s3, s57, 1
  s_add_u32 s3, s3, s53
  s_lshl_b32 s3, s3, 7
  s_add_u32 s56, s3, 32768
  s_cmp_eq_u32 s24, 0
  s_cselect_b32 s36, s56, 1073741824
  v_and_b32 v18, 15, v1
  v_lshlrev_b32 v18, 2, v18
  s_add_u32 s3, s56, 688128
  buffer_load_dword v19, v18, s[64:67], s3 offen sc1
  s_lshl_b32 s55, s96, 1
  s_mul_i32 s55, s55, 385024
  s_add_u32 s55, s55, 3145728
  s_add_u32 s8, s38, s55
  s_addc_u32 s9, s39, 0
  s_mov_b32 s10, 770048
  s_mov_b32 s11, 0x20000
  s_mul_i32 s49, s53, 385024
  s_sub_u32 s48, 385024, s49
  v_readlane_b32 s40, v13, 0
  s_nop 1
  s_lshl_b32 s40, s40, 2
  s_add_u32 s40, s40, s48
  v_readlane_b32 s41, v13, 1
  s_nop 1
  s_lshl_b32 s41, s41, 2
  s_add_u32 s41, s41, s48
  v_readlane_b32 s42, v13, 2
  s_nop 1
  s_lshl_b32 s42, s42, 2
  s_add_u32 s42, s42, s48
  v_readlane_b32 s43, v13, 0
  s_nop 1
  s_lshl_b32 s43, s43, 2
  s_add_u32 s43, s43, s49
  s_waitcnt lgkmcnt(14)
  buffer_store_dwordx4 v[96:99], v14, s[12:15], s30 offen offset:0 sc1
  s_waitcnt lgkmcnt(12)
  buffer_store_dwordx4 v[100:103], v14, s[12:15], s30 offen offset:1024 sc1
  s_waitcnt lgkmcnt(10)
  buffer_store_dwordx4 v[104:107], v14, s[12:15], s30 offen offset:2048 sc1
  s_waitcnt lgkmcnt(8)
  buffer_store_dwordx4 v[108:111], v14, s[12:15], s30 offen offset:3072 sc1
  s_waitcnt lgkmcnt(6)
  buffer_store_dwordx4 v[112:115], v14, s[12:15], s31 offen offset:0 sc1
  s_waitcnt lgkmcnt(4)
  buffer_store_dwordx4 v[116:119], v14, s[12:15], s31 offen offset:1024 sc1
  s_waitcnt lgkmcnt(2)
  buffer_store_dwordx4 v[120:123], v14, s[12:15], s31 offen offset:2048 sc1
  s_waitcnt lgkmcnt(0)
  buffer_store_dwordx4 v[124:127], v14, s[12:15], s31 offen offset:3072 sc1
  s_waitcnt vmcnt(30)
  s_mov_b32 s62, 0
L_CHK18:
  v_bitop3_b32 v194, v192, v193, v194 bitop3:0x96
  v_bitop3_b32 v198, v196, v197, v198 bitop3:0x96
  v_bitop3_b32 v202, v200, v201, v202 bitop3:0x96
  v_bitop3_b32 v206, v204, v205, v206 bitop3:0x96
  v_bitop3_b32 v210, v208, v209, v210 bitop3:0x96
  v_bitop3_b32 v214, v212, v213, v214 bitop3:0x96
  v_bitop3_b32 v218, v216, v217, v218 bitop3:0x96
  v_bitop3_b32 v222, v220, v221, v222 bitop3:0x96
  v_add_u32 v9, v194, v198
  v_add3_u32 v9, v9, v202, v206
  v_add3_u32 v9, v9, v210, v214
  v_add3_u32 v9, v9, v218, v222
  v_cmp_ne_u32 vcc, v9, v8
  s_cbranch_vccz L_OK18
  s_add_u32 s62, s62, 1
  s_cmp_lt_u32 s62, 0x40000
  s_cbranch_scc0 L_OK18
  s_sleep 2
  buffer_load_dwordx4 v[192:195], v6, s[20:23], 0 offen offset:0 sc1
  buffer_load_dwordx4 v[196:199], v6, s[20:23], 0 offen offset:512 sc1
  buffer_load_dwordx4 v[200:203], v6, s[20:23], 0 offen offset:1024 sc1
  buffer_load_dwordx4 v[204:207], v6, s[20:23], 0 offen offset:1536 sc1
  buffer_load_dwordx4 v[208:211], v6, s[20:23], 0 offen offset:2048 sc1
  buffer_load_dwordx4 v[212:215], v6, s[20:23], 0 offen offset:2560 sc1
  buffer_load_dwordx4 v[216:219], v6, s[20:23], 0 offen offset:3072 sc1
  buffer_load_dwordx4 v[220:223], v6, s[20:23], 0 offen offset:3584 sc1
  s_waitcnt vmcnt(0)
  s_branch L_CHK18
L_OK18:
  v_pk_fma_f32 v[40:41], v[220:221], v[246:247], v[216:217] op_sel:[1,1,0] op_sel_hi:[0,1,1] neg_lo:[0,1,0]
  v_pk_fma_f32 v[36:37], v[220:221], v[246:247], v[40:41] op_sel_hi:[1,0,1]
  v_pk_fma_f32 v[40:41], v[36:37], v[246:247], v[212:213] op_sel:[1,1,0] op_sel_hi:[0,1,1] neg_lo:[0,1,0]
  v_pk_fma_f32 v[36:37], v[36:37], v[246:247], v[40:41] op_sel_hi:[1,0,1]
  v_pk_fma_f32 v[40:41], v[36:37], v[246:247], v[208:209] op_sel:[1,1,0] op_sel_hi:[0,1,1] neg_lo:[0,1,0]
  v_pk_fma_f32 v[36:37], v[36:37], v[246:247], v[40:41] op_sel_hi:[1,0,1]
  v_pk_fma_f32 v[40:41], v[36:37], v[246:247], v[204:205] op_sel:[1,1,0] op_sel_hi:[0,1,1] neg_lo:[0,1,0]
  v_pk_fma_f32 v[36:37], v[36:37], v[246:247], v[40:41] op_sel_hi:[1,0,1]
  v_pk_fma_f32 v[40:41], v[36:37], v[246:247], v[200:201] op_sel:[1,1,0] op_sel_hi:[0,1,1] neg_lo:[0,1,0]
  v_pk_fma_f32 v[36:37], v[36:37], v[246:247], v[40:41] op_sel_hi:[1,0,1]
  v_pk_fma_f32 v[40:41], v[36:37], v[246:247], v[196:197] op_sel:[1,1,0] op_sel_hi:[0,1,1] neg_lo:[0,1,0]
  v_pk_fma_f32 v[36:37], v[36:37], v[246:247], v[40:41] op_sel_hi:[1,0,1]
  v_pk_fma_f32 v[40:41], v[36:37], v[246:247], v[192:193] op_sel:[1,1,0] op_sel_hi:[0,1,1] neg_lo:[0,1,0]
  v_pk_fma_f32 v[36:37], v[36:37], v[246:247], v[40:41] op_sel_hi:[1,0,1]
  v_mov_b32 v38, v36
  v_mov_b32 v39, v37
  s_nop 1
  v_permlane32_swap_b32 v38, v36
  v_permlane32_swap_b32 v39, v37
  v_pk_fma_f32 v[40:41], v[36:37], v[248:249], v[38:39] op_sel:[1,1,0] op_sel_hi:[0,1,1] neg_lo:[0,1,0]
  v_pk_fma_f32 v[36:37], v[36:37], v[248:249], v[40:41] op_sel_hi:[1,0,1]
  v_pk_fma_f32 v[40:41], v[36:37], v[244:245], v[232:233] op_sel:[1,1,0] op_sel_hi:[0,1,1] neg_lo:[0,1,0]
  v_pk_fma_f32 v[38:39], v[36:37], v[244:245], v[40:41] op_sel_hi:[1,0,1]
  v_cndmask_b32 v36, v36, v38, s[46:47]
  v_cndmask_b32 v37, v37, v39, s[46:47]
  v_pk_fma_f32 v[40:41], v[36:37], v[242:243], v[230:231] op_sel:[1,1,0] op_sel_hi:[0,1,1] neg_lo:[0,1,0]
  v_pk_fma_f32 v[38:39], v[36:37], v[242:243], v[40:41] op_sel_hi:[1,0,1]
  v_cndmask_b32 v36, v36, v38, s[58:59]
  v_cndmask_b32 v37, v37, v39, s[58:59]
  v_pk_fma_f32 v[40:41], v[36:37], v[240:241], v[228:229] op_sel:[1,1,0] op_sel_hi:[0,1,1] neg_lo:[0,1,0]
  s_waitcnt vmcnt(8)
  s_mov_b32 s62, 0
L_CHK19:
  v_cmp_ne_u32 vcc, s60, v19
  s_and_b64 vcc, vcc, 0x7ff
  s_cbranch_vccz L_OK19
  s_add_u32 s62, s62, 1
  s_cmp_lt_u32 s62, 0x40000
  s_cbranch_scc0 L_OK19
  s_sleep 2
  s_add_u32 s3, s56, 688128
  buffer_load_dword v19, v18, s[64:67], s3 offen sc1
  s_waitcnt vmcnt(0)
  s_branch L_CHK19
L_OK19:
  v_pk_fma_f32 v[38:39], v[36:37], v[240:241], v[40:41] op_sel_hi:[1,0,1]
  v_mov_b32 v24, v36
  v_mov_b32 v25, v38
  v_mov_b32 v26, v37
  v_mov_b32 v27, v39
  v_pk_fma_f32 v[40:41], v[26:27], v[20:21], v[128:129] op_sel:[0,1,0] op_sel_hi:[1,1,1] neg_lo:[0,1,0] neg_hi:[0,1,0]
  v_pk_fma_f32 v[42:43], v[24:25], v[20:21], v[160:161] op_sel:[0,1,0] op_sel_hi:[1,1,1]
  v_pk_fma_f32 v[24:25], v[24:25], v[20:21], v[40:41] op_sel_hi:[1,0,1]
  v_pk_fma_f32 v[26:27], v[26:27], v[20:21], v[42:43] op_sel_hi:[1,0,1]
  v_pk_mul_f32 v[128:129], v[24:25], v[22:23] op_sel_hi:[1,0]
  v_pk_mul_f32 v[160:161], v[24:25], v[22:23] op_sel:[0,1] neg_lo:[0,1] neg_hi:[0,1]
  v_pk_fma_f32 v[128:129], v[26:27], v[22:23], v[128:129] op_sel:[0,1,0] neg_lo:[0,1,0] neg_hi:[0,1,0]
  buffer_load_dwordx4 a[160:163], v16, s[8:11], s40 offen offset:0 sc1
  v_pk_fma_f32 v[160:161], v[26:27], v[22:23], v[160:161] op_sel_hi:[1,0,1] neg_lo:[0,1,0] neg_hi:[0,1,0]
  v_pk_fma_f32 v[40:41], v[26:27], v[20:21], v[130:131] op_sel:[0,1,0] op_sel_hi:[1,1,1] neg_lo:[0,1,0] neg_hi:[0,1,0]
  v_pk_fma_f32 v[42:43], v[24:25], v[20:21], v[162:163] op_sel:[0,1,0] op_sel_hi:[1,1,1]
  v_pk_fma_f32 v[24:25], v[24:25], v[20:21], v[40:41] op_sel_hi:[1,0,1]
  v_pk_fma_f32 v[26:27], v[26:27], v[20:21], v[42:43] op_sel_hi:[1,0,1]
  v_pk_mul_f32 v[130:131], v[24:25], v[22:23] op_sel_hi:[1,0]
  v_pk_mul_f32 v[162:163], v[24:25], v[22:23] op_sel:[0,1] neg_lo:[0,1] neg_hi:[0,1]
  v_pk_fma_f32 v[130:131], v[26:27], v[22:23], v[130:131] op_sel:[0,1,0] neg_lo:[0,1,0] neg_hi:[0,1,0]
  v_pk_fma_f32 v[162:163], v[26:27], v[22:23], v[162:163] op_sel_hi:[1,0,1] neg_lo:[0,1,0] neg_hi:[0,1,0]
  v_pk_fma_f32 v[40:41], v[26:27], v[20:21], v[132:133] op_sel:[0,1,0] op_sel_hi:[1,1,1] neg_lo:[0,1,0] neg_hi:[0,1,0]
  v_pk_fma_f32 v[42:43], v[24:25], v[20:21], v[164:165] op_sel:[0,1,0] op_sel_hi:[1,1,1]
  v_pk_fma_f32 v[24:25], v[24:25], v[20:21], v[40:41] op_sel_hi:[1,0,1]
  buffer_load_dwordx4 a[164:167], v16, s[8:11], s40 offen offset:1024 sc1
  v_pk_fma_f32 v[26:27], v[26:27], v[20:21], v[42:43] op_sel_hi:[1,0,1]
  v_pk_mul_f32 v[132:133], v[24:25], v[22:23] op_sel_hi:[1,0]
  v_pk_mul_f32 v[164:165], v[24:25], v[22:23] op_sel:[0,1] neg_lo:[0,1] neg_hi:[0,1]
  v_pk_fma_f32 v[132:133], v[26:27], v[22:23], v[132:133] op_sel:[0,1,0] neg_lo:[0,1,0] neg_hi:[0,1,0]
  v_pk_fma_f32 v[164:165], v[26:27], v[22:23], v[164:165] op_sel_hi:[1,0,1] neg_lo:[0,1,0] neg_hi:[0,1,0]
  v_pk_fma_f32 v[40:41], v[26:27], v[20:21], v[134:135] op_sel:[0,1,0] op_sel_hi:[1,1,1] neg_lo:[0,1,0] neg_hi:[0,1,0]
  v_pk_fma_f32 v[42:43], v[24:25], v[20:21], v[166:167] op_sel:[0,1,0] op_sel_hi:[1,1,1]
  v_pk_fma_f32 v[24:25], v[24:25], v[20:21], v[40:41] op_sel_hi:[1,0,1]
  v_pk_fma_f32 v[26:27], v[26:27], v[20:21], v[42:43] op_sel_hi:[1,0,1]
  v_pk_mul_f32 v[134:135], v[24:25], v[22:23] op_sel_hi:[1,0]
  v_pk_mul_f32 v[166:167], v[24:25], v[22:23] op_sel:[0,1] neg_lo:[0,1] neg_hi:[0,1]
  v_pk_fma_f32 v[134:135], v[26:27], v[22:23], v[134:135] op_sel:[0,1,0] neg_lo:[0,1,0] neg_hi:[0,1,0]
  buffer_load_dwordx4 a[168:171], v16, s[8:11], s40 offen offset:2048 sc1
  v_pk_fma_f32 v[166:167], v[26:27], v[22:23], v[166:167] op_sel_hi:[1,0,1] neg_lo:[0,1,0] neg_hi:[0,1,0]
  v_pk_fma_f32 v[40:41], v[26:27], v[20:21], v[136:137] op_sel:[0,1,0] op_sel_hi:[1,1,1] neg_lo:[0,1,0] neg_hi:[0,1,0]
  v_pk_fma_f32 v[42:43], v[24:25], v[20:21], v[168:169] op_sel:[0,1,0] op_sel_hi:[1,1,1]
  v_pk_fma_f32 v[24:25], v[24:25], v[20:21], v[40:41] op_sel_hi:[1,0,1]
  v_pk_fma_f32 v[26:27], v[26:27], v[20:21], v[42:43] op_sel_hi:[1,0,1]
  v_pk_mul_f32 v[136:137], v[24:25], v[22:23] op_sel_hi:[1,0]
  v_pk_mul_f32 v[168:169], v[24:25], v[22:23] op_sel:[0,1] neg_lo:[0,1] neg_hi:[0,1]
  v_pk_fma_f32 v[136:137], v[26:27], v[22:23], v[136:137] op_sel:[0,1,0] neg_lo:[0,1,0] neg_hi:[0,1,0]
  v_pk_fma_f32 v[168:169], v[26:27], v[22:23], v[168:169] op_sel_hi:[1,0,1] neg_lo:[0,1,0] neg_hi:[0,1,0]
  v_pk_fma_f32 v[40:41], v[26:27], v[20:21], v[138:139] op_sel:[0,1,0] op_sel_hi:[1,1,1] neg_lo:[0,1,0] neg_hi:[0,1,0]
  v_pk_fma_f32 v[42:43], v[24:25], v[20:21], v[170:171] op_sel:[0,1,0] op_sel_hi:[1,1,1]
  v_pk_fma_f32 v[24:25], v[24:25], v[20:21], v[40:41] op_sel_hi:[1,0,1]
  buffer_load_dwordx4 a[172:175], v16, s[8:11], s40 offen offset:3072 sc1
  v_readlane_b32 s40, v13, 1
  s_nop 1
  s_lshl_b32 s40, s40, 2
  s_add_u32 s40, s40, s49
  v_pk_fma_f32 v[26:27], v[26:27], v[20:21], v[42:43] op_sel_hi:[1,0,1]
  v_pk_mul_f32 v[138:139], v[24:25], v[22:23] op_sel_hi:[1,0]
  v_pk_mul_f32 v[170:171], v[24:25], v[22:23] op_sel:[0,1] neg_lo:[0,1] neg_hi:[0,1]
  v_pk_fma_f32 v[138:139], v[26:27], v[22:23], v[138:139] op_sel:[0,1,0] neg_lo:[0,1,0] neg_hi:[0,1,0]
  v_pk_fma_f32 v[170:171], v[26:27], v[22:23], v[170:171] op_sel_hi:[1,0,1] neg_lo:[0,1,0] neg_hi:[0,1,0]
  v_pk_fma_f32 v[40:41], v[26:27], v[20:21], v[140:141] op_sel:[0,1,0] op_sel_hi:[1,1,1] neg_lo:[0,1,0] neg_hi:[0,1,0]
  v_pk_fma_f32 v[42:43], v[24:25], v[20:21], v[172:173] op_sel:[0,1,0] op_sel_hi:[1,1,1]
  v_pk_fma_f32 v[24:25], v[24:25], v[20:21], v[40:41] op_sel_hi:[1,0,1]
  v_pk_fma_f32 v[26:27], v[26:27], v[20:21], v[42:43] op_sel_hi:[1,0,1]
  v_pk_mul_f32 v[140:141], v[24:25], v[22:23] op_sel_hi:[1,0]
  v_pk_mul_f32 v[172:173], v[24:25], v[22:23] op_sel:[0,1] neg_lo:[0,1] neg_hi:[0,1]
  v_pk_fma_f32 v[140:141], v[26:27], v[22:23], v[140:141] op_sel:[0,1,0] neg_lo:[0,1,0] neg_hi:[0,1,0]
  buffer_load_dwordx4 a[176:179], v16, s[8:11], s41 offen offset:0 sc1
  v_pk_fma_f32 v[172:173], v[26:27], v[22:23], v[172:173] op_sel_hi:[1,0,1] neg_lo:[0,1,0] neg_hi:[0,1,0]
  v_pk_fma_f32 v[40:41], v[26:27], v[20:21], v[142:143] op_sel:[0,1,0] op_sel_hi:[1,1,1] neg_lo:[0,1,0] neg_hi:[0,1,0]
  v_pk_fma_f32 v[42:43], v[24:25], v[20:21], v[174:175] op_sel:[0,1,0] op_sel_hi:[1,1,1]
  v_pk_fma_f32 v[24:25], v[24:25], v[20:21], v[40:41] op_sel_hi:[1,0,1]
  v_pk_fma_f32 v[26:27], v[26:27], v[20:21], v[42:43] op_sel_hi:[1,0,1]
  v_pk_mul_f32 v[142:143], v[24:25], v[22:23] op_sel_hi:[1,0]
  v_pk_mul_f32 v[174:175], v[24:25], v[22:23] op_sel:[0,1] neg_lo:[0,1] neg_hi:[0,1]
  v_pk_fma_f32 v[142:143], v[26:27], v[22:23], v[142:143] op_sel:[0,1,0] neg_lo:[0,1,0] neg_hi:[0,1,0]
  v_pk_fma_f32 v[174:175], v[26:27], v[22:23], v[174:175] op_sel_hi:[1,0,1] neg_lo:[0,1,0] neg_hi:[0,1,0]
  v_cvt_pk_bf16_f32 v48, v128, v130
  v_cvt_pk_bf16_f32 v49, v132, v134
  v_cvt_pk_bf16_f32 v50, v136, v138
  buffer_load_dwordx4 a[180:183], v16, s[8:11], s41 offen offset:1024 sc1
  v_cvt_pk_bf16_f32 v51, v140, v142
  ds_write_b128 v10, v[48:51] offset:0
  v_cvt_pk_bf16_f32 v52, v129, v131
  v_cvt_pk_bf16_f32 v53, v133, v135
  v_cvt_pk_bf16_f32 v54, v137, v139
  v_cvt_pk_bf16_f32 v55, v141, v143
  ds_write_b128 v12, v[52:55] offset:0
  v_cvt_pk_bf16_f32 v56, v160, v162
  v_cvt_pk_bf16_f32 v57, v164, v166
  v_cvt_pk_bf16_f32 v58, v168, v170
  v_cvt_pk_bf16_f32 v59, v172, v174
  ds_write_b128 v10, v[56:59] offset:4096
  buffer_load_dwordx4 a[184:187], v16, s[8:11], s41 offen offset:2048 sc1
  v_cvt_pk_bf16_f32 v60, v161, v163
  v_cvt_pk_bf16_f32 v61, v165, v167
  v_cvt_pk_bf16_f32 v62, v169, v171
  v_cvt_pk_bf16_f32 v63, v173, v175
  ds_write_b128 v12, v[60:63] offset:4096
  v_pk_fma_f32 v[40:41], v[26:27], v[20:21], v[144:145] op_sel:[0,1,0] op_sel_hi:[1,1,1] neg_lo:[0,1,0] neg_hi:[0,1,0]
  v_pk_fma_f32 v[42:43], v[24:25], v[20:21], v[176:177] op_sel:[0,1,0] op_sel_hi:[1,1,1]
  v_pk_fma_f32 v[24:25], v[24:25], v[20:21], v[40:41] op_sel_hi:[1,0,1]
  v_pk_fma_f32 v[26:27], v[26:27], v[20:21], v[42:43] op_sel_hi:[1,0,1]
  v_pk_mul_f32 v[144:145], v[24:25], v[22:23] op_sel_hi:[1,0]
  v_pk_mul_f32 v[176:177], v[24:25], v[22:23] op_sel:[0,1] neg_lo:[0,1] neg_hi:[0,1]
  v_pk_fma_f32 v[144:145], v[26:27], v[22:23], v[144:145] op_sel:[0,1,0] neg_lo:[0,1,0] neg_hi:[0,1,0]
  buffer_load_dwordx4 a[188:191], v16, s[8:11], s41 offen offset:3072 sc1
  v_readlane_b32 s41, v13, 2
  s_nop 1
  s_lshl_b32 s41, s41, 2
  s_add_u32 s41, s41, s49
  v_pk_fma_f32 v[176:177], v[26:27], v[22:23], v[176:177] op_sel_hi:[1,0,1] neg_lo:[0,1,0] neg_hi:[0,1,0]
  v_pk_fma_f32 v[40:41], v[26:27], v[20:21], v[146:147] op_sel:[0,1,0] op_sel_hi:[1,1,1] neg_lo:[0,1,0] neg_hi:[0,1,0]
  v_pk_fma_f32 v[42:43], v[24:25], v[20:21], v[178:179] op_sel:[0,1,0] op_sel_hi:[1,1,1]
  v_pk_fma_f32 v[24:25], v[24:25], v[20:21], v[40:41] op_sel_hi:[1,0,1]
  v_pk_fma_f32 v[26:27], v[26:27], v[20:21], v[42:43] op_sel_hi:[1,0,1]
  v_pk_mul_f32 v[146:147], v[24:25], v[22:23] op_sel_hi:[1,0]
  v_pk_mul_f32 v[178:179], v[24:25], v[22:23] op_sel:[0,1] neg_lo:[0,1] neg_hi:[0,1]
  v_pk_fma_f32 v[146:147], v[26:27], v[22:23], v[146:147] op_sel:[0,1,0] neg_lo:[0,1,0] neg_hi:[0,1,0]
  v_pk_fma_f32 v[178:179], v[26:27], v[22:23], v[178:179] op_sel_hi:[1,0,1] neg_lo:[0,1,0] neg_hi:[0,1,0]
  v_pk_fma_f32 v[40:41], v[26:27], v[20:21], v[148:149] op_sel:[0,1,0] op_sel_hi:[1,1,1] neg_lo:[0,1,0] neg_hi:[0,1,0]
  v_pk_fma_f32 v[42:43], v[24:25], v[20:21], v[180:181] op_sel:[0,1,0] op_sel_hi:[1,1,1]
  v_pk_fma_f32 v[24:25], v[24:25], v[20:21], v[40:41] op_sel_hi:[1,0,1]
  buffer_load_dwordx4 a[192:195], v16, s[8:11], s42 offen offset:0 sc1
  v_pk_fma_f32 v[26:27], v[26:27], v[20:21], v[42:43] op_sel_hi:[1,0,1]
  v_pk_mul_f32 v[148:149], v[24:25], v[22:23] op_sel_hi:[1,0]
  v_pk_mul_f32 v[180:181], v[24:25], v[22:23] op_sel:[0,1] neg_lo:[0,1] neg_hi:[0,1]
  v_pk_fma_f32 v[148:149], v[26:27], v[22:23], v[148:149] op_sel:[0,1,0] neg_lo:[0,1,0] neg_hi:[0,1,0]
  v_pk_fma_f32 v[180:181], v[26:27], v[22:23], v[180:181] op_sel_hi:[1,0,1] neg_lo:[0,1,0] neg_hi:[0,1,0]
  v_pk_fma_f32 v[40:41], v[26:27], v[20:21], v[150:151] op_sel:[0,1,0] op_sel_hi:[1,1,1] neg_lo:[0,1,0] neg_hi:[0,1,0]
  v_pk_fma_f32 v[42:43], v[24:25], v[20:21], v[182:183] op_sel:[0,1,0] op_sel_hi:[1,1,1]
  v_pk_fma_f32 v[24:25], v[24:25], v[20:21], v[40:41] op_sel_hi:[1,0,1]
  v_pk_fma_f32 v[26:27], v[26:27], v[20:21], v[42:43] op_sel_hi:[1,0,1]
  v_pk_mul_f32 v[150:151], v[24:25], v[22:23] op_sel_hi:[1,0]
  v_pk_mul_f32 v[182:183], v[24:25], v[22:23] op_sel:[0,1] neg_lo:[0,1] neg_hi:[0,1]
  v_pk_fma_f32 v[150:151], v[26:27], v[22:23], v[150:151] op_sel:[0,1,0] neg_lo:[0,1,0] neg_hi:[0,1,0]
  buffer_load_dwordx4 a[196:199], v16, s[8:11], s42 offen offset:1024 sc1
  v_pk_fma_f32 v[182:183], v[26:27], v[22:23], v[182:183] op_sel_hi:[1,0,1] neg_lo:[0,1,0] neg_hi:[0,1,0]
  v_pk_fma_f32 v[40:41], v[26:27], v[20:21], v[152:153] op_sel:[0,1,0] op_sel_hi:[1,1,1] neg_lo:[0,1,0] neg_hi:[0,1,0]
  v_pk_fma_f32 v[42:43], v[24:25], v[20:21], v[184:185] op_sel:[0,1,0] op_sel_hi:[1,1,1]
  v_pk_fma_f32 v[24:25], v[24:25], v[20:21], v[40:41] op_sel_hi:[1,0,1]
  v_pk_fma_f32 v[26:27], v[26:27], v[20:21], v[42:43] op_sel_hi:[1,0,1]
  v_pk_mul_f32 v[152:153], v[24:25], v[22:23] op_sel_hi:[1,0]
  v_pk_mul_f32 v[184:185], v[24:25], v[22:23] op_sel:[0,1] neg_lo:[0,1] neg_hi:[0,1]
  v_pk_fma_f32 v[152:153], v[26:27], v[22:23], v[152:153] op_sel:[0,1,0] neg_lo:[0,1,0] neg_hi:[0,1,0]
  v_pk_fma_f32 v[184:185], v[26:27], v[22:23], v[184:185] op_sel_hi:[1,0,1] neg_lo:[0,1,0] neg_hi:[0,1,0]
  v_pk_fma_f32 v[40:41], v[26:27], v[20:21], v[154:155] op_sel:[0,1,0] op_sel_hi:[1,1,1] neg_lo:[0,1,0] neg_hi:[0,1,0]
  v_pk_fma_f32 v[42:43], v[24:25], v[20:21], v[186:187] op_sel:[0,1,0] op_sel_hi:[1,1,1]
  v_pk_fma_f32 v[24:25], v[24:25], v[20:21], v[40:41] op_sel_hi:[1,0,1]
  buffer_load_dwordx4 a[240:243], v16, s[8:11], s42 offen offset:2048 sc1
  v_pk_fma_f32 v[26:27], v[26:27], v[20:21], v[42:43] op_sel_hi:[1,0,1]
  v_pk_mul_f32 v[154:155], v[24:25], v[22:23] op_sel_hi:[1,0]
  v_pk_mul_f32 v[186:187], v[24:25], v[22:23] op_sel:[0,1] neg_lo:[0,1] neg_hi:[0,1]
  v_pk_fma_f32 v[154:155], v[26:27], v[22:23], v[154:155] op_sel:[0,1,0] neg_lo:[0,1,0] neg_hi:[0,1,0]
  v_pk_fma_f32 v[186:187], v[26:27], v[22:23], v[186:187] op_sel_hi:[1,0,1] neg_lo:[0,1,0] neg_hi:[0,1,0]
  v_pk_fma_f32 v[40:41], v[26:27], v[20:21], v[156:157] op_sel:[0,1,0] op_sel_hi:[1,1,1] neg_lo:[0,1,0] neg_hi:[0,1,0]
  v_pk_fma_f32 v[42:43], v[24:25], v[20:21], v[188:189] op_sel:[0,1,0] op_sel_hi:[1,1,1]
  v_pk_fma_f32 v[24:25], v[24:25], v[20:21], v[40:41] op_sel_hi:[1,0,1]
  v_pk_fma_f32 v[26:27], v[26:27], v[20:21], v[42:43] op_sel_hi:[1,0,1]
  v_pk_mul_f32 v[156:157], v[24:25], v[22:23] op_sel_hi:[1,0]
  v_pk_mul_f32 v[188:189], v[24:25], v[22:23] op_sel:[0,1] neg_lo:[0,1] neg_hi:[0,1]
  v_pk_fma_f32 v[156:157], v[26:27], v[22:23], v[156:157] op_sel:[0,1,0] neg_lo:[0,1,0] neg_hi:[0,1,0]
  buffer_load_dwordx4 a[244:247], v16, s[8:11], s42 offen offset:3072 sc1
  v_readlane_b32 s42, v13, 3
  s_nop 1
  s_lshl_b32 s42, s42, 2
  s_add_u32 s42, s42, s48
  v_pk_fma_f32 v[188:189], v[26:27], v[22:23], v[188:189] op_sel_hi:[1,0,1] neg_lo:[0,1,0] neg_hi:[0,1,0]
  v_pk_fma_f32 v[40:41], v[26:27], v[20:21], v[158:159] op_sel:[0,1,0] op_sel_hi:[1,1,1] neg_lo:[0,1,0] neg_hi:[0,1,0]
  v_pk_fma_f32 v[42:43], v[24:25], v[20:21], v[190:191] op_sel:[0,1,0] op_sel_hi:[1,1,1]
  v_pk_fma_f32 v[24:25], v[24:25], v[20:21], v[40:41] op_sel_hi:[1,0,1]
  v_pk_fma_f32 v[26:27], v[26:27], v[20:21], v[42:43] op_sel_hi:[1,0,1]
  v_pk_mul_f32 v[158:159], v[24:25], v[22:23] op_sel_hi:[1,0]
  v_pk_mul_f32 v[190:191], v[24:25], v[22:23] op_sel:[0,1] neg_lo:[0,1] neg_hi:[0,1]
  v_pk_fma_f32 v[158:159], v[26:27], v[22:23], v[158:159] op_sel:[0,1,0] neg_lo:[0,1,0] neg_hi:[0,1,0]
  v_pk_fma_f32 v[190:191], v[26:27], v[22:23], v[190:191] op_sel_hi:[1,0,1] neg_lo:[0,1,0] neg_hi:[0,1,0]
  v_cvt_pk_bf16_f32 v48, v144, v146
  v_cvt_pk_bf16_f32 v49, v148, v150
  v_cvt_pk_bf16_f32 v50, v152, v154
  buffer_load_dwordx4 a[248:251], v16, s[8:11], s43 offen offset:0 sc1
  v_cvt_pk_bf16_f32 v51, v156, v158
  ds_write_b128 v11, v[48:51] offset:0
  v_cvt_pk_bf16_f32 v52, v145, v147
  v_cvt_pk_bf16_f32 v53, v149, v151
  v_cvt_pk_bf16_f32 v54, v153, v155
  v_cvt_pk_bf16_f32 v55, v157, v159
  ds_write_b128 v15, v[52:55] offset:0
  v_cvt_pk_bf16_f32 v56, v176, v178
  v_cvt_pk_bf16_f32 v57, v180, v182
  v_cvt_pk_bf16_f32 v58, v184, v186
  v_cvt_pk_bf16_f32 v59, v188, v190
  ds_write_b128 v11, v[56:59] offset:4096
  buffer_load_dwordx4 a[252:255], v16, s[8:11], s43 offen offset:1024 sc1
  v_cvt_pk_bf16_f32 v60, v177, v179
  v_cvt_pk_bf16_f32 v61, v181, v183
  v_cvt_pk_bf16_f32 v62, v185, v187
  v_cvt_pk_bf16_f32 v63, v189, v191
  ds_write_b128 v15, v[60:63] offset:4096
  s_waitcnt lgkmcnt(0)
  ds_read_b64_tr_b16 v[160:161], v252 offset:0
  ds_read_b64_tr_b16 v[162:163], v254 offset:512
  ds_read_b64_tr_b16 v[164:165], v253 offset:0
  ds_read_b64_tr_b16 v[166:167], v255 offset:512
  ds_read_b64_tr_b16 v[168:169], v254 offset:0
  ds_read_b64_tr_b16 v[170:171], v252 offset:512
  ds_read_b64_tr_b16 v[172:173], v255 offset:0
  ds_read_b64_tr_b16 v[174:175], v253 offset:512
  ds_read_b64_tr_b16 v[176:177], v252 offset:4096
  ds_read_b64_tr_b16 v[178:179], v254 offset:4608
  ds_read_b64_tr_b16 v[180:181], v253 offset:4096
  ds_read_b64_tr_b16 v[182:183], v255 offset:4608
  ds_read_b64_tr_b16 v[184:185], v254 offset:4096
  ds_read_b64_tr_b16 v[186:187], v252 offset:4608
  ds_read_b64_tr_b16 v[188:189], v255 offset:4096
  ds_read_b64_tr_b16 v[190:191], v253 offset:4608
  s_waitcnt lgkmcnt(14)
  buffer_store_dwordx4 v[160:163], v14, s[12:15], s32 offen offset:0 sc1
  s_waitcnt lgkmcnt(12)
  buffer_store_dwordx4 v[164:167], v14, s[12:15], s32 offen offset:1024 sc1
  s_waitcnt lgkmcnt(10)
  buffer_store_dwordx4 v[168:171], v14, s[12:15], s32 offen offset:2048 sc1
  s_waitcnt lgkmcnt(8)
  buffer_store_dwordx4 v[172:175], v14, s[12:15], s32 offen offset:3072 sc1
  s_waitcnt lgkmcnt(6)
  buffer_store_dwordx4 v[176:179], v14, s[12:15], s33 offen offset:0 sc1
  s_waitcnt lgkmcnt(4)
  buffer_store_dwordx4 v[180:183], v14, s[12:15], s33 offen offset:1024 sc1
  s_waitcnt lgkmcnt(2)
  buffer_store_dwordx4 v[184:187], v14, s[12:15], s33 offen offset:2048 sc1
  s_waitcnt lgkmcnt(0)
  buffer_store_dwordx4 v[188:191], v14, s[12:15], s33 offen offset:3072 sc1
L_STAGE2:
  v_and_b32 v18, 15, v1
  v_lshlrev_b32 v18, 2, v18
  s_waitcnt lgkmcnt(0)
  s_add_u32 s3, s36, 720896
  buffer_load_dword v19, v18, s[64:67], s3 offen sc1
  s_waitcnt vmcnt(22)
  v_mfma_f32_16x16x32_bf16 v[64:67], a[0:3], a[160:163], 0
  s_mov_b32 s16, s6
  s_mov_b32 s17, s7
  s_mov_b32 s18, 2621440
  s_mov_b32 s20, s4
  s_mov_b32 s21, s5
  s_mov_b32 s22, 1280
  v_mfma_f32_16x16x32_bf16 v[68:71], a[4:7], a[160:163], 0
  buffer_load_dwordx4 v[224:227], v16, s[8:11], s43 offen offset:2048 sc1
  v_mfma_f32_16x16x32_bf16 v[72:75], a[8:11], a[160:163], 0
  v_mfma_f32_16x16x32_bf16 v[76:79], a[12:15], a[160:163], 0
  buffer_load_dwordx4 v[228:231], v16, s[8:11], s43 offen offset:3072 sc1
  v_readlane_b32 s43, v13, 4
  s_nop 1
  s_lshl_b32 s43, s43, 2
  s_add_u32 s43, s43, s48
  v_mfma_f32_16x16x32_bf16 v[80:83], a[16:19], a[160:163], 0
  s_waitcnt vmcnt(23)
  v_mfma_f32_16x16x32_bf16 v[84:87], a[0:3], a[164:167], 0
  s_mov_b32 s44, s34
  s_mov_b32 s45, s35
  s_mov_b32 s46, 5242880
  s_mov_b32 s47, 0x20000
  s_mov_b32 s31, 65536
  v_mfma_f32_16x16x32_bf16 v[88:91], a[4:7], a[164:167], 0
  buffer_load_dwordx4 v[232:235], v16, s[8:11], s40 offen offset:0 sc1
  v_mfma_f32_16x16x32_bf16 v[92:95], a[8:11], a[164:167], 0
  v_mfma_f32_16x16x32_bf16 v[96:99], a[12:15], a[164:167], 0
  buffer_load_dwordx4 v[236:239], v16, s[8:11], s40 offen offset:1024 sc1
  v_mfma_f32_16x16x32_bf16 v[100:103], a[16:19], a[164:167], 0
  s_cmp_lt_u32 s26, 11
  s_cbranch_scc0 L_P20
  v_readlane_b32 s99, v13, 11
  s_nop 3
  s_mul_i32 s99, s99, 5
L_P20:
  s_waitcnt vmcnt(24)
  v_mfma_f32_16x16x32_bf16 v[104:107], a[0:3], a[168:171], 0
  v_mfma_f32_16x16x32_bf16 v[108:111], a[4:7], a[168:171], 0
  buffer_load_dwordx4 v[240:243], v16, s[8:11], s40 offen offset:2048 sc1
  v_mfma_f32_16x16x32_bf16 v[112:115], a[8:11], a[168:171], 0
  s_lshl_b32 s3, s96, 1
  s_add_u32 s3, s3, s53
  s_lshl_b32 s52, s3, 6
  s_mul_i32 s51, s97, 80
  s_mov_b32 s50, 0xcccccccd
  v_mfma_f32_16x16x32_bf16 v[116:119], a[12:15], a[168:171], 0
  buffer_load_dwordx4 v[244:247], v16, s[8:11], s40 offen offset:3072 sc1
  v_readlane_b32 s40, v13, 10
  s_nop 1
  s_lshl_b32 s40, s40, 2
  s_add_u32 s40, s40, s48
  v_mfma_f32_16x16x32_bf16 v[120:123], a[16:19], a[168:171], 0
  s_cmp_lt_u32 s26, 11
  s_cbranch_scc0 L_P21
  buffer_load_dwordx4 a[220:223], v16, s[92:95], s99 offen offset:0 sc1
  v_readlane_b32 s100, v13, 5
L_P21:
  s_waitcnt vmcnt(25)
  v_mfma_f32_16x16x32_bf16 v[124:127], a[0:3], a[172:175], 0
  v_mfma_f32_16x16x32_bf16 v[128:131], a[4:7], a[172:175], 0
  buffer_load_dwordx4 v[248:251], v16, s[8:11], s41 offen offset:0 sc1
  v_mfma_f32_16x16x32_bf16 v[132:135], a[8:11], a[172:175], 0
  v_mfma_f32_16x16x32_bf16 v[136:139], a[12:15], a[172:175], 0
  buffer_load_dwordx4 v[252:255], v16, s[8:11], s41 offen offset:1024 sc1
  v_mfma_f32_16x16x32_bf16 v[140:143], a[16:19], a[172:175], 0
  s_cmp_lt_u32 s26, 11
  s_cbranch_scc0 L_P22
  buffer_load_dwordx4 a[224:227], v16, s[92:95], s99 offen offset:1024 sc1
L_P22:
  s_waitcnt vmcnt(26)
  v_mfma_f32_16x16x32_bf16 v[64:67], a[20:23], a[176:179], v[64:67]
  s_waitcnt vmcnt(8)
  s_barrier
  v_lshlrev_b32 v61, 3, v16
  v_mov_b32 v60, s60
  s_lshl_b32 s3, s25, 11
  s_lshl_b32 s54, s26, 2
  s_add_u32 s54, s54, s3
  s_add_u32 s54, s54, 32768
  s_cmp_eq_u32 s24, 0
  s_cselect_b32 s54, s54, 1073741824
  s_mov_b64 exec, 0xffff
  buffer_store_dword v60, v61, s[64:67], s54 offen sc1
  s_mov_b64 exec, -1
  v_mfma_f32_16x16x32_bf16 v[68:71], a[24:27], a[176:179], v[68:71]
  buffer_load_dwordx4 v[52:55], v16, s[8:11], s41 offen offset:2048 sc1
  v_mfma_f32_16x16x32_bf16 v[72:75], a[28:31], a[176:179], v[72:75]
  s_lshl_b32 s3, s24, 6
  v_add_u32 v14, s3, v1
  v_mfma_f32_16x16x32_bf16 v[76:79], a[32:35], a[176:179], v[76:79]
  buffer_load_dwordx4 v[56:59], v16, s[8:11], s41 offen offset:3072 sc1
  v_readlane_b32 s41, v13, 11
  s_nop 1
  s_lshl_b32 s41, s41, 2
  s_add_u32 s41, s41, s48
  v_mfma_f32_16x16x32_bf16 v[80:83], a[36:39], a[176:179], v[80:83]
  s_cmp_lt_u32 s26, 11
  s_cbranch_scc0 L_P23
  buffer_load_dwordx4 a[228:231], v16, s[92:95], s99 offen offset:2048 sc1
  s_mul_i32 s100, s100, 5
L_P23:
  v_mfma_f32_16x16x32_bf16 v[84:87], a[20:23], a[180:183], v[84:87]
  v_mfma_f32_16x16x32_bf16 v[88:91], a[24:27], a[180:183], v[88:91]
  v_and_b32 v12, 15, v1
  v_mfma_f32_16x16x32_bf16 v[92:95], a[28:31], a[180:183], v[92:95]
  v_bfe_u32 v20, v1, 1, 2
  v_lshrrev_b32 v21, 4, v1
  v_mfma_f32_16x16x32_bf16 v[96:99], a[32:35], a[180:183], v[96:99]
  v_xor_b32 v20, v20, v21
  v_mul_u32_u24 v12, 320, v12
  v_mfma_f32_16x16x32_bf16 v[100:103], a[36:39], a[180:183], v[100:103]
  s_cmp_lt_u32 s26, 11
  s_cbranch_scc0 L_P24
  buffer_load_dwordx4 a[232:235], v16, s[92:95], s99 offen offset:3072 sc1
L_P24:
  v_mfma_f32_16x16x32_bf16 v[104:107], a[20:23], a[184:187], v[104:107]
  v_lshl_add_u32 v12, v20, 4, v12
  s_mul_i32 s3, s24, 20480
  v_add_u32 v12, s3, v12
  v_mfma_f32_16x16x32_bf16 v[108:111], a[24:27], a[184:187], v[108:111]
  v_add_u32 v15, 81920, v12
  v_mov_b32 v17, 0
  v_mfma_f32_16x16x32_bf16 v[112:115], a[28:31], a[184:187], v[112:115]
  v_add_u32 v20, 0, v14
  v_mul_hi_u32 v21, s50, v20
  v_mfma_f32_16x16x32_bf16 v[116:119], a[32:35], a[184:187], v[116:119]
  v_lshrrev_b32 v21, 4, v21
  v_mul_u32_u24 v22, 20, v21
  v_mfma_f32_16x16x32_bf16 v[120:123], a[36:39], a[184:187], v[120:123]
  s_cmp_lt_u32 s26, 11
  s_cbranch_scc0 L_P25
  s_add_u32 s99, s99, 4096
  buffer_load_dwordx4 a[236:239], v16, s[92:95], s99 offen offset:0 sc1
L_P25:
  v_mfma_f32_16x16x32_bf16 v[124:127], a[20:23], a[188:191], v[124:127]
  v_sub_u32 v22, v20, v22
  v_mfma_f32_16x16x32_bf16 v[128:131], a[24:27], a[188:191], v[128:131]
  v_bfe_u32 v20, v21, 1, 2
  v_xor_b32 v20, v20, v22
  v_mfma_f32_16x16x32_bf16 v[132:135], a[28:31], a[188:191], v[132:135]
  v_mul_u32_u24 v7, 320, v21
  v_lshl_add_u32 v7, v20, 4, v7
  v_mfma_f32_16x16x32_bf16 v[136:139], a[32:35], a[188:191], v[136:139]
  v_add_u32 v21, s52, v21
  v_lshlrev_b32 v22, 2, v22
  v_mfma_f32_16x16x32_bf16 v[140:143], a[36:39], a[188:191], v[140:143]
  s_cmp_lt_u32 s26, 11
  s_cbranch_scc0 L_P26
  buffer_load_dwordx4 a[100:103], v16, s[92:95], s100 offen offset:0 sc1
  v_readlane_b32 s99, v13, 6
L_P26:
  v_mfma_f32_16x16x32_bf16 v[64:67], a[40:43], a[192:195], v[64:67]
  v_add_u32 v22, s51, v22
  v_mfma_f32_16x16x32_bf16 v[68:71], a[44:47], a[192:195], v[68:71]
  v_mul_u32_u24 v20, 640, v21
  v_add_u32 v20, v20, v22
  v_mfma_f32_16x16x32_bf16 v[72:75], a[48:51], a[192:195], v[72:75]
  v_lshlrev_b32 v2, 2, v20
  v_lshlrev_b32 v20, 1, v20
  v_mfma_f32_16x16x32_bf16 v[76:79], a[52:55], a[192:195], v[76:79]
  v_lshlrev_b32 v22, 1, v22
  v_lshlrev_b32 v21, 4, v21
  v_mfma_f32_16x16x32_bf16 v[80:83], a[56:59], a[192:195], v[80:83]
  s_cmp_lt_u32 s26, 11
  s_cbranch_scc0 L_P27
  buffer_load_dwordx4 a[104:107], v16, s[92:95], s100 offen offset:1024 sc1
L_P27:
  v_mfma_f32_16x16x32_bf16 v[84:87], a[40:43], a[196:199], v[84:87]
  buffer_load_dwordx2 v[32:33], v20, s[16:19], 0 offen
  v_mfma_f32_16x16x32_bf16 v[88:91], a[44:47], a[196:199], v[88:91]
  buffer_load_dwordx2 v[34:35], v22, s[20:23], 0 offen
  v_mfma_f32_16x16x32_bf16 v[92:95], a[48:51], a[196:199], v[92:95]
  buffer_load_dwordx2 v[0:1], v21, s[64:67], s31 offen sc1
  v_mfma_f32_16x16x32_bf16 v[96:99], a[52:55], a[196:199], v[96:99]
  v_add_u32 v20, 256, v14
  v_mul_hi_u32 v21, s50, v20
  v_mfma_f32_16x16x32_bf16 v[100:103], a[56:59], a[196:199], v[100:103]
  s_cmp_lt_u32 s26, 11
  s_cbranch_scc0 L_P28
  buffer_load_dwordx4 a[108:111], v16, s[92:95], s100 offen offset:2048 sc1
  s_mul_i32 s99, s99, 5
L_P28:
  v_mfma_f32_16x16x32_bf16 v[104:107], a[40:43], a[240:243], v[104:107]
  v_lshrrev_b32 v21, 4, v21
  v_mfma_f32_16x16x32_bf16 v[108:111], a[44:47], a[240:243], v[108:111]
  v_mul_u32_u24 v22, 20, v21
  v_sub_u32 v22, v20, v22
  v_mfma_f32_16x16x32_bf16 v[112:115], a[48:51], a[240:243], v[112:115]
  v_bfe_u32 v20, v21, 1, 2
  v_xor_b32 v20, v20, v22
  v_mfma_f32_16x16x32_bf16 v[116:119], a[52:55], a[240:243], v[116:119]
  v_mul_u32_u24 v8, 320, v21
  v_lshl_add_u32 v8, v20, 4, v8
  v_mfma_f32_16x16x32_bf16 v[120:123], a[56:59], a[240:243], v[120:123]
  s_cmp_lt_u32 s26, 11
  s_cbranch_scc0 L_P29
  buffer_load_dwordx4 a[112:115], v16, s[92:95], s100 offen offset:3072 sc1
L_P29:
  v_mfma_f32_16x16x32_bf16 v[124:127], a[40:43], a[244:247], v[124:127]
  v_add_u32 v21, s52, v21
  v_lshlrev_b32 v22, 2, v22
  v_mfma_f32_16x16x32_bf16 v[128:131], a[44:47], a[244:247], v[128:131]
  v_add_u32 v22, s51, v22
  v_mul_u32_u24 v20, 640, v21
  v_mfma_f32_16x16x32_bf16 v[132:135], a[48:51], a[244:247], v[132:135]
  v_add_u32 v20, v20, v22
  v_lshlrev_b32 v3, 2, v20
  v_mfma_f32_16x16x32_bf16 v[136:139], a[52:55], a[244:247], v[136:139]
  v_lshlrev_b32 v20, 1, v20
  v_lshlrev_b32 v22, 1, v22
  v_mfma_f32_16x16x32_bf16 v[140:143], a[56:59], a[244:247], v[140:143]
  s_cmp_lt_u32 s26, 11
  s_cbranch_scc0 L_P30
  s_add_u32 s100, s100, 4096
  buffer_load_dwordx4 a[116:119], v16, s[92:95], s100 offen offset:0 sc1
L_P30:
  v_mfma_f32_16x16x32_bf16 v[144:147], a[0:3], a[248:251], 0
  s_cmp_lg_u32 s24, 0
  s_cbranch_scc1 L_W31
  s_mov_b32 s62, 0
L_CHK32:
  v_cmp_ne_u32 vcc, s60, v19
  s_and_b64 vcc, vcc, 0x7ff
  s_cbranch_vccz L_OK32
  s_add_u32 s62, s62, 1
  s_cmp_lt_u32 s62, 0x40000
  s_cbranch_scc0 L_OK32
  s_sleep 12
  s_add_u32 s3, s36, 720896
  buffer_load_dword v19, v18, s[64:67], s3 offen sc1
  s_waitcnt vmcnt(0)
  s_branch L_CHK32
L_OK32:
L_W31:
  s_barrier
  v_mfma_f32_16x16x32_bf16 v[148:151], a[4:7], a[248:251], 0
  buffer_load_dwordx4 a[240:243], v16, s[8:11], s42 offen offset:0 sc1
  v_mfma_f32_16x16x32_bf16 v[152:155], a[8:11], a[248:251], 0
  v_lshlrev_b32 v21, 4, v21
  buffer_load_dwordx2 v[36:37], v20, s[16:19], 0 offen
  v_mfma_f32_16x16x32_bf16 v[156:159], a[12:15], a[248:251], 0
  buffer_load_dwordx4 a[244:247], v16, s[8:11], s42 offen offset:1024 sc1
  v_mfma_f32_16x16x32_bf16 v[160:163], a[16:19], a[248:251], 0
  s_cmp_lt_u32 s26, 11
  s_cbranch_scc0 L_P33
  buffer_load_dwordx4 a[120:123], v16, s[92:95], s99 offen offset:0 sc1
  v_readlane_b32 s100, v13, 7
L_P33:
  v_mfma_f32_16x16x32_bf16 v[164:167], a[0:3], a[252:255], 0
  s_add_u32 s3, s36, 0
  buffer_load_dword v19, v18, s[64:67], s3 offen sc1
  v_mfma_f32_16x16x32_bf16 v[168:171], a[4:7], a[252:255], 0
  buffer_load_dwordx4 a[248:251], v16, s[8:11], s42 offen offset:2048 sc1
  v_mfma_f32_16x16x32_bf16 v[172:175], a[8:11], a[252:255], 0
  buffer_load_dwordx2 v[38:39], v22, s[20:23], 0 offen
  v_mfma_f32_16x16x32_bf16 v[176:179], a[12:15], a[252:255], 0
  buffer_load_dwordx2 v[24:25], v21, s[64:67], s31 offen sc1
  v_mfma_f32_16x16x32_bf16 v[180:183], a[16:19], a[252:255], 0
  s_cmp_lt_u32 s26, 11
  s_cbranch_scc0 L_P34
  buffer_load_dwordx4 a[124:127], v16, s[92:95], s99 offen offset:1024 sc1
L_P34:
  s_waitcnt vmcnt(20)
  v_mfma_f32_16x16x32_bf16 v[184:187], a[0:3], v[224:227], 0
  v_add_u32 v20, 512, v14
  v_mul_hi_u32 v21, s50, v20
  v_mfma_f32_16x16x32_bf16 v[188:191], a[4:7], v[224:227], 0
  buffer_load_dwordx4 a[252:255], v16, s[8:11], s42 offen offset:3072 sc1
  v_readlane_b32 s42, v13, 5
  s_nop 1
  s_lshl_b32 s42, s42, 2
  s_add_u32 s42, s42, s48
  v_mfma_f32_16x16x32_bf16 v[192:195], a[8:11], v[224:227], 0
  v_mfma_f32_16x16x32_bf16 v[196:199], a[12:15], v[224:227], 0
  v_lshrrev_b32 v21, 4, v21
  v_mul_u32_u24 v22, 20, v21
  v_mfma_f32_16x16x32_bf16 v[200:203], a[16:19], v[224:227], 0
  s_cmp_lt_u32 s26, 11
  s_cbranch_scc0 L_P35
  buffer_load_dwordx4 a[128:131], v16, s[92:95], s99 offen offset:2048 sc1
  s_mul_i32 s100, s100, 5
L_P35:
  s_waitcnt vmcnt(20)
  v_mfma_f32_16x16x32_bf16 v[204:207], a[0:3], v[228:231], 0
  v_sub_u32 v22, v20, v22
  v_mfma_f32_16x16x32_bf16 v[208:211], a[4:7], v[228:231], 0
  buffer_load_dwordx4 v[224:227], v16, s[8:11], s43 offen offset:0 sc1
  v_mfma_f32_16x16x32_bf16 v[212:215], a[8:11], v[228:231], 0
  v_bfe_u32 v20, v21, 1, 2
  v_xor_b32 v20, v20, v22
  v_mfma_f32_16x16x32_bf16 v[216:219], a[12:15], v[228:231], 0
  v_mul_u32_u24 v9, 320, v21
  v_lshl_add_u32 v9, v20, 4, v9
  v_mfma_f32_16x16x32_bf16 v[220:223], a[16:19], v[228:231], 0
  s_cmp_lt_u32 s26, 11
  s_cbranch_scc0 L_P36
  buffer_load_dwordx4 a[132:135], v16, s[92:95], s99 offen offset:3072 sc1
L_P36:
  s_waitcnt vmcnt(20)
  v_mfma_f32_16x16x32_bf16 v[144:147], a[20:23], v[232:235], v[144:147]
  v_add_u32 v21, s52, v21
  v_lshlrev_b32 v22, 2, v22
  v_mfma_f32_16x16x32_bf16 v[148:151], a[24:27], v[232:235], v[148:151]
  buffer_load_dwordx4 a[0:3], v16, s[8:11], s43 offen offset:1024 sc1
  v_mfma_f32_16x16x32_bf16 v[152:155], a[28:31], v[232:235], v[152:155]
  v_add_u32 v22, s51, v22
  v_mul_u32_u24 v20, 640, v21
  v_mfma_f32_16x16x32_bf16 v[156:159], a[32:35], v[232:235], v[156:159]
  buffer_load_dwordx4 a[4:7], v16, s[8:11], s43 offen offset:2048 sc1
  v_mfma_f32_16x16x32_bf16 v[160:163], a[36:39], v[232:235], v[160:163]
  s_cmp_lt_u32 s26, 11
  s_cbranch_scc0 L_P37
  s_add_u32 s99, s99, 4096
  buffer_load_dwordx4 a[136:139], v16, s[92:95], s99 offen offset:0 sc1
L_P37:
  s_waitcnt vmcnt(21)
  v_mfma_f32_16x16x32_bf16 v[164:167], a[20:23], v[236:239], v[164:167]
  v_add_u32 v20, v20, v22
  v_mfma_f32_16x16x32_bf16 v[168:171], a[24:27], v[236:239], v[168:171]
  buffer_load_dwordx4 a[8:11], v16, s[8:11], s43 offen offset:3072 sc1
  v_readlane_b32 s43, v13, 6
  s_nop 1
  s_lshl_b32 s43, s43, 2
  s_add_u32 s43, s43, s48
  v_mfma_f32_16x16x32_bf16 v[172:175], a[28:31], v[236:239], v[172:175]
  v_mfma_f32_16x16x32_bf16 v[176:179], a[32:35], v[236:239], v[176:179]
  v_lshlrev_b32 v4, 2, v20
  v_lshlrev_b32 v20, 1, v20
  v_mfma_f32_16x16x32_bf16 v[180:183], a[36:39], v[236:239], v[180:183]
  s_cmp_lt_u32 s26, 11
  s_cbranch_scc0 L_P38
  buffer_load_dwordx4 a[140:143], v16, s[92:95], s100 offen offset:0 sc1
L_P38:
  s_waitcnt vmcnt(21)
  v_mfma_f32_16x16x32_bf16 v[184:187], a[20:23], v[240:243], v[184:187]
  v_lshlrev_b32 v22, 1, v22
  v_lshlrev_b32 v21, 4, v21
  v_mfma_f32_16x16x32_bf16 v[188:191], a[24:27], v[240:243], v[188:191]
  buffer_load_dwordx2 v[40:41], v20, s[16:19], 0 offen
  v_mfma_f32_16x16x32_bf16 v[192:195], a[28:31], v[240:243], v[192:195]
  buffer_load_dwordx2 v[42:43], v22, s[20:23], 0 offen
  v_mfma_f32_16x16x32_bf16 v[196:199], a[32:35], v[240:243], v[196:199]
  buffer_load_dwordx2 v[26:27], v21, s[64:67], s31 offen sc1
  v_mfma_f32_16x16x32_bf16 v[200:203], a[36:39], v[240:243], v[200:203]
  s_cmp_lt_u32 s26, 11
  s_cbranch_scc0 L_P39
  buffer_load_dwordx4 a[144:147], v16, s[92:95], s100 offen offset:1024 sc1
L_P39:
  s_waitcnt vmcnt(23)
  v_mfma_f32_16x16x32_bf16 v[204:207], a[20:23], v[244:247], v[204:207]
  v_add_u32 v20, 768, v14
  v_mul_hi_u32 v21, s50, v20
  v_mfma_f32_16x16x32_bf16 v[208:211], a[24:27], v[244:247], v[208:211]
  v_lshrrev_b32 v21, 4, v21
  v_mul_u32_u24 v22, 20, v21
  v_mfma_f32_16x16x32_bf16 v[212:215], a[28:31], v[244:247], v[212:215]
  v_sub_u32 v22, v20, v22
  v_bfe_u32 v20, v21, 1, 2
  v_mfma_f32_16x16x32_bf16 v[216:219], a[32:35], v[244:247], v[216:219]
  v_xor_b32 v20, v20, v22
  v_mul_u32_u24 v10, 320, v21
  v_mfma_f32_16x16x32_bf16 v[220:223], a[36:39], v[244:247], v[220:223]
  s_cmp_lt_u32 s26, 11
  s_cbranch_scc0 L_P40
  buffer_load_dwordx4 a[148:151], v16, s[92:95], s100 offen offset:2048 sc1
L_P40:
  s_waitcnt vmcnt(22)
  v_mfma_f32_16x16x32_bf16 v[144:147], a[40:43], v[248:251], v[144:147]
  s_cmp_lg_u32 s24, 0
  s_cbranch_scc1 L_W41
  s_waitcnt vmcnt(11)
  s_mov_b32 s62, 0
L_CHK42:
  v_cmp_ne_u32 vcc, s60, v19
  s_and_b64 vcc, vcc, 0x7ff
  s_cbranch_vccz L_OK42
  s_add_u32 s62, s62, 1
  s_cmp_lt_u32 s62, 0x40000
  s_cbranch_scc0 L_OK42
  s_sleep 12
  s_add_u32 s3, s36, 0
  buffer_load_dword v19, v18, s[64:67], s3 offen sc1
  s_waitcnt vmcnt(0)
  s_branch L_CHK42
L_OK42:
L_W41:
  s_barrier
  v_mfma_f32_16x16x32_bf16 v[148:151], a[44:47], v[248:251], v[148:151]
  buffer_load_dwordx4 a[12:15], v16, s[8:11], s40 offen offset:0 sc1
  v_mfma_f32_16x16x32_bf16 v[152:155], a[48:51], v[248:251], v[152:155]
  v_lshl_add_u32 v10, v20, 4, v10
  v_add_u32 v21, s52, v21
  v_mfma_f32_16x16x32_bf16 v[156:159], a[52:55], v[248:251], v[156:159]
  buffer_load_dwordx4 a[16:19], v16, s[8:11], s40 offen offset:1024 sc1
  v_mfma_f32_16x16x32_bf16 v[160:163], a[56:59], v[248:251], v[160:163]
  s_cmp_lt_u32 s26, 11
  s_cbranch_scc0 L_P43
  buffer_load_dwordx4 a[152:155], v16, s[92:95], s100 offen offset:3072 sc1
L_P43:
  s_waitcnt vmcnt(23)
  v_mfma_f32_16x16x32_bf16 v[164:167], a[40:43], v[252:255], v[164:167]
  s_add_u32 s3, s36, 0
  buffer_load_dword v19, v18, s[64:67], s3 offen sc1
  v_mfma_f32_16x16x32_bf16 v[168:171], a[44:47], v[252:255], v[168:171]
  buffer_load_dwordx4 v[228:231], v16, s[8:11], s40 offen offset:2048 sc1
  v_mfma_f32_16x16x32_bf16 v[172:175], a[48:51], v[252:255], v[172:175]
  v_lshlrev_b32 v22, 2, v22
  v_add_u32 v22, s51, v22
  v_mfma_f32_16x16x32_bf16 v[176:179], a[52:55], v[252:255], v[176:179]
  buffer_load_dwordx4 v[232:235], v16, s[8:11], s40 offen offset:3072 sc1
  v_readlane_b32 s40, v13, 7
  s_nop 1
  s_lshl_b32 s40, s40, 2
  s_add_u32 s40, s40, s48
  v_mfma_f32_16x16x32_bf16 v[180:183], a[56:59], v[252:255], v[180:183]
  s_cmp_lt_u32 s26, 11
  s_cbranch_scc0 L_P44
  s_add_u32 s100, s100, 4096
  buffer_load_dwordx4 a[156:159], v16, s[92:95], s100 offen offset:0 sc1
L_P44:
  s_waitcnt vmcnt(24)
  v_mfma_f32_16x16x32_bf16 v[184:187], a[40:43], v[52:55], v[184:187]
  v_mfma_f32_16x16x32_bf16 v[188:191], a[44:47], v[52:55], v[188:191]
  buffer_load_dwordx4 v[236:239], v16, s[8:11], s41 offen offset:0 sc1
  v_mfma_f32_16x16x32_bf16 v[192:195], a[48:51], v[52:55], v[192:195]
  v_mul_u32_u24 v20, 640, v21
  v_mfma_f32_16x16x32_bf16 v[196:199], a[52:55], v[52:55], v[196:199]
  buffer_load_dwordx4 v[240:243], v16, s[8:11], s41 offen offset:1024 sc1
  v_mfma_f32_16x16x32_bf16 v[200:203], a[56:59], v[52:55], v[200:203]
  v_readlane_b32 s99, v13, 8
  s_nop 3
  s_mul_i32 s99, s99, 5
  s_waitcnt vmcnt(25)
  v_mfma_f32_16x16x32_bf16 v[204:207], a[40:43], v[56:59], v[204:207]
  v_mfma_f32_16x16x32_bf16 v[208:211], a[44:47], v[56:59], v[208:211]
  buffer_load_dwordx4 a[20:23], v16, s[8:11], s41 offen offset:2048 sc1
  v_mfma_f32_16x16x32_bf16 v[212:215], a[48:51], v[56:59], v[212:215]
  v_add_u32 v20, v20, v22
  v_lshlrev_b32 v5, 2, v20
  v_mfma_f32_16x16x32_bf16 v[216:219], a[52:55], v[56:59], v[216:219]
  buffer_load_dwordx4 a[24:27], v16, s[8:11], s41 offen offset:3072 sc1
  v_readlane_b32 s41, v13, 8
  s_nop 1
  s_lshl_b32 s41, s41, 2
  s_add_u32 s41, s41, s48
  v_mfma_f32_16x16x32_bf16 v[220:223], a[56:59], v[56:59], v[220:223]
  buffer_load_dwordx4 a[160:163], v16, s[92:95], s99 offen offset:0 sc1
  v_readlane_b32 s100, v13, 9
  s_waitcnt vmcnt(24)
  v_mfma_f32_16x16x32_bf16 v[64:67], a[60:63], a[240:243], v[64:67]
  v_mfma_f32_16x16x32_bf16 v[68:71], a[64:67], a[240:243], v[68:71]
  v_lshlrev_b32 v20, 1, v20
  v_mfma_f32_16x16x32_bf16 v[72:75], a[68:71], a[240:243], v[72:75]
  v_lshlrev_b32 v22, 1, v22
  v_lshlrev_b32 v21, 4, v21
  v_mfma_f32_16x16x32_bf16 v[76:79], a[72:75], a[240:243], v[76:79]
  buffer_load_dwordx2 v[44:45], v20, s[16:19], 0 offen
  v_mfma_f32_16x16x32_bf16 v[80:83], a[76:79], a[240:243], v[80:83]
  buffer_load_dwordx4 a[164:167], v16, s[92:95], s99 offen offset:1024 sc1
  s_waitcnt vmcnt(24)
  v_mfma_f32_16x16x32_bf16 v[84:87], a[60:63], a[244:247], v[84:87]
  buffer_load_dwordx2 v[46:47], v22, s[20:23], 0 offen
  v_mfma_f32_16x16x32_bf16 v[88:91], a[64:67], a[244:247], v[88:91]
  buffer_load_dwordx2 v[28:29], v21, s[64:67], s31 offen sc1
  v_mfma_f32_16x16x32_bf16 v[92:95], a[68:71], a[244:247], v[92:95]
  v_add_u32 v20, 1024, v14
  v_mul_hi_u32 v21, s50, v20
  v_mfma_f32_16x16x32_bf16 v[96:99], a[72:75], a[244:247], v[96:99]
  v_lshrrev_b32 v21, 4, v21
  v_mul_u32_u24 v22, 20, v21
  v_mfma_f32_16x16x32_bf16 v[100:103], a[76:79], a[244:247], v[100:103]
  buffer_load_dwordx4 a[168:171], v16, s[92:95], s99 offen offset:2048 sc1
  s_mul_i32 s100, s100, 5
  s_waitcnt vmcnt(25)
  v_mfma_f32_16x16x32_bf16 v[104:107], a[60:63], a[248:251], v[104:107]
  v_sub_u32 v22, v20, v22
  v_mfma_f32_16x16x32_bf16 v[108:111], a[64:67], a[248:251], v[108:111]
  v_bfe_u32 v20, v21, 1, 2
  v_xor_b32 v20, v20, v22
  v_mfma_f32_16x16x32_bf16 v[112:115], a[68:71], a[248:251], v[112:115]
  v_mul_u32_u24 v11, 320, v21
  v_lshl_add_u32 v11, v20, 4, v11
  v_mfma_f32_16x16x32_bf16 v[116:119], a[72:75], a[248:251], v[116:119]
  v_add_u32 v21, s52, v21
  v_lshlrev_b32 v22, 2, v22
  v_mfma_f32_16x16x32_bf16 v[120:123], a[76:79], a[248:251], v[120:123]
  buffer_load_dwordx4 a[172:175], v16, s[92:95], s99 offen offset:3072 sc1
  s_waitcnt vmcnt(23)
  v_mfma_f32_16x16x32_bf16 v[124:127], a[60:63], a[252:255], v[124:127]
  v_add_u32 v22, s51, v22
  v_mul_u32_u24 v20, 640, v21
  v_mfma_f32_16x16x32_bf16 v[128:131], a[64:67], a[252:255], v[128:131]
  v_add_u32 v20, v20, v22
  v_lshlrev_b32 v6, 2, v20
  v_mfma_f32_16x16x32_bf16 v[132:135], a[68:71], a[252:255], v[132:135]
  v_lshlrev_b32 v20, 1, v20
  v_lshlrev_b32 v22, 1, v22
  v_mfma_f32_16x16x32_bf16 v[136:139], a[72:75], a[252:255], v[136:139]
  v_lshlrev_b32 v21, 4, v21
  buffer_load_dwordx2 v[48:49], v20, s[16:19], 0 offen
  v_mfma_f32_16x16x32_bf16 v[140:143], a[76:79], a[252:255], v[140:143]
  s_add_u32 s99, s99, 4096
  buffer_load_dwordx4 a[176:179], v16, s[92:95], s99 offen offset:0 sc1
  s_waitcnt vmcnt(24)
  v_mfma_f32_16x16x32_bf16 v[64:67], a[80:83], v[224:227], v[64:67]
  buffer_load_dwordx2 v[50:51], v22, s[20:23], 0 offen
  v_mfma_f32_16x16x32_bf16 v[68:71], a[84:87], v[224:227], v[68:71]
  buffer_load_dwordx2 v[30:31], v21, s[64:67], s31 offen sc1
  v_mfma_f32_16x16x32_bf16 v[72:75], a[88:91], v[224:227], v[72:75]
  v_lshlrev_b32 v14, 4, v14
  s_mul_i32 s3, s57, 40960
  s_add_u32 s3, s3, 19922944
  s_add_u32 s12, s38, s3
  s_addc_u32 s13, s39, 0
  s_mov_b32 s14, 40960
  s_mul_i32 s33, s53, 20480
  s_sub_u32 s32, 20480, s33
  v_mfma_f32_16x16x32_bf16 v[76:79], a[92:95], v[224:227], v[76:79]
  v_mfma_f32_16x16x32_bf16 v[80:83], a[96:99], v[224:227], v[80:83]
  buffer_load_dwordx4 a[180:183], v16, s[92:95], s100 offen offset:0 sc1
  s_waitcnt vmcnt(26)
  v_mfma_f32_16x16x32_bf16 v[84:87], a[80:83], a[0:3], v[84:87]
  v_mfma_f32_16x16x32_bf16 v[88:91], a[84:87], a[0:3], v[88:91]
  s_lshl_b32 s3, s57, 1
  s_add_u32 s3, s3, s53
  s_lshl_b32 s3, s3, 2
  s_add_u32 s3, s3, s24
  s_lshl_b32 s3, s3, 7
  s_add_u32 s56, s3, 589824
  s_xor_b32 s57, s56, 512
  v_mfma_f32_16x16x32_bf16 v[92:95], a[88:91], a[0:3], v[92:95]
  v_mfma_f32_16x16x32_bf16 v[96:99], a[92:95], a[0:3], v[96:99]
  s_waitcnt vmcnt(1)
  v_mfma_f32_16x16x32_bf16 v[100:103], a[96:99], a[0:3], v[100:103]
  buffer_load_dwordx4 a[184:187], v16, s[92:95], s100 offen offset:1024 sc1
  v_mfma_f32_16x16x32_bf16 v[104:107], a[80:83], a[4:7], v[104:107]
  s_cmp_lg_u32 s24, 0
  s_cbranch_scc1 L_W45
  s_mov_b32 s62, 0
L_CHK46:
  v_cmp_ne_u32 vcc, s60, v19
  s_cbranch_vccz L_OK46
  s_add_u32 s62, s62, 1
  s_cmp_lt_u32 s62, 0x40000
  s_cbranch_scc0 L_OK46
  s_sleep 12
  s_add_u32 s3, s36, 0
  buffer_load_dword v19, v18, s[64:67], s3 offen sc1
  s_waitcnt vmcnt(0)
  s_branch L_CHK46
L_OK46:
L_W45:
  s_barrier
  v_mfma_f32_16x16x32_bf16 v[108:111], a[84:87], a[4:7], v[108:111]
  buffer_load_dwordx4 a[28:31], v16, s[8:11], s42 offen offset:0 sc1
  v_mfma_f32_16x16x32_bf16 v[112:115], a[88:91], a[4:7], v[112:115]
  v_rcp_f32 v1, v1
  v_mfma_f32_16x16x32_bf16 v[116:119], a[92:95], a[4:7], v[116:119]
  buffer_load_dwordx4 a[32:35], v16, s[8:11], s42 offen offset:1024 sc1
  v_mfma_f32_16x16x32_bf16 v[120:123], a[96:99], a[4:7], v[120:123]
  buffer_load_dwordx4 a[188:191], v16, s[92:95], s100 offen offset:2048 sc1
  v_mfma_f32_16x16x32_bf16 v[124:127], a[80:83], a[8:11], v[124:127]
  v_lshlrev_b32 v20, 16, v32
  v_and_b32 v21, 0xffff0000, v32
  v_mfma_f32_16x16x32_bf16 v[128:131], a[84:87], a[8:11], v[128:131]
  buffer_load_dwordx4 a[36:39], v16, s[8:11], s42 offen offset:2048 sc1
  v_mfma_f32_16x16x32_bf16 v[132:135], a[88:91], a[8:11], v[132:135]
  v_sub_f32 v20, v20, v0
  v_sub_f32 v21, v21, v0
  v_mfma_f32_16x16x32_bf16 v[136:139], a[92:95], a[8:11], v[136:139]
  buffer_load_dwordx4 v[244:247], v16, s[8:11], s42 offen offset:3072 sc1
  v_readlane_b32 s42, v13, 9
  s_nop 1
  s_lshl_b32 s42, s42, 2
  s_add_u32 s42, s42, s48
  v_mfma_f32_16x16x32_bf16 v[140:143], a[96:99], a[8:11], v[140:143]
  buffer_load_dwordx4 a[192:195], v16, s[92:95], s100 offen offset:3072 sc1
  v_mfma_f32_16x16x32_bf16 v[64:67], a[200:203], a[12:15], v[64:67]
  v_mfma_f32_16x16x32_bf16 v[68:71], a[204:207], a[12:15], v[68:71]
  buffer_load_dwordx4 v[248:251], v16, s[8:11], s43 offen offset:0 sc1
  v_mfma_f32_16x16x32_bf16 v[72:75], a[208:211], a[12:15], v[72:75]
  v_mfma_f32_16x16x32_bf16 v[76:79], a[212:215], a[12:15], v[76:79]
  buffer_load_dwordx4 v[252:255], v16, s[8:11], s43 offen offset:1024 sc1
  v_mfma_f32_16x16x32_bf16 v[80:83], a[216:219], a[12:15], v[80:83]
  s_add_u32 s100, s100, 4096
  buffer_load_dwordx4 a[196:199], v16, s[92:95], s100 offen offset:0 sc1
  v_mfma_f32_16x16x32_bf16 v[84:87], a[200:203], a[16:19], v[84:87]
  v_mfma_f32_16x16x32_bf16 v[88:91], a[204:207], a[16:19], v[88:91]
  buffer_load_dwordx4 v[52:55], v16, s[8:11], s43 offen offset:2048 sc1
  v_mfma_f32_16x16x32_bf16 v[92:95], a[208:211], a[16:19], v[92:95]
  v_cvt_pk_bf16_f32 v20, v20, v21
  v_and_b32 v21, 0xffff0000, v20
  v_mfma_f32_16x16x32_bf16 v[96:99], a[212:215], a[16:19], v[96:99]
  buffer_load_dwordx4 a[40:43], v16, s[8:11], s43 offen offset:3072 sc1
  v_readlane_b32 s43, v13, 3
  s_nop 1
  s_lshl_b32 s43, s43, 2
  s_add_u32 s43, s43, s49
  v_mfma_f32_16x16x32_bf16 v[100:103], a[216:219], a[16:19], v[100:103]
  v_mfma_f32_16x16x32_bf16 v[104:107], a[200:203], v[228:231], v[104:107]
  v_mfma_f32_16x16x32_bf16 v[108:111], a[204:207], v[228:231], v[108:111]
  buffer_load_dwordx4 a[44:47], v16, s[8:11], s40 offen offset:0 sc1
  v_mfma_f32_16x16x32_bf16 v[112:115], a[208:211], v[228:231], v[112:115]
  v_lshlrev_b32 v20, 16, v20
  v_mfma_f32_16x16x32_bf16 v[116:119], a[212:215], v[228:231], v[116:119]
  buffer_load_dwordx4 a[48:51], v16, s[8:11], s41 offen offset:0 sc1
  v_mfma_f32_16x16x32_bf16 v[120:123], a[216:219], v[228:231], v[120:123]
  v_mul_f32 v20, v20, v1
  v_mfma_f32_16x16x32_bf16 v[124:127], a[200:203], v[232:235], v[124:127]
  v_mul_f32 v21, v21, v1
  v_cvt_pk_bf16_f32 v20, v20, v21
  v_mfma_f32_16x16x32_bf16 v[128:131], a[204:207], v[232:235], v[128:131]
  buffer_load_dwordx4 a[52:55], v16, s[8:11], s42 offen offset:0 sc1
  v_mfma_f32_16x16x32_bf16 v[132:135], a[208:211], v[232:235], v[132:135]
  v_and_b32 v21, 0xffff0000, v20
  v_lshlrev_b32 v20, 16, v20
  v_mfma_f32_16x16x32_bf16 v[136:139], a[212:215], v[232:235], v[136:139]
  buffer_load_dwordx4 a[56:59], v16, s[8:11], s40 offen offset:1024 sc1
  v_mfma_f32_16x16x32_bf16 v[140:143], a[216:219], v[232:235], v[140:143]
  v_lshlrev_b32 v22, 16, v34
  v_mfma_f32_16x16x32_bf16 v[64:67], a[220:223], v[236:239], v[64:67]
  v_and_b32 v23, 0xffff0000, v34
  v_mul_f32 v20, v20, v22
  v_mfma_f32_16x16x32_bf16 v[68:71], a[224:227], v[236:239], v[68:71]
  buffer_load_dwordx4 v[56:59], v16, s[8:11], s41 offen offset:1024 sc1
  v_mfma_f32_16x16x32_bf16 v[72:75], a[228:231], v[236:239], v[72:75]
  v_mul_f32 v21, v21, v23
  v_cvt_pk_bf16_f32 v20, v20, v21
  v_mfma_f32_16x16x32_bf16 v[76:79], a[232:235], v[236:239], v[76:79]
  buffer_load_dwordx4 a[240:243], v16, s[8:11], s42 offen offset:1024 sc1
  v_mfma_f32_16x16x32_bf16 v[80:83], a[236:239], v[236:239], v[80:83]
  v_and_b32 v21, 0xffff0000, v20
  v_mfma_f32_16x16x32_bf16 v[84:87], a[220:223], v[240:243], v[84:87]
  v_lshlrev_b32 v20, 16, v20
  v_lshlrev_b32 v22, 16, v32
  v_mfma_f32_16x16x32_bf16 v[88:91], a[224:227], v[240:243], v[88:91]
  buffer_load_dwordx4 a[244:247], v16, s[8:11], s40 offen offset:2048 sc1
  v_mfma_f32_16x16x32_bf16 v[92:95], a[228:231], v[240:243], v[92:95]
  v_and_b32 v23, 0xffff0000, v32
  v_add_f32 v22, v22, v20
  v_mfma_f32_16x16x32_bf16 v[96:99], a[232:235], v[240:243], v[96:99]
  buffer_load_dwordx4 a[248:251], v16, s[8:11], s41 offen offset:2048 sc1
  v_mfma_f32_16x16x32_bf16 v[100:103], a[236:239], v[240:243], v[100:103]
  v_add_f32 v23, v23, v21
  v_mfma_f32_16x16x32_bf16 v[104:107], a[220:223], a[20:23], v[104:107]
  v_lshlrev_b32 v20, 16, v33
  v_and_b32 v21, 0xffff0000, v33
  v_mfma_f32_16x16x32_bf16 v[108:111], a[224:227], a[20:23], v[108:111]
  buffer_load_dwordx4 a[252:255], v16, s[8:11], s42 offen offset:2048 sc1
  v_mfma_f32_16x16x32_bf16 v[112:115], a[228:231], a[20:23], v[112:115]
  v_sub_f32 v20, v20, v0
  v_sub_f32 v21, v21, v0
  v_mfma_f32_16x16x32_bf16 v[116:119], a[232:235], a[20:23], v[116:119]
  buffer_load_dwordx4 v[224:227], v16, s[8:11], s40 offen offset:3072 sc1
  v_readlane_b32 s40, v13, 4
  s_nop 1
  s_lshl_b32 s40, s40, 2
  s_add_u32 s40, s40, s49
  v_mfma_f32_16x16x32_bf16 v[120:123], a[236:239], a[20:23], v[120:123]
  v_mfma_f32_16x16x32_bf16 v[124:127], a[220:223], a[24:27], v[124:127]
  v_mfma_f32_16x16x32_bf16 v[128:131], a[224:227], a[24:27], v[128:131]
  buffer_load_dwordx4 a[0:3], v16, s[8:11], s41 offen offset:3072 sc1
  v_readlane_b32 s41, v13, 10
  s_nop 1
  s_lshl_b32 s41, s41, 2
  s_add_u32 s41, s41, s49
  v_mfma_f32_16x16x32_bf16 v[132:135], a[228:231], a[24:27], v[132:135]
  v_mfma_f32_16x16x32_bf16 v[136:139], a[232:235], a[24:27], v[136:139]
  buffer_load_dwordx4 a[4:7], v16, s[8:11], s42 offen offset:3072 sc1
  v_readlane_b32 s42, v13, 11
  s_nop 1
  s_lshl_b32 s42, s42, 2
  s_add_u32 s42, s42, s49
  v_mfma_f32_16x16x32_bf16 v[140:143], a[236:239], a[24:27], v[140:143]
  s_waitcnt vmcnt(22)
  v_mfma_f32_16x16x32_bf16 v[64:67], a[100:103], a[28:31], v[64:67]
  v_mfma_f32_16x16x32_bf16 v[68:71], a[104:107], a[28:31], v[68:71]
  buffer_load_dwordx4 a[8:11], v16, s[8:11], s43 offen offset:0 sc1
  v_mfma_f32_16x16x32_bf16 v[72:75], a[108:111], a[28:31], v[72:75]
  v_mfma_f32_16x16x32_bf16 v[76:79], a[112:115], a[28:31], v[76:79]
  buffer_load_dwordx4 a[12:15], v16, s[8:11], s43 offen offset:1024 sc1
  v_mfma_f32_16x16x32_bf16 v[80:83], a[116:119], a[28:31], v[80:83]
  s_waitcnt vmcnt(23)
  v_mfma_f32_16x16x32_bf16 v[84:87], a[100:103], a[32:35], v[84:87]
  v_cvt_pk_bf16_f32 v20, v20, v21
  v_mfma_f32_16x16x32_bf16 v[88:91], a[104:107], a[32:35], v[88:91]
  buffer_load_dwordx4 a[16:19], v16, s[8:11], s43 offen offset:2048 sc1
  v_mfma_f32_16x16x32_bf16 v[92:95], a[108:111], a[32:35], v[92:95]
  v_and_b32 v21, 0xffff0000, v20
  v_lshlrev_b32 v20, 16, v20
  v_mfma_f32_16x16x32_bf16 v[96:99], a[112:115], a[32:35], v[96:99]
  buffer_load_dwordx4 v[228:231], v16, s[8:11], s43 offen offset:3072 sc1
  v_readlane_b32 s43, v13, 5
  s_nop 1
  s_lshl_b32 s43, s43, 2
  s_add_u32 s43, s43, s49
  v_mfma_f32_16x16x32_bf16 v[100:103], a[116:119], a[32:35], v[100:103]
  s_waitcnt vmcnt(23)
  v_mfma_f32_16x16x32_bf16 v[104:107], a[100:103], a[36:39], v[104:107]
  v_mfma_f32_16x16x32_bf16 v[108:111], a[104:107], a[36:39], v[108:111]
  buffer_load_dwordx4 v[232:235], v16, s[8:11], s40 offen offset:0 sc1
  v_mfma_f32_16x16x32_bf16 v[112:115], a[108:111], a[36:39], v[112:115]
  v_mul_f32 v20, v20, v1
  v_mfma_f32_16x16x32_bf16 v[116:119], a[112:115], a[36:39], v[116:119]
  buffer_load_dwordx4 v[236:239], v16, s[8:11], s40 offen offset:1024 sc1
  v_mfma_f32_16x16x32_bf16 v[120:123], a[116:119], a[36:39], v[120:123]
  v_mul_f32 v21, v21, v1
  s_waitcnt vmcnt(24)
  v_mfma_f32_16x16x32_bf16 v[124:127], a[100:103], v[244:247], v[124:127]
  v_cvt_pk_bf16_f32 v20, v20, v21
  v_and_b32 v21, 0xffff0000, v20
  v_mfma_f32_16x16x32_bf16 v[128:131], a[104:107], v[244:247], v[128:131]
  buffer_load_dwordx4 v[240:243], v16, s[8:11], s40 offen offset:2048 sc1
  v_mfma_f32_16x16x32_bf16 v[132:135], a[108:111], v[244:247], v[132:135]
  v_lshlrev_b32 v20, 16, v20
  v_lshlrev_b32 v34, 16, v35
  v_mfma_f32_16x16x32_bf16 v[136:139], a[112:115], v[244:247], v[136:139]
  buffer_load_dwordx4 a[20:23], v16, s[8:11], s40 offen offset:3072 sc1
  v_readlane_b32 s40, v13, 6
  s_nop 1
  s_lshl_b32 s40, s40, 2
  s_add_u32 s40, s40, s49
  v_mfma_f32_16x16x32_bf16 v[140:143], a[116:119], v[244:247], v[140:143]
  s_waitcnt vmcnt(24)
  v_mfma_f32_16x16x32_bf16 v[64:67], a[120:123], v[248:251], v[64:67]
  v_mfma_f32_16x16x32_bf16 v[68:71], a[124:127], v[248:251], v[68:71]
  buffer_load_dwordx4 a[24:27], v16, s[8:11], s41 offen offset:0 sc1
  v_mfma_f32_16x16x32_bf16 v[72:75], a[128:131], v[248:251], v[72:75]
  v_and_b32 v35, 0xffff0000, v35
  v_mfma_f32_16x16x32_bf16 v[76:79], a[132:135], v[248:251], v[76:79]
  v_mul_f32 v20, v20, v34
  v_mul_f32 v21, v21, v35
  v_mfma_f32_16x16x32_bf16 v[80:83], a[136:139], v[248:251], v[80:83]
  v_cvt_pk_bf16_f32 v20, v20, v21
  s_waitcnt vmcnt(24)
  v_mfma_f32_16x16x32_bf16 v[84:87], a[120:123], v[252:255], v[84:87]
  v_and_b32 v21, 0xffff0000, v20
  v_lshlrev_b32 v20, 16, v20
  v_mfma_f32_16x16x32_bf16 v[88:91], a[124:127], v[252:255], v[88:91]
  buffer_load_dwordx4 a[28:31], v16, s[8:11], s41 offen offset:1024 sc1
  v_mfma_f32_16x16x32_bf16 v[92:95], a[128:131], v[252:255], v[92:95]
  v_lshlrev_b32 v34, 16, v33
  v_and_b32 v35, 0xffff0000, v33
  v_mfma_f32_16x16x32_bf16 v[96:99], a[132:135], v[252:255], v[96:99]
  v_add_f32 v34, v34, v20
  v_add_f32 v35, v35, v21
  v_mfma_f32_16x16x32_bf16 v[100:103], a[136:139], v[252:255], v[100:103]
  v_mov_b32 v32, v22
  s_waitcnt vmcnt(23)
  v_mfma_f32_16x16x32_bf16 v[104:107], a[120:123], v[52:55], v[104:107]
  v_mov_b32 v33, v23
  v_rcp_f32 v25, v25
  v_mfma_f32_16x16x32_bf16 v[108:111], a[124:127], v[52:55], v[108:111]
  buffer_load_dwordx4 a[32:35], v16, s[8:11], s41 offen offset:2048 sc1
  v_mfma_f32_16x16x32_bf16 v[112:115], a[128:131], v[52:55], v[112:115]
  v_lshlrev_b32 v20, 16, v36
  v_mfma_f32_16x16x32_bf16 v[116:119], a[132:135], v[52:55], v[116:119]
  v_and_b32 v21, 0xffff0000, v36
  v_sub_f32 v20, v20, v24
  v_mfma_f32_16x16x32_bf16 v[120:123], a[136:139], v[52:55], v[120:123]
  v_sub_f32 v21, v21, v24
  s_waitcnt vmcnt(23)
  v_mfma_f32_16x16x32_bf16 v[124:127], a[120:123], a[40:43], v[124:127]
  v_cvt_pk_bf16_f32 v20, v20, v21
  v_and_b32 v21, 0xffff0000, v20
  v_mfma_f32_16x16x32_bf16 v[128:131], a[124:127], a[40:43], v[128:131]
  buffer_load_dwordx4 a[36:39], v16, s[8:11], s41 offen offset:3072 sc1
  v_readlane_b32 s41, v13, 7
  s_nop 1
  s_lshl_b32 s41, s41, 2
  s_add_u32 s41, s41, s49
  v_mfma_f32_16x16x32_bf16 v[132:135], a[128:131], a[40:43], v[132:135]
  v_mfma_f32_16x16x32_bf16 v[136:139], a[132:135], a[40:43], v[136:139]
  v_mfma_f32_16x16x32_bf16 v[140:143], a[136:139], a[40:43], v[140:143]
  v_lshlrev_b32 v20, 16, v20
  s_waitcnt vmcnt(23)
  v_mfma_f32_16x16x32_bf16 v[64:67], a[140:143], a[44:47], v[64:67]
  v_mul_f32 v20, v20, v25
  v_mul_f32 v21, v21, v25
  v_mfma_f32_16x16x32_bf16 v[68:71], a[144:147], a[44:47], v[68:71]
  buffer_load_dwordx4 v[244:247], v16, s[8:11], s42 offen offset:0 sc1
  v_mfma_f32_16x16x32_bf16 v[72:75], a[148:151], a[44:47], v[72:75]
  v_cvt_pk_bf16_f32 v20, v20, v21
  v_and_b32 v21, 0xffff0000, v20
  v_mfma_f32_16x16x32_bf16 v[76:79], a[152:155], a[44:47], v[76:79]
  v_lshlrev_b32 v20, 16, v20
  v_lshlrev_b32 v22, 16, v38
  v_mfma_f32_16x16x32_bf16 v[80:83], a[156:159], a[44:47], v[80:83]
  v_and_b32 v23, 0xffff0000, v38
  s_waitcnt vmcnt(23)
  v_mfma_f32_16x16x32_bf16 v[64:67], a[160:163], a[48:51], v[64:67]
  v_mul_f32 v20, v20, v22
  v_mul_f32 v21, v21, v23
  v_mfma_f32_16x16x32_bf16 v[68:71], a[164:167], a[48:51], v[68:71]
  buffer_load_dwordx4 v[248:251], v16, s[8:11], s42 offen offset:1024 sc1
  v_mfma_f32_16x16x32_bf16 v[72:75], a[168:171], a[48:51], v[72:75]
  v_cvt_pk_bf16_f32 v20, v20, v21
  v_and_b32 v21, 0xffff0000, v20
  v_mfma_f32_16x16x32_bf16 v[76:79], a[172:175], a[48:51], v[76:79]
  v_lshlrev_b32 v20, 16, v20
  v_lshlrev_b32 v22, 16, v36
  v_mfma_f32_16x16x32_bf16 v[80:83], a[176:179], a[48:51], v[80:83]
  v_and_b32 v23, 0xffff0000, v36
  s_waitcnt vmcnt(23)
  v_mfma_f32_16x16x32_bf16 v[64:67], a[180:183], a[52:55], v[64:67]
  v_add_f32 v22, v22, v20
  v_add_f32 v23, v23, v21
  v_mfma_f32_16x16x32_bf16 v[68:71], a[184:187], a[52:55], v[68:71]
  buffer_load_dwordx4 v[252:255], v16, s[8:11], s42 offen offset:2048 sc1
  v_mfma_f32_16x16x32_bf16 v[72:75], a[188:191], a[52:55], v[72:75]
  v_lshlrev_b32 v20, 16, v37
  v_and_b32 v21, 0xffff0000, v37
  v_mfma_f32_16x16x32_bf16 v[76:79], a[192:195], a[52:55], v[76:79]
  v_sub_f32 v20, v20, v24
  v_sub_f32 v21, v21, v24
  v_mfma_f32_16x16x32_bf16 v[80:83], a[196:199], a[52:55], v[80:83]
  v_cvt_pk_bf16_f32 v20, v20, v21
  s_waitcnt vmcnt(23)
  v_mfma_f32_16x16x32_bf16 v[84:87], a[140:143], a[56:59], v[84:87]
  v_and_b32 v21, 0xffff0000, v20
  v_lshlrev_b32 v20, 16, v20
  v_mfma_f32_16x16x32_bf16 v[88:91], a[144:147], a[56:59], v[88:91]
  buffer_load_dwordx4 v[52:55], v16, s[8:11], s42 offen offset:3072 sc1
  v_readlane_b32 s42, v13, 8
  s_nop 1
  s_lshl_b32 s42, s42, 2
  s_add_u32 s42, s42, s49
  v_mfma_f32_16x16x32_bf16 v[92:95], a[148:151], a[56:59], v[92:95]
  v_mfma_f32_16x16x32_bf16 v[96:99], a[152:155], a[56:59], v[96:99]
  v_mfma_f32_16x16x32_bf16 v[100:103], a[156:159], a[56:59], v[100:103]
  v_mul_f32 v20, v20, v25
  s_waitcnt vmcnt(23)
  v_mfma_f32_16x16x32_bf16 v[84:87], a[160:163], v[56:59], v[84:87]
  ds_write_b128 v12, v[64:67] offset:0
  v_mfma_f32_16x16x32_bf16 v[88:91], a[164:167], v[56:59], v[88:91]
  buffer_load_dwordx4 a[40:43], v16, s[8:11], s43 offen offset:0 sc1
  v_mfma_f32_16x16x32_bf16 v[92:95], a[168:171], v[56:59], v[92:95]
  v_mul_f32 v21, v21, v25
  v_cvt_pk_bf16_f32 v20, v20, v21
  v_mfma_f32_16x16x32_bf16 v[96:99], a[172:175], v[56:59], v[96:99]
  ds_write_b128 v12, v[68:71] offset:64
  v_mfma_f32_16x16x32_bf16 v[100:103], a[176:179], v[56:59], v[100:103]
  v_and_b32 v21, 0xffff0000, v20
  s_waitcnt vmcnt(23)
  v_mfma_f32_16x16x32_bf16 v[84:87], a[180:183], a[240:243], v[84:87]
  v_lshlrev_b32 v20, 16, v20
  v_lshlrev_b32 v38, 16, v39
  v_mfma_f32_16x16x32_bf16 v[88:91], a[184:187], a[240:243], v[88:91]
  buffer_load_dwordx4 a[44:47], v16, s[8:11], s43 offen offset:1024 sc1
  ds_write_b128 v12, v[72:75] offset:128
  v_mfma_f32_16x16x32_bf16 v[92:95], a[188:191], a[240:243], v[92:95]
  v_mfma_f32_16x16x32_bf16 v[96:99], a[192:195], a[240:243], v[96:99]
  v_and_b32 v39, 0xffff0000, v39
  v_mul_f32 v20, v20, v38
  v_mfma_f32_16x16x32_bf16 v[100:103], a[196:199], a[240:243], v[100:103]
  ds_write_b128 v12, v[76:79] offset:192
  s_waitcnt vmcnt(23)
  v_mfma_f32_16x16x32_bf16 v[104:107], a[140:143], a[244:247], v[104:107]
  v_mul_f32 v21, v21, v39
  v_mfma_f32_16x16x32_bf16 v[108:111], a[144:147], a[244:247], v[108:111]
  buffer_load_dwordx4 a[48:51], v16, s[8:11], s43 offen offset:2048 sc1
  v_mfma_f32_16x16x32_bf16 v[112:115], a[148:151], a[244:247], v[112:115]
  ds_write_b128 v12, v[80:83] offset:256
  v_mfma_f32_16x16x32_bf16 v[116:119], a[152:155], a[244:247], v[116:119]
  v_cvt_pk_bf16_f32 v20, v20, v21
  v_and_b32 v21, 0xffff0000, v20
  v_mfma_f32_16x16x32_bf16 v[120:123], a[156:159], a[244:247], v[120:123]
  v_lshlrev_b32 v20, 16, v20
  s_waitcnt vmcnt(23)
  v_mfma_f32_16x16x32_bf16 v[104:107], a[160:163], a[248:251], v[104:107]
  ds_write_b128 v12, v[84:87] offset:5120
  v_mfma_f32_16x16x32_bf16 v[108:111], a[164:167], a[248:251], v[108:111]
  buffer_load_dwordx4 a[52:55], v16, s[8:11], s43 offen offset:3072 sc1
  v_readlane_b32 s43, v13, 9
  s_nop 1
  s_lshl_b32 s43, s43, 2
  s_add_u32 s43, s43, s49
  v_mfma_f32_16x16x32_bf16 v[112:115], a[168:171], a[248:251], v[112:115]
  v_mfma_f32_16x16x32_bf16 v[116:119], a[172:175], a[248:251], v[116:119]
  ds_write_b128 v12, v[88:91] offset:5184
  v_mfma_f32_16x16x32_bf16 v[120:123], a[176:179], a[248:251], v[120:123]
  s_waitcnt vmcnt(23)
  v_mfma_f32_16x16x32_bf16 v[104:107], a[180:183], a[252:255], v[104:107]
  v_lshlrev_b32 v38, 16, v37
  v_mfma_f32_16x16x32_bf16 v[108:111], a[184:187], a[252:255], v[108:111]
  buffer_load_dwordx4 a[56:59], v16, s[8:11], s40 offen offset:0 sc1
  ds_write_b128 v12, v[92:95] offset:5248
  v_mfma_f32_16x16x32_bf16 v[112:115], a[188:191], a[252:255], v[112:115]
  v_mfma_f32_16x16x32_bf16 v[116:119], a[192:195], a[252:255], v[116:119]
  v_and_b32 v39, 0xffff0000, v37
  v_add_f32 v38, v38, v20
  v_mfma_f32_16x16x32_bf16 v[120:123], a[196:199], a[252:255], v[120:123]
  ds_write_b128 v12, v[96:99] offset:5312
  s_waitcnt vmcnt(23)
  v_mfma_f32_16x16x32_bf16 v[124:127], a[140:143], v[224:227], v[124:127]
  v_add_f32 v39, v39, v21
  v_mfma_f32_16x16x32_bf16 v[128:131], a[144:147], v[224:227], v[128:131]
  buffer_load_dwordx4 v[56:59], v16, s[8:11], s40 offen offset:1024 sc1
  v_mfma_f32_16x16x32_bf16 v[132:135], a[148:151], v[224:227], v[132:135]
  ds_write_b128 v12, v[100:103] offset:5376
  v_mfma_f32_16x16x32_bf16 v[136:139], a[152:155], v[224:227], v[136:139]
  v_mov_b32 v36, v22
  v_mov_b32 v37, v23
  v_mfma_f32_16x16x32_bf16 v[140:143], a[156:159], v[224:227], v[140:143]
  v_rcp_f32 v27, v27
  s_waitcnt vmcnt(23)
  v_mfma_f32_16x16x32_bf16 v[124:127], a[160:163], a[0:3], v[124:127]
  ds_write_b128 v12, v[104:107] offset:10240
  v_mfma_f32_16x16x32_bf16 v[128:131], a[164:167], a[0:3], v[128:131]
  buffer_load_dwordx4 a[240:243], v16, s[8:11], s40 offen offset:2048 sc1
  v_mfma_f32_16x16x32_bf16 v[132:135], a[168:171], a[0:3], v[132:135]
  v_lshlrev_b32 v20, 16, v40
  v_mfma_f32_16x16x32_bf16 v[136:139], a[172:175], a[0:3], v[136:139]
  ds_write_b128 v12, v[108:111] offset:10304
  v_mfma_f32_16x16x32_bf16 v[140:143], a[176:179], a[0:3], v[140:143]
  v_and_b32 v21, 0xffff0000, v40
  s_waitcnt vmcnt(23)
  v_mfma_f32_16x16x32_bf16 v[124:127], a[180:183], a[4:7], v[124:127]
  v_sub_f32 v20, v20, v26
  v_sub_f32 v21, v21, v26
  v_mfma_f32_16x16x32_bf16 v[128:131], a[184:187], a[4:7], v[128:131]
  buffer_load_dwordx4 a[244:247], v16, s[8:11], s40 offen offset:3072 sc1
  ds_write_b128 v12, v[112:115] offset:10368
  v_mfma_f32_16x16x32_bf16 v[132:135], a[188:191], a[4:7], v[132:135]
  v_mfma_f32_16x16x32_bf16 v[136:139], a[192:195], a[4:7], v[136:139]
  v_cvt_pk_bf16_f32 v20, v20, v21
  v_and_b32 v21, 0xffff0000, v20
  v_mfma_f32_16x16x32_bf16 v[140:143], a[196:199], a[4:7], v[140:143]
  ds_write_b128 v12, v[116:119] offset:10432
  s_waitcnt vmcnt(23)
  v_mfma_f32_16x16x32_bf16 v[144:147], a[60:63], a[8:11], v[144:147]
  v_lshlrev_b32 v20, 16, v20
  v_mfma_f32_16x16x32_bf16 v[148:151], a[64:67], a[8:11], v[148:151]
  buffer_load_dwordx4 a[248:251], v16, s[8:11], s41 offen offset:0 sc1
  v_mfma_f32_16x16x32_bf16 v[152:155], a[68:71], a[8:11], v[152:155]
  ds_write_b128 v12, v[120:123] offset:10496
  v_mfma_f32_16x16x32_bf16 v[156:159], a[72:75], a[8:11], v[156:159]
  v_mul_f32 v20, v20, v27
  v_mul_f32 v21, v21, v27
  v_mfma_f32_16x16x32_bf16 v[160:163], a[76:79], a[8:11], v[160:163]
  v_cvt_pk_bf16_f32 v20, v20, v21
  s_waitcnt vmcnt(23)
  v_mfma_f32_16x16x32_bf16 v[164:167], a[60:63], a[12:15], v[164:167]
  ds_write_b128 v12, v[124:127] offset:15360
  v_mfma_f32_16x16x32_bf16 v[168:171], a[64:67], a[12:15], v[168:171]
  buffer_load_dwordx4 a[252:255], v16, s[8:11], s42 offen offset:0 sc1
  v_mfma_f32_16x16x32_bf16 v[172:175], a[68:71], a[12:15], v[172:175]
  v_and_b32 v21, 0xffff0000, v20
  v_lshlrev_b32 v20, 16, v20
  v_mfma_f32_16x16x32_bf16 v[176:179], a[72:75], a[12:15], v[176:179]
  ds_write_b128 v12, v[128:131] offset:15424
  v_mfma_f32_16x16x32_bf16 v[180:183], a[76:79], a[12:15], v[180:183]
  v_lshlrev_b32 v22, 16, v42
  s_waitcnt vmcnt(23)
  v_mfma_f32_16x16x32_bf16 v[184:187], a[60:63], a[16:19], v[184:187]
  v_and_b32 v23, 0xffff0000, v42
  v_mul_f32 v20, v20, v22
  v_mfma_f32_16x16x32_bf16 v[188:191], a[64:67], a[16:19], v[188:191]
  buffer_load_dwordx4 v[224:227], v16, s[8:11], s43 offen offset:0 sc1
  ds_write_b128 v12, v[132:135] offset:15488
  v_mfma_f32_16x16x32_bf16 v[192:195], a[68:71], a[16:19], v[192:195]
  v_mfma_f32_16x16x32_bf16 v[196:199], a[72:75], a[16:19], v[196:199]
  v_mul_f32 v21, v21, v23
  v_cvt_pk_bf16_f32 v20, v20, v21
  v_mfma_f32_16x16x32_bf16 v[200:203], a[76:79], a[16:19], v[200:203]
  ds_write_b128 v12, v[136:139] offset:15552
  s_waitcnt vmcnt(23)
  v_mfma_f32_16x16x32_bf16 v[204:207], a[60:63], v[228:231], v[204:207]
  v_and_b32 v21, 0xffff0000, v20
  v_mfma_f32_16x16x32_bf16 v[208:211], a[64:67], v[228:231], v[208:211]
  buffer_load_dwordx4 a[0:3], v16, s[8:11], s41 offen offset:1024 sc1
  v_mfma_f32_16x16x32_bf16 v[212:215], a[68:71], v[228:231], v[212:215]
  ds_write_b128 v12, v[140:143] offset:15616
  v_mfma_f32_16x16x32_bf16 v[216:219], a[72:75], v[228:231], v[216:219]
  v_lshlrev_b32 v20, 16, v20
  v_lshlrev_b32 v22, 16, v40
  v_mfma_f32_16x16x32_bf16 v[220:223], a[76:79], v[228:231], v[220:223]
  v_and_b32 v23, 0xffff0000, v40
  s_waitcnt vmcnt(23)
  v_mfma_f32_16x16x32_bf16 v[144:147], a[80:83], v[232:235], v[144:147]
  v_add_f32 v22, v22, v20
  v_add_f32 v23, v23, v21
  v_mfma_f32_16x16x32_bf16 v[148:151], a[84:87], v[232:235], v[148:151]
  buffer_load_dwordx4 a[4:7], v16, s[8:11], s42 offen offset:1024 sc1
  v_mfma_f32_16x16x32_bf16 v[152:155], a[88:91], v[232:235], v[152:155]
  v_lshlrev_b32 v20, 16, v41
  v_and_b32 v21, 0xffff0000, v41
  v_mfma_f32_16x16x32_bf16 v[156:159], a[92:95], v[232:235], v[156:159]
  s_waitcnt lgkmcnt(0)
  s_barrier
  v_mfma_f32_16x16x32_bf16 v[160:163], a[96:99], v[232:235], v[160:163]
  v_sub_f32 v20, v20, v26
  s_waitcnt vmcnt(23)
  v_mfma_f32_16x16x32_bf16 v[164:167], a[80:83], v[236:239], v[164:167]
  v_sub_f32 v21, v21, v26
  v_cvt_pk_bf16_f32 v20, v20, v21
  v_mfma_f32_16x16x32_bf16 v[168:171], a[84:87], v[236:239], v[168:171]
  buffer_load_dwordx4 a[8:11], v16, s[8:11], s43 offen offset:1024 sc1
  v_mfma_f32_16x16x32_bf16 v[172:175], a[88:91], v[236:239], v[172:175]
  v_and_b32 v21, 0xffff0000, v20
  v_lshlrev_b32 v20, 16, v20
  v_mfma_f32_16x16x32_bf16 v[176:179], a[92:95], v[236:239], v[176:179]
  v_mul_f32 v20, v20, v27
  v_mul_f32 v21, v21, v27
  v_mfma_f32_16x16x32_bf16 v[180:183], a[96:99], v[236:239], v[180:183]
  v_cvt_pk_bf16_f32 v20, v20, v21
  s_waitcnt vmcnt(23)
  v_mfma_f32_16x16x32_bf16 v[184:187], a[80:83], v[240:243], v[184:187]
  v_and_b32 v21, 0xffff0000, v20
  v_lshlrev_b32 v20, 16, v20
  v_mfma_f32_16x16x32_bf16 v[188:191], a[84:87], v[240:243], v[188:191]
  buffer_load_dwordx4 a[12:15], v16, s[8:11], s41 offen offset:2048 sc1
  v_mfma_f32_16x16x32_bf16 v[192:195], a[88:91], v[240:243], v[192:195]
  v_lshlrev_b32 v42, 16, v43
  v_and_b32 v43, 0xffff0000, v43
  v_mfma_f32_16x16x32_bf16 v[196:199], a[92:95], v[240:243], v[196:199]
  v_mul_f32 v20, v20, v42
  v_mul_f32 v21, v21, v43
  v_mfma_f32_16x16x32_bf16 v[200:203], a[96:99], v[240:243], v[200:203]
  v_cvt_pk_bf16_f32 v20, v20, v21
  s_waitcnt vmcnt(23)
  v_mfma_f32_16x16x32_bf16 v[204:207], a[80:83], a[20:23], v[204:207]
  v_and_b32 v21, 0xffff0000, v20
  v_lshlrev_b32 v20, 16, v20
  v_mfma_f32_16x16x32_bf16 v[208:211], a[84:87], a[20:23], v[208:211]
  buffer_load_dwordx4 a[16:19], v16, s[8:11], s42 offen offset:2048 sc1
  v_mfma_f32_16x16x32_bf16 v[212:215], a[88:91], a[20:23], v[212:215]
  v_lshlrev_b32 v42, 16, v41
  v_and_b32 v43, 0xffff0000, v41
  v_mfma_f32_16x16x32_bf16 v[216:219], a[92:95], a[20:23], v[216:219]
  v_add_f32 v42, v42, v20
  v_add_f32 v43, v43, v21
  v_mfma_f32_16x16x32_bf16 v[220:223], a[96:99], a[20:23], v[220:223]
  v_mov_b32 v40, v22
  s_waitcnt vmcnt(23)
  v_mfma_f32_16x16x32_bf16 v[144:147], a[200:203], a[24:27], v[144:147]
  v_mov_b32 v41, v23
  v_rcp_f32 v29, v29
  v_mfma_f32_16x16x32_bf16 v[148:151], a[204:207], a[24:27], v[148:151]
  buffer_load_dwordx4 a[60:63], v16, s[8:11], s43 offen offset:2048 sc1
  v_mfma_f32_16x16x32_bf16 v[152:155], a[208:211], a[24:27], v[152:155]
  v_lshlrev_b32 v20, 16, v44
  v_mfma_f32_16x16x32_bf16 v[156:159], a[212:215], a[24:27], v[156:159]
  v_and_b32 v21, 0xffff0000, v44
  v_sub_f32 v20, v20, v28
  v_mfma_f32_16x16x32_bf16 v[160:163], a[216:219], a[24:27], v[160:163]
  v_sub_f32 v21, v21, v28
  s_waitcnt vmcnt(23)
  v_mfma_f32_16x16x32_bf16 v[164:167], a[200:203], a[28:31], v[164:167]
  v_cvt_pk_bf16_f32 v20, v20, v21
  v_and_b32 v21, 0xffff0000, v20
  v_mfma_f32_16x16x32_bf16 v[168:171], a[204:207], a[28:31], v[168:171]
  buffer_load_dwordx4 a[64:67], v16, s[8:11], s41 offen offset:3072 sc1
  v_mfma_f32_16x16x32_bf16 v[172:175], a[208:211], a[28:31], v[172:175]
  v_lshlrev_b32 v20, 16, v20
  v_mul_f32 v20, v20, v29
  v_mfma_f32_16x16x32_bf16 v[176:179], a[212:215], a[28:31], v[176:179]
  v_mul_f32 v21, v21, v29
  v_cvt_pk_bf16_f32 v20, v20, v21
  v_mfma_f32_16x16x32_bf16 v[180:183], a[216:219], a[28:31], v[180:183]
  v_and_b32 v21, 0xffff0000, v20
  s_waitcnt vmcnt(23)
  v_mfma_f32_16x16x32_bf16 v[184:187], a[200:203], a[32:35], v[184:187]
  v_lshlrev_b32 v20, 16, v20
  v_lshlrev_b32 v22, 16, v46
  v_mfma_f32_16x16x32_bf16 v[188:191], a[204:207], a[32:35], v[188:191]
  buffer_load_dwordx4 a[68:71], v16, s[8:11], s42 offen offset:3072 sc1
  v_mfma_f32_16x16x32_bf16 v[192:195], a[208:211], a[32:35], v[192:195]
  v_and_b32 v23, 0xffff0000, v46
  v_mul_f32 v20, v20, v22
  v_mfma_f32_16x16x32_bf16 v[196:199], a[212:215], a[32:35], v[196:199]
  v_mul_f32 v21, v21, v23
  v_cvt_pk_bf16_f32 v20, v20, v21
  v_mfma_f32_16x16x32_bf16 v[200:203], a[216:219], a[32:35], v[200:203]
  v_and_b32 v21, 0xffff0000, v20
  s_waitcnt vmcnt(23)
  v_mfma_f32_16x16x32_bf16 v[204:207], a[200:203], a[36:39], v[204:207]
  v_lshlrev_b32 v20, 16, v20
  v_lshlrev_b32 v22, 16, v44
  v_mfma_f32_16x16x32_bf16 v[208:211], a[204:207], a[36:39], v[208:211]
  buffer_load_dwordx4 a[72:75], v16, s[8:11], s43 offen offset:3072 sc1
  v_mfma_f32_16x16x32_bf16 v[212:215], a[208:211], a[36:39], v[212:215]
  v_and_b32 v23, 0xffff0000, v44
  v_add_f32 v22, v22, v20
  v_mfma_f32_16x16x32_bf16 v[216:219], a[212:215], a[36:39], v[216:219]
  v_add_f32 v23, v23, v21
  v_lshlrev_b32 v20, 16, v45
  v_mfma_f32_16x16x32_bf16 v[220:223], a[216:219], a[36:39], v[220:223]
  v_and_b32 v21, 0xffff0000, v45
  s_waitcnt vmcnt(23)
  v_mfma_f32_16x16x32_bf16 v[144:147], a[220:223], v[244:247], v[144:147]
  v_sub_f32 v20, v20, v28
  ds_read_b128 v[64:67], v7 offset:0
  v_mfma_f32_16x16x32_bf16 v[148:151], a[224:227], v[244:247], v[148:151]
  ds_read_b128 v[68:71], v7 offset:20480
  v_mfma_f32_16x16x32_bf16 v[152:155], a[228:231], v[244:247], v[152:155]
  ds_read_b128 v[72:75], v7 offset:40960
  v_mfma_f32_16x16x32_bf16 v[156:159], a[232:235], v[244:247], v[156:159]
  ds_read_b128 v[76:79], v7 offset:61440
  v_mfma_f32_16x16x32_bf16 v[160:163], a[236:239], v[244:247], v[160:163]
  ds_read_b128 v[80:83], v8 offset:0
  s_waitcnt vmcnt(22)
  v_mfma_f32_16x16x32_bf16 v[164:167], a[220:223], v[248:251], v[164:167]
  ds_read_b128 v[84:87], v8 offset:20480
  v_mfma_f32_16x16x32_bf16 v[168:171], a[224:227], v[248:251], v[168:171]
  ds_read_b128 v[88:91], v8 offset:40960
  v_mfma_f32_16x16x32_bf16 v[172:175], a[228:231], v[248:251], v[172:175]
  ds_read_b128 v[92:95], v8 offset:61440
  v_mfma_f32_16x16x32_bf16 v[176:179], a[232:235], v[248:251], v[176:179]
  s_waitcnt lgkmcnt(4)
  v_add_f32 v64, v64, v68
  v_mfma_f32_16x16x32_bf16 v[180:183], a[236:239], v[248:251], v[180:183]
  v_add_f32 v65, v65, v69
  s_waitcnt vmcnt(21)
  v_mfma_f32_16x16x32_bf16 v[184:187], a[220:223], v[252:255], v[184:187]
  v_add_f32 v66, v66, v70
  v_add_f32 v67, v67, v71
  v_mfma_f32_16x16x32_bf16 v[188:191], a[224:227], v[252:255], v[188:191]
  v_add_f32 v72, v72, v76
  v_add_f32 v73, v73, v77
  v_mfma_f32_16x16x32_bf16 v[192:195], a[228:231], v[252:255], v[192:195]
  v_add_f32 v74, v74, v78
  v_add_f32 v75, v75, v79
  v_mfma_f32_16x16x32_bf16 v[196:199], a[232:235], v[252:255], v[196:199]
  v_add_f32 v64, v64, v72
  v_add_f32 v65, v65, v73
  v_mfma_f32_16x16x32_bf16 v[200:203], a[236:239], v[252:255], v[200:203]
  v_add_f32 v66, v66, v74
  s_waitcnt vmcnt(20)
  v_mfma_f32_16x16x32_bf16 v[204:207], a[220:223], v[52:55], v[204:207]
  v_add_f32 v67, v67, v75
  s_add_u32 s3, s33, 0
  buffer_store_dwordx4 v[64:67], v14, s[12:15], s3 offen sc1
  v_mfma_f32_16x16x32_bf16 v[208:211], a[224:227], v[52:55], v[208:211]
  ds_read_b128 v[96:99], v9 offset:0
  v_mfma_f32_16x16x32_bf16 v[212:215], a[228:231], v[52:55], v[212:215]
  ds_read_b128 v[100:103], v9 offset:20480
  v_mfma_f32_16x16x32_bf16 v[216:219], a[232:235], v[52:55], v[216:219]
  ds_read_b128 v[104:107], v9 offset:40960
  v_mfma_f32_16x16x32_bf16 v[220:223], a[236:239], v[52:55], v[220:223]
  ds_read_b128 v[108:111], v9 offset:61440
  s_waitcnt vmcnt(20)
  v_mfma_f32_16x16x32_bf16 v[144:147], a[100:103], a[40:43], v[144:147]
  s_waitcnt lgkmcnt(4)
  v_mfma_f32_16x16x32_bf16 v[148:151], a[104:107], a[40:43], v[148:151]
  v_add_f32 v80, v80, v84
  v_add_f32 v81, v81, v85
  v_mfma_f32_16x16x32_bf16 v[152:155], a[108:111], a[40:43], v[152:155]
  v_add_f32 v82, v82, v86
  v_add_f32 v83, v83, v87
  v_mfma_f32_16x16x32_bf16 v[156:159], a[112:115], a[40:43], v[156:159]
  v_add_f32 v88, v88, v92
  v_add_f32 v89, v89, v93
  v_mfma_f32_16x16x32_bf16 v[160:163], a[116:119], a[40:43], v[160:163]
  v_add_f32 v90, v90, v94
  s_waitcnt vmcnt(19)
  v_mfma_f32_16x16x32_bf16 v[164:167], a[100:103], a[44:47], v[164:167]
  v_add_f32 v91, v91, v95
  v_add_f32 v80, v80, v88
  v_mfma_f32_16x16x32_bf16 v[168:171], a[104:107], a[44:47], v[168:171]
  v_add_f32 v81, v81, v89
  v_add_f32 v82, v82, v90
  v_mfma_f32_16x16x32_bf16 v[172:175], a[108:111], a[44:47], v[172:175]
  v_add_f32 v83, v83, v91
  s_add_u32 s3, s33, 4096
  buffer_store_dwordx4 v[80:83], v14, s[12:15], s3 offen sc1
  v_mfma_f32_16x16x32_bf16 v[176:179], a[112:115], a[44:47], v[176:179]
  ds_read_b128 v[112:115], v10 offset:0
  v_mfma_f32_16x16x32_bf16 v[180:183], a[116:119], a[44:47], v[180:183]
  s_waitcnt vmcnt(19)
  v_mfma_f32_16x16x32_bf16 v[184:187], a[100:103], a[48:51], v[184:187]
  ds_read_b128 v[116:119], v10 offset:20480
  v_mfma_f32_16x16x32_bf16 v[188:191], a[104:107], a[48:51], v[188:191]
  ds_read_b128 v[120:123], v10 offset:40960
  v_mfma_f32_16x16x32_bf16 v[192:195], a[108:111], a[48:51], v[192:195]
  ds_read_b128 v[124:127], v10 offset:61440
  v_mfma_f32_16x16x32_bf16 v[196:199], a[112:115], a[48:51], v[196:199]
  s_waitcnt lgkmcnt(4)
  v_add_f32 v96, v96, v100
  v_mfma_f32_16x16x32_bf16 v[200:203], a[116:119], a[48:51], v[200:203]
  v_add_f32 v97, v97, v101
  s_waitcnt vmcnt(18)
  v_mfma_f32_16x16x32_bf16 v[204:207], a[100:103], a[52:55], v[204:207]
  v_add_f32 v98, v98, v102
  v_add_f32 v99, v99, v103
  v_mfma_f32_16x16x32_bf16 v[208:211], a[104:107], a[52:55], v[208:211]
  v_add_f32 v104, v104, v108
  v_add_f32 v105, v105, v109
  v_mfma_f32_16x16x32_bf16 v[212:215], a[108:111], a[52:55], v[212:215]
  v_add_f32 v106, v106, v110
  v_add_f32 v107, v107, v111
  v_mfma_f32_16x16x32_bf16 v[216:219], a[112:115], a[52:55], v[216:219]
  v_add_f32 v96, v96, v104
  v_add_f32 v97, v97, v105
  v_mfma_f32_16x16x32_bf16 v[220:223], a[116:119], a[52:55], v[220:223]
  v_add_f32 v98, v98, v106
  s_waitcnt vmcnt(17)
  v_mfma_f32_16x16x32_bf16 v[144:147], a[120:123], a[56:59], v[144:147]
  v_add_f32 v99, v99, v107
  s_add_u32 s3, s33, 8192
  buffer_store_dwordx4 v[96:99], v14, s[12:15], s3 offen sc1
  v_mfma_f32_16x16x32_bf16 v[148:151], a[124:127], a[56:59], v[148:151]
  ds_read_b128 v[128:131], v11 offset:0
  v_mfma_f32_16x16x32_bf16 v[152:155], a[128:131], a[56:59], v[152:155]
  ds_read_b128 v[132:135], v11 offset:20480
  v_mfma_f32_16x16x32_bf16 v[156:159], a[132:135], a[56:59], v[156:159]
  ds_read_b128 v[136:139], v11 offset:40960
  v_mfma_f32_16x16x32_bf16 v[160:163], a[136:139], a[56:59], v[160:163]
  ds_read_b128 v[140:143], v11 offset:61440
  s_waitcnt vmcnt(17)
  v_mfma_f32_16x16x32_bf16 v[164:167], a[120:123], v[56:59], v[164:167]
  s_waitcnt lgkmcnt(4)
  v_mfma_f32_16x16x32_bf16 v[168:171], a[124:127], v[56:59], v[168:171]
  v_add_f32 v112, v112, v116
  v_add_f32 v113, v113, v117
  v_mfma_f32_16x16x32_bf16 v[172:175], a[128:131], v[56:59], v[172:175]
  v_add_f32 v114, v114, v118
  v_add_f32 v115, v115, v119
  v_mfma_f32_16x16x32_bf16 v[176:179], a[132:135], v[56:59], v[176:179]
  v_add_f32 v120, v120, v124
  v_add_f32 v121, v121, v125
  v_mfma_f32_16x16x32_bf16 v[180:183], a[136:139], v[56:59], v[180:183]
  v_add_f32 v122, v122, v126
  s_waitcnt vmcnt(16)
  v_mfma_f32_16x16x32_bf16 v[184:187], a[120:123], a[240:243], v[184:187]
  v_add_f32 v123, v123, v127
  v_add_f32 v112, v112, v120
  v_mfma_f32_16x16x32_bf16 v[188:191], a[124:127], a[240:243], v[188:191]
  v_add_f32 v113, v113, v121
  v_add_f32 v114, v114, v122
  v_mfma_f32_16x16x32_bf16 v[192:195], a[128:131], a[240:243], v[192:195]
  v_add_f32 v115, v115, v123
  s_add_u32 s3, s33, 12288
  buffer_store_dwordx4 v[112:115], v14, s[12:15], s3 offen sc1
  v_mfma_f32_16x16x32_bf16 v[196:199], a[132:135], a[240:243], v[196:199]
  s_waitcnt lgkmcnt(0)
  v_mfma_f32_16x16x32_bf16 v[200:203], a[136:139], a[240:243], v[200:203]
  v_add_f32 v128, v128, v132
  s_waitcnt vmcnt(16)
  v_mfma_f32_16x16x32_bf16 v[204:207], a[120:123], a[244:247], v[204:207]
  v_add_f32 v129, v129, v133
  v_add_f32 v130, v130, v134
  v_mfma_f32_16x16x32_bf16 v[208:211], a[124:127], a[244:247], v[208:211]
  v_add_f32 v131, v131, v135
  v_add_f32 v136, v136, v140
  v_mfma_f32_16x16x32_bf16 v[212:215], a[128:131], a[244:247], v[212:215]
  v_add_f32 v137, v137, v141
  v_add_f32 v138, v138, v142
  v_mfma_f32_16x16x32_bf16 v[216:219], a[132:135], a[244:247], v[216:219]
  v_add_f32 v139, v139, v143
  v_add_f32 v128, v128, v136
  v_mfma_f32_16x16x32_bf16 v[220:223], a[136:139], a[244:247], v[220:223]
  v_add_f32 v129, v129, v137
  s_waitcnt vmcnt(15)
  v_mfma_f32_16x16x32_bf16 v[144:147], a[140:143], a[248:251], v[144:147]
  v_add_f32 v130, v130, v138
  v_add_f32 v131, v131, v139
  v_mfma_f32_16x16x32_bf16 v[148:151], a[144:147], a[248:251], v[148:151]
  s_add_u32 s3, s33, 16384
  buffer_store_dwordx4 v[128:131], v14, s[12:15], s3 offen sc1
  v_mfma_f32_16x16x32_bf16 v[152:155], a[148:151], a[248:251], v[152:155]
  v_add_u32 v7, 81920, v7
  v_add_u32 v8, 81920, v8
  v_mfma_f32_16x16x32_bf16 v[156:159], a[152:155], a[248:251], v[156:159]
  v_add_u32 v9, 81920, v9
  v_add_u32 v10, 81920, v10
  v_mfma_f32_16x16x32_bf16 v[160:163], a[156:159], a[248:251], v[160:163]
  v_add_u32 v11, 81920, v11
  s_waitcnt vmcnt(15)
  v_mfma_f32_16x16x32_bf16 v[144:147], a[160:163], a[252:255], v[144:147]
  v_sub_f32 v21, v21, v28
  v_cvt_pk_bf16_f32 v20, v20, v21
  v_mfma_f32_16x16x32_bf16 v[148:151], a[164:167], a[252:255], v[148:151]
  v_and_b32 v21, 0xffff0000, v20
  v_lshlrev_b32 v20, 16, v20
  v_mfma_f32_16x16x32_bf16 v[152:155], a[168:171], a[252:255], v[152:155]
  v_mul_f32 v20, v20, v29
  v_mul_f32 v21, v21, v29
  v_mfma_f32_16x16x32_bf16 v[156:159], a[172:175], a[252:255], v[156:159]
  v_cvt_pk_bf16_f32 v20, v20, v21
  v_and_b32 v21, 0xffff0000, v20
  v_mfma_f32_16x16x32_bf16 v[160:163], a[176:179], a[252:255], v[160:163]
  v_lshlrev_b32 v20, 16, v20
  s_waitcnt vmcnt(14)
  v_mfma_f32_16x16x32_bf16 v[144:147], a[180:183], v[224:227], v[144:147]
  v_lshlrev_b32 v46, 16, v47
  v_and_b32 v47, 0xffff0000, v47
  v_mfma_f32_16x16x32_bf16 v[148:151], a[184:187], v[224:227], v[148:151]
  v_mul_f32 v20, v20, v46
  v_mul_f32 v21, v21, v47
  v_mfma_f32_16x16x32_bf16 v[152:155], a[188:191], v[224:227], v[152:155]
  v_cvt_pk_bf16_f32 v20, v20, v21
  v_and_b32 v21, 0xffff0000, v20
  v_mfma_f32_16x16x32_bf16 v[156:159], a[192:195], v[224:227], v[156:159]
  v_lshlrev_b32 v20, 16, v20
  v_lshlrev_b32 v46, 16, v45
  v_mfma_f32_16x16x32_bf16 v[160:163], a[196:199], v[224:227], v[160:163]
  v_and_b32 v47, 0xffff0000, v45
  s_waitcnt vmcnt(13)
  v_mfma_f32_16x16x32_bf16 v[164:167], a[140:143], a[0:3], v[164:167]
  v_add_f32 v46, v46, v20
  v_add_f32 v47, v47, v21
  v_mfma_f32_16x16x32_bf16 v[168:171], a[144:147], a[0:3], v[168:171]
  v_mov_b32 v44, v22
  v_mov_b32 v45, v23
  v_mfma_f32_16x16x32_bf16 v[172:175], a[148:151], a[0:3], v[172:175]
  v_rcp_f32 v31, v31
  v_mfma_f32_16x16x32_bf16 v[176:179], a[152:155], a[0:3], v[176:179]
  v_lshlrev_b32 v20, 16, v48
  v_and_b32 v21, 0xffff0000, v48
  v_mfma_f32_16x16x32_bf16 v[180:183], a[156:159], a[0:3], v[180:183]
  v_sub_f32 v20, v20, v30
  s_waitcnt vmcnt(12)
  v_mfma_f32_16x16x32_bf16 v[164:167], a[160:163], a[4:7], v[164:167]
  ds_write_b128 v15, v[144:147] offset:0
  v_mfma_f32_16x16x32_bf16 v[168:171], a[164:167], a[4:7], v[168:171]
  v_sub_f32 v21, v21, v30
  v_cvt_pk_bf16_f32 v20, v20, v21
  v_mfma_f32_16x16x32_bf16 v[172:175], a[168:171], a[4:7], v[172:175]
  v_and_b32 v21, 0xffff0000, v20
  v_lshlrev_b32 v20, 16, v20
  v_mfma_f32_16x16x32_bf16 v[176:179], a[172:175], a[4:7], v[176:179]
  ds_write_b128 v15, v[148:151] offset:64
  v_mfma_f32_16x16x32_bf16 v[180:183], a[176:179], a[4:7], v[180:183]
  v_mul_f32 v20, v20, v31
  s_waitcnt vmcnt(11)
  v_mfma_f32_16x16x32_bf16 v[164:167], a[180:183], a[8:11], v[164:167]
  v_mul_f32 v21, v21, v31
  v_cvt_pk_bf16_f32 v20, v20, v21
  v_mfma_f32_16x16x32_bf16 v[168:171], a[184:187], a[8:11], v[168:171]
  ds_write_b128 v15, v[152:155] offset:128
  v_mfma_f32_16x16x32_bf16 v[172:175], a[188:191], a[8:11], v[172:175]
  v_and_b32 v21, 0xffff0000, v20
  v_lshlrev_b32 v20, 16, v20
  v_mfma_f32_16x16x32_bf16 v[176:179], a[192:195], a[8:11], v[176:179]
  s_waitcnt vmcnt(0)
  v_mov_b32 v18, s60
  s_mov_b64 exec, 1
  buffer_store_dword v18, v17, s[64:67], s56 offen sc1
  s_mov_b64 exec, -1
  v_mfma_f32_16x16x32_bf16 v[180:183], a[196:199], a[8:11], v[180:183]
  ds_write_b128 v15, v[156:159] offset:192
  v_mfma_f32_16x16x32_bf16 v[184:187], a[140:143], a[12:15], v[184:187]
  v_mfma_f32_16x16x32_bf16 v[188:191], a[144:147], a[12:15], v[188:191]
  v_lshlrev_b32 v22, 16, v50
  v_mfma_f32_16x16x32_bf16 v[192:195], a[148:151], a[12:15], v[192:195]
  ds_write_b128 v15, v[160:163] offset:256
  v_mfma_f32_16x16x32_bf16 v[196:199], a[152:155], a[12:15], v[196:199]
  v_and_b32 v23, 0xffff0000, v50
  v_mul_f32 v20, v20, v22
  v_mfma_f32_16x16x32_bf16 v[200:203], a[156:159], a[12:15], v[200:203]
  v_mul_f32 v21, v21, v23
  v_mfma_f32_16x16x32_bf16 v[184:187], a[160:163], a[16:19], v[184:187]
  ds_write_b128 v15, v[164:167] offset:5120
  v_mfma_f32_16x16x32_bf16 v[188:191], a[164:167], a[16:19], v[188:191]
  v_cvt_pk_bf16_f32 v20, v20, v21
  v_and_b32 v21, 0xffff0000, v20
  v_mfma_f32_16x16x32_bf16 v[192:195], a[168:171], a[16:19], v[192:195]
  v_lshlrev_b32 v20, 16, v20
  v_lshlrev_b32 v22, 16, v48
  v_mfma_f32_16x16x32_bf16 v[196:199], a[172:175], a[16:19], v[196:199]
  ds_write_b128 v15, v[168:171] offset:5184
  v_mfma_f32_16x16x32_bf16 v[200:203], a[176:179], a[16:19], v[200:203]
  v_and_b32 v23, 0xffff0000, v48
  v_mfma_f32_16x16x32_bf16 v[184:187], a[180:183], a[60:63], v[184:187]
  v_add_f32 v22, v22, v20
  v_add_f32 v23, v23, v21
  v_mfma_f32_16x16x32_bf16 v[188:191], a[184:187], a[60:63], v[188:191]
  ds_write_b128 v15, v[172:175] offset:5248
  v_mfma_f32_16x16x32_bf16 v[192:195], a[188:191], a[60:63], v[192:195]
  v_lshlrev_b32 v20, 16, v49
  v_and_b32 v21, 0xffff0000, v49
  v_mfma_f32_16x16x32_bf16 v[196:199], a[192:195], a[60:63], v[196:199]
  v_sub_f32 v20, v20, v30
  v_sub_f32 v21, v21, v30
  v_mfma_f32_16x16x32_bf16 v[200:203], a[196:199], a[60:63], v[200:203]
  ds_write_b128 v15, v[176:179] offset:5312
  v_mfma_f32_16x16x32_bf16 v[204:207], a[140:143], a[64:67], v[204:207]
  v_cvt_pk_bf16_f32 v20, v20, v21
  v_mfma_f32_16x16x32_bf16 v[208:211], a[144:147], a[64:67], v[208:211]
  v_and_b32 v21, 0xffff0000, v20
  v_lshlrev_b32 v20, 16, v20
  v_mfma_f32_16x16x32_bf16 v[212:215], a[148:151], a[64:67], v[212:215]
  ds_write_b128 v15, v[180:183] offset:5376
  v_mfma_f32_16x16x32_bf16 v[216:219], a[152:155], a[64:67], v[216:219]
  v_mul_f32 v20, v20, v31
  v_mul_f32 v21, v21, v31
  v_mfma_f32_16x16x32_bf16 v[220:223], a[156:159], a[64:67], v[220:223]
  v_cvt_pk_bf16_f32 v20, v20, v21
  v_mfma_f32_16x16x32_bf16 v[204:207], a[160:163], a[68:71], v[204:207]
  ds_write_b128 v15, v[184:187] offset:10240
  v_mfma_f32_16x16x32_bf16 v[208:211], a[164:167], a[68:71], v[208:211]
  v_and_b32 v21, 0xffff0000, v20
  v_lshlrev_b32 v20, 16, v20
  v_mfma_f32_16x16x32_bf16 v[212:215], a[168:171], a[68:71], v[212:215]
  v_lshlrev_b32 v50, 16, v51
  v_and_b32 v51, 0xffff0000, v51
  v_mfma_f32_16x16x32_bf16 v[216:219], a[172:175], a[68:71], v[216:219]
  ds_write_b128 v15, v[188:191] offset:10304
  v_mfma_f32_16x16x32_bf16 v[220:223], a[176:179], a[68:71], v[220:223]
  v_mul_f32 v20, v20, v50
  v_mfma_f32_16x16x32_bf16 v[204:207], a[180:183], a[72:75], v[204:207]
  v_mul_f32 v21, v21, v51
  v_cvt_pk_bf16_f32 v20, v20, v21
  v_mfma_f32_16x16x32_bf16 v[208:211], a[184:187], a[72:75], v[208:211]
  ds_write_b128 v15, v[192:195] offset:10368
  v_mfma_f32_16x16x32_bf16 v[212:215], a[188:191], a[72:75], v[212:215]
  v_and_b32 v21, 0xffff0000, v20
  v_lshlrev_b32 v20, 16, v20
  v_mfma_f32_16x16x32_bf16 v[216:219], a[192:195], a[72:75], v[216:219]
  v_lshlrev_b32 v50, 16, v49
  v_and_b32 v51, 0xffff0000, v49
  v_mfma_f32_16x16x32_bf16 v[220:223], a[196:199], a[72:75], v[220:223]
  ds_write_b128 v15, v[196:199] offset:10432
  buffer_load_dword v19, v17, s[64:67], s57 offen sc1
  v_add_f32 v50, v50, v20
  v_add_f32 v51, v51, v21
  v_mov_b32 v48, v22
  v_mov_b32 v49, v23
  s_nop 3
  s_nop 0
  ds_write_b128 v15, v[200:203] offset:10496
  s_nop 0
  ds_write_b128 v15, v[204:207] offset:15360
  s_nop 0
  ds_write_b128 v15, v[208:211] offset:15424
  s_nop 0
  ds_write_b128 v15, v[212:215] offset:15488
  s_nop 0
  ds_write_b128 v15, v[216:219] offset:15552
  s_nop 0
  ds_write_b128 v15, v[220:223] offset:15616
  s_waitcnt lgkmcnt(0)
  s_barrier
  ds_read_b128 v[144:147], v7 offset:0
  ds_read_b128 v[148:151], v7 offset:20480
  ds_read_b128 v[152:155], v7 offset:40960
  ds_read_b128 v[156:159], v7 offset:61440
  ds_read_b128 v[160:163], v8 offset:0
  ds_read_b128 v[164:167], v8 offset:20480
  ds_read_b128 v[168:171], v8 offset:40960
  ds_read_b128 v[172:175], v8 offset:61440
  ds_read_b128 v[176:179], v9 offset:0
  ds_read_b128 v[180:183], v9 offset:20480
  ds_read_b128 v[184:187], v9 offset:40960
  ds_read_b128 v[188:191], v9 offset:61440
  s_waitcnt vmcnt(0)
  s_mov_b32 s62, 0
L_CHK47:
  v_cmp_ne_u32 vcc, s60, v19
  s_cbranch_vccz L_OK47
  s_add_u32 s62, s62, 1
  s_cmp_lt_u32 s62, 0x40000
  s_cbranch_scc0 L_OK47
  s_sleep 2
  buffer_load_dword v19, v17, s[64:67], s57 offen sc1
  s_waitcnt vmcnt(0)
  s_branch L_CHK47
L_OK47:
  s_add_u32 s3, s32, 0
  buffer_load_dwordx4 v[76:79], v14, s[12:15], s3 offen sc1
  s_add_u32 s3, s32, 4096
  buffer_load_dwordx4 v[92:95], v14, s[12:15], s3 offen sc1
  s_add_u32 s3, s32, 8192
  buffer_load_dwordx4 v[108:111], v14, s[12:15], s3 offen sc1
  s_add_u32 s3, s32, 12288
  buffer_load_dwordx4 v[124:127], v14, s[12:15], s3 offen sc1
  s_add_u32 s3, s32, 16384
  buffer_load_dwordx4 v[140:143], v14, s[12:15], s3 offen sc1
  ds_read_b128 v[192:195], v10 offset:0
  ds_read_b128 v[196:199], v10 offset:20480
  ds_read_b128 v[200:203], v10 offset:40960
  ds_read_b128 v[204:207], v10 offset:61440
  ds_read_b128 v[208:211], v11 offset:0
  ds_read_b128 v[212:215], v11 offset:20480
  ds_read_b128 v[216:219], v11 offset:40960
  ds_read_b128 v[220:223], v11 offset:61440
  s_waitcnt lgkmcnt(15)
  v_pk_add_f32 v[144:145], v[144:145], v[148:149]
  v_pk_add_f32 v[146:147], v[146:147], v[150:151]
  v_pk_add_f32 v[152:153], v[152:153], v[156:157]
  v_pk_add_f32 v[154:155], v[154:155], v[158:159]
  v_pk_add_f32 v[144:145], v[144:145], v[32:33]
  v_pk_add_f32 v[146:147], v[146:147], v[34:35]
  v_pk_add_f32 v[144:145], v[144:145], v[152:153]
  v_pk_add_f32 v[146:147], v[146:147], v[154:155]
  s_waitcnt lgkmcnt(12)
  v_pk_add_f32 v[160:161], v[160:161], v[164:165]
  v_pk_add_f32 v[162:163], v[162:163], v[166:167]
  v_pk_add_f32 v[168:169], v[168:169], v[172:173]
  v_pk_add_f32 v[170:171], v[170:171], v[174:175]
  v_pk_add_f32 v[160:161], v[160:161], v[36:37]
  v_pk_add_f32 v[162:163], v[162:163], v[38:39]
  v_pk_add_f32 v[160:161], v[160:161], v[168:169]
  v_pk_add_f32 v[162:163], v[162:163], v[170:171]
  s_waitcnt lgkmcnt(8)
  v_pk_add_f32 v[176:177], v[176:177], v[180:181]
  v_pk_add_f32 v[178:179], v[178:179], v[182:183]
  v_pk_add_f32 v[184:185], v[184:185], v[188:189]
  v_pk_add_f32 v[186:187], v[186:187], v[190:191]
  v_pk_add_f32 v[176:177], v[176:177], v[40:41]
  v_pk_add_f32 v[178:179], v[178:179], v[42:43]
  v_pk_add_f32 v[176:177], v[176:177], v[184:185]
  v_pk_add_f32 v[178:179], v[178:179], v[186:187]
  s_waitcnt lgkmcnt(4)
  v_pk_add_f32 v[192:193], v[192:193], v[196:197]
  v_pk_add_f32 v[194:195], v[194:195], v[198:199]
  v_pk_add_f32 v[200:201], v[200:201], v[204:205]
  v_pk_add_f32 v[202:203], v[202:203], v[206:207]
  v_pk_add_f32 v[192:193], v[192:193], v[44:45]
  v_pk_add_f32 v[194:195], v[194:195], v[46:47]
  v_pk_add_f32 v[192:193], v[192:193], v[200:201]
  v_pk_add_f32 v[194:195], v[194:195], v[202:203]
  s_waitcnt lgkmcnt(0)
  v_pk_add_f32 v[208:209], v[208:209], v[212:213]
  v_pk_add_f32 v[210:211], v[210:211], v[214:215]
  v_pk_add_f32 v[216:217], v[216:217], v[220:221]
  v_pk_add_f32 v[218:219], v[218:219], v[222:223]
  v_pk_add_f32 v[208:209], v[208:209], v[48:49]
  v_pk_add_f32 v[210:211], v[210:211], v[50:51]
  v_pk_add_f32 v[208:209], v[208:209], v[216:217]
  v_pk_add_f32 v[210:211], v[210:211], v[218:219]
  s_waitcnt vmcnt(4)
  v_pk_add_f32 v[144:145], v[144:145], v[76:77]
  v_pk_add_f32 v[146:147], v[146:147], v[78:79]
  buffer_store_dwordx4 v[144:147], v2, s[44:47], 0 offen
  s_waitcnt vmcnt(4)
  v_pk_add_f32 v[160:161], v[160:161], v[92:93]
  v_pk_add_f32 v[162:163], v[162:163], v[94:95]
  buffer_store_dwordx4 v[160:163], v3, s[44:47], 0 offen
  s_waitcnt vmcnt(4)
  v_pk_add_f32 v[176:177], v[176:177], v[108:109]
  v_pk_add_f32 v[178:179], v[178:179], v[110:111]
  buffer_store_dwordx4 v[176:179], v4, s[44:47], 0 offen
  s_waitcnt vmcnt(4)
  v_pk_add_f32 v[192:193], v[192:193], v[124:125]
  v_pk_add_f32 v[194:195], v[194:195], v[126:127]
  buffer_store_dwordx4 v[192:195], v5, s[44:47], 0 offen
  s_waitcnt vmcnt(4)
  v_pk_add_f32 v[208:209], v[208:209], v[140:141]
  v_pk_add_f32 v[210:211], v[210:211], v[142:143]
  buffer_store_dwordx4 v[208:211], v6, s[44:47], 0 offen
L_END:
  s_endpgm
.fill 4096, 4, 0xbf810000
.section .rodata,"a"
.p2align 6
.amdhsa_kernel parallel_sum__ssm_conv_s5__glu_gated_geglu__prompt_kernel
  .amdhsa_next_free_vgpr 512
  .amdhsa_next_free_sgpr 102
  .amdhsa_accum_offset 256
  .amdhsa_group_segment_fixed_size 0
  .amdhsa_kernarg_size 128
  .amdhsa_user_sgpr_count 2
  .amdhsa_user_sgpr_kernarg_segment_ptr 1
  .amdhsa_system_sgpr_workgroup_id_x 1
.end_amdhsa_kernel
```
